```python
import torch

def _softmax(x, axis=-1):
    return torch.softmax(x, dim=axis)

def _gelu(x):
    return torch.nn.functional.gelu(x, approximate='tanh')

def _silu(x):
    return torch.nn.functional.silu(x)

def _sigmoid(x):
    return torch.sigmoid(x)

def _layernorm(x, axis=-1, eps=1e-05):
    m = x.mean(dim=axis, keepdim=True)
    v = x.var(dim=axis, keepdim=True, unbiased=False)
    return (x - m) / torch.sqrt(v + eps)

def _scatter_add(tgt, idx, src, axis=0):
    return tgt.clone().index_add_(axis, idx, src)

def _segment_sum(src, seg, n):
    out = torch.zeros((n,) + src.shape[1:], dtype=src.dtype)
    return out.index_add_(0, seg, src)

def _pad(x, pw):
    flat = tuple((v for pair in reversed(pw) for v in pair))
    return torch.nn.functional.pad(x, flat)
kernel_name = 'gated_mix__mha_block__memory_aug_recurrent_mem_tr__prompt'

def setup_inputs():

    _w = lambda a: (lambda t: t.to(torch.bfloat16) if t.is_floating_point() else t)(torch.as_tensor(a))

    def _A_setup():
        B, S, D, H = (1, 2048, 512, 32)
        return {'x': _w((lambda *s: torch.randn(*s, dtype=torch.bfloat16) * 0.05)(B, S, D)), 'wqkv': _w((lambda *s: torch.randn(*s, dtype=torch.bfloat16) * 0.8)(D, 3 * D)), 'wo': _w((lambda *s: torch.randn(*s, dtype=torch.bfloat16) * 0.05)(D, D))}
    _A_in = _A_setup()

    def _B_setup():
        B, S, Dm = (1, 2048, 512)
        H, Dh = (32, 128)
        M, seg = (8, 32)
        seg = min(seg, S)
        S = S // seg * seg
        return {'x': _w((lambda *s: torch.randn(*s, dtype=torch.bfloat16) * 0.05)(B, S, Dm)), 'mem0': _w((lambda *s: torch.randn(*s, dtype=torch.bfloat16) * 0.8)(B, M, Dm)), 'Wq': _w((lambda *s: torch.randn(*s, dtype=torch.bfloat16) * 1.6)(Dm, H, Dh) * Dm ** (-0.5)), 'Wk': _w((lambda *s: torch.randn(*s, dtype=torch.bfloat16) * 1.6)(Dm, H, Dh) * Dm ** (-0.5)), 'Wv': _w((lambda *s: torch.randn(*s, dtype=torch.bfloat16) * 0.8)(Dm, H, Dh) * Dm ** (-0.5)), 'Wo': _w((lambda *s: torch.randn(*s, dtype=torch.bfloat16) * 0.8)(H, Dh, Dm) * (H * Dh) ** (-0.5)), 'seg_len': seg}
    _B_in = _B_setup()
    return {'A_x': _A_in['x'], 'A_wqkv': _A_in['wqkv'], 'A_wo': _A_in['wo'], 'B_x': _B_in['x'], 'B_mem0': _B_in['mem0'], 'B_Wq': _B_in['Wq'], 'B_Wk': _B_in['Wk'], 'B_Wv': _B_in['Wv'], 'B_Wo': _B_in['Wo'], 'B_seg_len': _B_in['seg_len'], 'gate_w': _w((lambda *s: torch.randn(*s, dtype=torch.bfloat16) * 0.05)(512) * 16.0)}

def reference(A_x, A_wqkv, A_wo, B_x, B_mem0, B_Wq, B_Wk, B_Wv, B_Wo, B_seg_len, gate_w):

    def _A_ref(x, wqkv, wo):
        B, S, D = x.shape
        H = 32
        Dh = D // H
        qkv = (lambda x, *d: x.permute(*d))((x @ wqkv).reshape(B, S, 3, H, Dh), 2, 0, 3, 1, 4)
        q, k, v = (qkv[0], qkv[1], qkv[2])
        scores = torch.einsum('bhqd,bhkd->bhqk', q, k) * Dh ** (-0.5)
        p = _softmax(scores, axis=-1)
        o = torch.einsum('bhqk,bhkd->bhqd', p, v)
        return (lambda x, *d: x.permute(*d))(o, 0, 2, 1, 3).reshape(B, S, D) @ wo

    def _B_ref(x, mem0, Wq, Wk, Wv, Wo, seg_len):
        B, S, Dm = x.shape
        H, Dh = (Wq.shape[1], Wq.shape[2])
        M = mem0.shape[1]
        scale = Dh ** (-0.5)
        n_seg = S // seg_len
        L = M + seg_len
        idx = torch.arange(L)
        mask = (idx[:, None] < M) | (idx[:, None] >= idx[None, :])
        mem = mem0
        outs = []
        for s in range(n_seg):
            xs = x[:, s * seg_len:(s + 1) * seg_len, :].clone()
            h = torch.concatenate([mem, xs], axis=1)
            q = torch.einsum('btd,dhe->bhte', h, Wq)
            k = torch.einsum('btd,dhe->bhte', h, Wk)
            v = torch.einsum('btd,dhe->bhte', h, Wv)
            scores = torch.einsum('bhqe,bhke->bhqk', q, k) * scale
            scores = torch.where(mask[None, None], scores, -1000000000.0)
            p = _softmax(scores, axis=-1)
            o = torch.einsum('bhqk,bhke->bhqe', p, v)
            o = torch.einsum('bhte,hed->btd', o, Wo)
            mem = o[:, :M, :].clone()
            outs.append(o[:, M:, :])
        return torch.concatenate(outs, axis=1)
    x = A_x
    g = _sigmoid((x * gate_w).sum(-1, keepdims=True))
    a = _A_ref(x, A_wqkv, A_wo)
    b = _B_ref(x, B_mem0, B_Wq, B_Wk, B_Wv, B_Wo, B_seg_len)
    return g * a + (1 - g) * b
```

```asm
; @launch grid=(256,1,1) block=(256,1,1) lds=163840
.amdgcn_target "amdgcn-amd-amdhsa--gfx950"
.text
.globl gated_mix__mha_block__memory_aug_recurrent_mem_tr__prompt_kernel
.p2align 8
.type gated_mix__mha_block__memory_aug_recurrent_mem_tr__prompt_kernel,@function
gated_mix__mha_block__memory_aug_recurrent_mem_tr__prompt_kernel:
s_cmp_ge_u32 s2, 256
s_cbranch_scc0 L_go
s_endpgm
L_go:
s_load_dwordx16 s[8:23], s[0:1], 0
s_load_dwordx8 s[24:31], s[0:1], 64
s_load_dwordx4 s[32:35], s[0:1], 96
s_getreg_b32 s5, hwreg(HW_REG_XCC_ID)
v_lshrrev_b32 v1, 6, v0
v_and_b32 v0, 63, v0
s_and_b32 s5, s5, 7
v_readfirstlane_b32 s3, v1
s_mov_b32 s56, 524288
s_mov_b32 s57, 0x05040100
s_mov_b32 s58, 0x07060302
s_lshl_b32 s52, s5, 2
s_add_u32 s52, s52, 128
s_cmp_eq_u32 s5, 0
s_cselect_b32 s52, 0, s52
s_waitcnt lgkmcnt(0)
s_mov_b32 s36, s34
s_mov_b32 s37, s35
s_mov_b32 s38, 268435456
s_mov_b32 s39, 0x20000
s_mov_b32 s40, s32
s_mov_b32 s41, s33
s_mov_b32 s42, 256
s_mov_b32 s43, 0x20000
s_cmp_lg_u32 s3, 0
s_cbranch_scc1 L_rank_wait
s_mov_b32 s4, 1
s_atomic_add s4, s[32:33], s52 glc
s_waitcnt lgkmcnt(0)
s_cmp_lt_u32 s4, 32
s_cbranch_scc0 L_overflow
s_lshl_b32 s52, s5, 5
s_add_u32 s4, s4, s52
L_have_slot:
v_mov_b32 v1, 0
v_mov_b32 v2, s4
ds_write_b32 v1, v2
s_waitcnt lgkmcnt(0)
L_rank_wait:
s_barrier
v_mov_b32 v1, 0
ds_read_b32 v2, v1
s_waitcnt lgkmcnt(0)
v_readfirstlane_b32 s4, v2
s_barrier
s_cmp_lt_u32 s4, 256
s_cbranch_scc1 L_slot_ok
s_endpgm
L_slot_ok:
s_cmp_lt_u32 s4, 32
s_cbranch_scc1 L_role_r
s_sub_u32 s52, s4, 32
s_mul_i32 s60, s52, 9363
s_lshr_b32 s60, s60, 16
s_mul_i32 s53, s60, 7
s_sub_u32 s61, s52, s53
s_cmp_eq_u32 s61, 0
s_cselect_b32 s62, 10, 9
v_mov_b32 v191, v0
v_lshlrev_b32 v176, 4, v0
v_and_b32 v1, 15, v0
v_lshrrev_b32 v2, 4, v0
v_lshlrev_b32 v177, 10, v1
v_lshl_add_u32 v177, v2, 4, v177
v_and_b32 v3, 1, v2
v_lshrrev_b32 v4, 1, v2
v_lshlrev_b32 v5, 4, v1
v_lshl_add_u32 v6, v4, 3, v5
v_lshl_add_u32 v178, v3, 9, v6
v_lshl_add_u32 v180, v3, 8, v6
v_lshl_add_u32 v6, v3, 3, v5
v_lshl_add_u32 v179, v4, 9, v6
s_lshl_b32 s52, s60, 8
s_lshl_b32 s53, s3, 6
s_add_u32 s52, s52, s53
v_lshlrev_b32 v181, 16, v2
v_lshl_add_u32 v181, v1, 2, v181
v_add_u32 v181, s52, v181
s_mov_b32 s54, 24576
v_mul_lo_u32 v182, v2, s54
v_lshl_add_u32 v182, v1, 1, v182
s_lshl_b32 s52, s60, 5
s_lshl_b32 s53, s3, 10
s_add_u32 s52, s52, s53
v_add_u32 v182, s52, v182
s_mov_b32 s92, s8
s_mov_b32 s93, s9
s_mov_b32 s94, 2097152
s_mov_b32 s95, 0x20000
s_mov_b32 s96, s30
s_mov_b32 s97, s31
s_mov_b32 s98, 2097152
s_mov_b32 s99, 0x20000
s_cmp_lg_u32 s4, 32
s_cbranch_scc1 L_noinit
v_mov_b64 v[8:9], 0
v_mov_b64 v[10:11], 0
s_lshl_b32 s52, s3, 13
buffer_store_dwordx4 v[8:11], v176, s[36:39], s52 offen offset:0 sc0 sc1
buffer_store_dwordx4 v[8:11], v176, s[36:39], s52 offen offset:1024 sc0 sc1
buffer_store_dwordx4 v[8:11], v176, s[36:39], s52 offen offset:2048 sc0 sc1
buffer_store_dwordx4 v[8:11], v176, s[36:39], s52 offen offset:3072 sc0 sc1
s_add_u32 s52, s52, 4096
buffer_store_dwordx4 v[8:11], v176, s[36:39], s52 offen offset:0 sc0 sc1
buffer_store_dwordx4 v[8:11], v176, s[36:39], s52 offen offset:1024 sc0 sc1
buffer_store_dwordx4 v[8:11], v176, s[36:39], s52 offen offset:2048 sc0 sc1
buffer_store_dwordx4 v[8:11], v176, s[36:39], s52 offen offset:3072 sc0 sc1
s_waitcnt vmcnt(0)
s_barrier
v_mov_b32 v8, 1
buffer_store_dword v8, off, s[40:43], 0 offset:192 sc0 sc1
L_noinit:
s_mov_b32 s64, s61
s_mov_b32 s65, 0
s_sub_u32 s66, s4, 32
s_lshl_b32 s66, s66, 2
s_add_u32 s66, s66, s3
s_lshl_b32 s66, s66, 10
v_add_u32 v189, s66, v176
s_mov_b32 s48, s18
s_mov_b32 s49, s19
s_mov_b32 s50, 4194304
s_mov_b32 s51, 0x20000
buffer_load_dwordx4 v[128:131], v189, s[48:51], 0 offen
v_add_u32 v188, 917504, v189
buffer_load_dwordx4 v[132:135], v188, s[48:51], 0 offen
v_add_u32 v188, 1835008, v189
buffer_load_dwordx4 v[136:139], v188, s[48:51], 0 offen
v_add_u32 v188, 2752512, v189
buffer_load_dwordx4 v[140:143], v188, s[48:51], 0 offen
v_add_u32 v188, 3670016, v189
buffer_load_dwordx4 v[144:147], v188, s[48:51], 0 offen
s_mov_b32 s48, s24
s_mov_b32 s49, s25
s_mov_b32 s50, 4194304
s_mov_b32 s51, 0x20000
buffer_load_dwordx4 v[128:131], v189, s[48:51], 0 offen
v_add_u32 v188, 917504, v189
buffer_load_dwordx4 v[132:135], v188, s[48:51], 0 offen
v_add_u32 v188, 1835008, v189
buffer_load_dwordx4 v[136:139], v188, s[48:51], 0 offen
v_add_u32 v188, 2752512, v189
buffer_load_dwordx4 v[140:143], v188, s[48:51], 0 offen
v_add_u32 v188, 3670016, v189
buffer_load_dwordx4 v[144:147], v188, s[48:51], 0 offen
s_lshl_b32 s52, s64, 15
s_lshl_b32 s53, s3, 8
s_add_u32 s52, s52, s53
s_lshl_b32 s53, s3, 13
s_add_u32 s53, s53, s65
s_add_u32 m0, s53, 0
s_add_u32 s54, s52, 0
buffer_load_dwordx4 v177, s[92:95], s54 offen lds
s_add_u32 m0, s53, 1024
s_add_u32 s54, s52, 16384
buffer_load_dwordx4 v177, s[92:95], s54 offen lds
s_add_u32 m0, s53, 2048
s_add_u32 s54, s52, 64
buffer_load_dwordx4 v177, s[92:95], s54 offen lds
s_add_u32 m0, s53, 3072
s_add_u32 s54, s52, 16448
buffer_load_dwordx4 v177, s[92:95], s54 offen lds
s_add_u32 m0, s53, 4096
s_add_u32 s54, s52, 128
buffer_load_dwordx4 v177, s[92:95], s54 offen lds
s_add_u32 m0, s53, 5120
s_add_u32 s54, s52, 16512
buffer_load_dwordx4 v177, s[92:95], s54 offen lds
s_add_u32 m0, s53, 6144
s_add_u32 s54, s52, 192
buffer_load_dwordx4 v177, s[92:95], s54 offen lds
s_add_u32 m0, s53, 7168
s_add_u32 s54, s52, 16576
buffer_load_dwordx4 v177, s[92:95], s54 offen lds
s_mov_b32 s44, s20
s_mov_b32 s45, s21
s_mov_b32 s46, 4194304
s_mov_b32 s47, 0x20000
s_mov_b32 s48, s22
s_mov_b32 s49, s23
s_mov_b32 s50, 4194304
s_mov_b32 s51, 0x20000
s_mov_b32 s52, 0
buffer_load_dword v0, v181, s[44:47], s52 offen
s_mov_b32 s52, 8192
buffer_load_dword v1, v181, s[44:47], s52 offen
s_mov_b32 s52, 16384
buffer_load_dword v2, v181, s[44:47], s52 offen
s_mov_b32 s52, 24576
buffer_load_dword v3, v181, s[44:47], s52 offen
s_mov_b32 s52, 32768
buffer_load_dword v4, v181, s[44:47], s52 offen
s_mov_b32 s52, 40960
buffer_load_dword v5, v181, s[44:47], s52 offen
s_mov_b32 s52, 49152
buffer_load_dword v6, v181, s[44:47], s52 offen
s_mov_b32 s52, 57344
buffer_load_dword v7, v181, s[44:47], s52 offen
s_mov_b32 s52, 262144
buffer_load_dword v8, v181, s[44:47], s52 offen
s_mov_b32 s52, 270336
buffer_load_dword v9, v181, s[44:47], s52 offen
s_mov_b32 s52, 278528
buffer_load_dword v10, v181, s[44:47], s52 offen
s_mov_b32 s52, 286720
buffer_load_dword v11, v181, s[44:47], s52 offen
s_mov_b32 s52, 294912
buffer_load_dword v12, v181, s[44:47], s52 offen
s_mov_b32 s52, 303104
buffer_load_dword v13, v181, s[44:47], s52 offen
s_mov_b32 s52, 311296
buffer_load_dword v14, v181, s[44:47], s52 offen
s_mov_b32 s52, 319488
buffer_load_dword v15, v181, s[44:47], s52 offen
s_mov_b32 s52, 524288
buffer_load_dword v16, v181, s[44:47], s52 offen
s_mov_b32 s52, 532480
buffer_load_dword v17, v181, s[44:47], s52 offen
s_mov_b32 s52, 540672
buffer_load_dword v18, v181, s[44:47], s52 offen
s_mov_b32 s52, 548864
buffer_load_dword v19, v181, s[44:47], s52 offen
s_mov_b32 s52, 557056
buffer_load_dword v20, v181, s[44:47], s52 offen
s_mov_b32 s52, 565248
buffer_load_dword v21, v181, s[44:47], s52 offen
s_mov_b32 s52, 573440
buffer_load_dword v22, v181, s[44:47], s52 offen
s_mov_b32 s52, 581632
buffer_load_dword v23, v181, s[44:47], s52 offen
s_mov_b32 s52, 786432
buffer_load_dword v24, v181, s[44:47], s52 offen
s_mov_b32 s52, 794624
buffer_load_dword v25, v181, s[44:47], s52 offen
s_mov_b32 s52, 802816
buffer_load_dword v26, v181, s[44:47], s52 offen
s_mov_b32 s52, 811008
buffer_load_dword v27, v181, s[44:47], s52 offen
s_mov_b32 s52, 819200
buffer_load_dword v28, v181, s[44:47], s52 offen
s_mov_b32 s52, 827392
buffer_load_dword v29, v181, s[44:47], s52 offen
s_mov_b32 s52, 835584
buffer_load_dword v30, v181, s[44:47], s52 offen
s_mov_b32 s52, 843776
buffer_load_dword v31, v181, s[44:47], s52 offen
s_mov_b32 s52, 1048576
buffer_load_dword v32, v181, s[44:47], s52 offen
s_mov_b32 s52, 1056768
buffer_load_dword v33, v181, s[44:47], s52 offen
s_mov_b32 s52, 1064960
buffer_load_dword v34, v181, s[44:47], s52 offen
s_mov_b32 s52, 1073152
buffer_load_dword v35, v181, s[44:47], s52 offen
s_mov_b32 s52, 1081344
buffer_load_dword v36, v181, s[44:47], s52 offen
s_mov_b32 s52, 1089536
buffer_load_dword v37, v181, s[44:47], s52 offen
s_mov_b32 s52, 1097728
buffer_load_dword v38, v181, s[44:47], s52 offen
s_mov_b32 s52, 1105920
buffer_load_dword v39, v181, s[44:47], s52 offen
s_mov_b32 s52, 1310720
buffer_load_dword v40, v181, s[44:47], s52 offen
s_mov_b32 s52, 1318912
buffer_load_dword v41, v181, s[44:47], s52 offen
s_mov_b32 s52, 1327104
buffer_load_dword v42, v181, s[44:47], s52 offen
s_mov_b32 s52, 1335296
buffer_load_dword v43, v181, s[44:47], s52 offen
s_mov_b32 s52, 1343488
buffer_load_dword v44, v181, s[44:47], s52 offen
s_mov_b32 s52, 1351680
buffer_load_dword v45, v181, s[44:47], s52 offen
s_mov_b32 s52, 1359872
buffer_load_dword v46, v181, s[44:47], s52 offen
s_mov_b32 s52, 1368064
buffer_load_dword v47, v181, s[44:47], s52 offen
s_mov_b32 s52, 1572864
buffer_load_dword v48, v181, s[44:47], s52 offen
s_mov_b32 s52, 1581056
buffer_load_dword v49, v181, s[44:47], s52 offen
s_mov_b32 s52, 1589248
buffer_load_dword v50, v181, s[44:47], s52 offen
s_mov_b32 s52, 1597440
buffer_load_dword v51, v181, s[44:47], s52 offen
s_mov_b32 s52, 1605632
buffer_load_dword v52, v181, s[44:47], s52 offen
s_mov_b32 s52, 1613824
buffer_load_dword v53, v181, s[44:47], s52 offen
s_mov_b32 s52, 1622016
buffer_load_dword v54, v181, s[44:47], s52 offen
s_mov_b32 s52, 1630208
buffer_load_dword v55, v181, s[44:47], s52 offen
s_mov_b32 s52, 1835008
buffer_load_dword v56, v181, s[44:47], s52 offen
s_mov_b32 s52, 1843200
buffer_load_dword v57, v181, s[44:47], s52 offen
s_mov_b32 s52, 1851392
buffer_load_dword v58, v181, s[44:47], s52 offen
s_mov_b32 s52, 1859584
buffer_load_dword v59, v181, s[44:47], s52 offen
s_mov_b32 s52, 1867776
buffer_load_dword v60, v181, s[44:47], s52 offen
s_mov_b32 s52, 1875968
buffer_load_dword v61, v181, s[44:47], s52 offen
s_mov_b32 s52, 1884160
buffer_load_dword v62, v181, s[44:47], s52 offen
s_mov_b32 s52, 1892352
buffer_load_dword v63, v181, s[44:47], s52 offen
s_mov_b32 s52, 2097152
buffer_load_dword v64, v181, s[44:47], s52 offen
s_mov_b32 s52, 2105344
buffer_load_dword v65, v181, s[44:47], s52 offen
s_mov_b32 s52, 2113536
buffer_load_dword v66, v181, s[44:47], s52 offen
s_mov_b32 s52, 2121728
buffer_load_dword v67, v181, s[44:47], s52 offen
s_mov_b32 s52, 2129920
buffer_load_dword v68, v181, s[44:47], s52 offen
s_mov_b32 s52, 2138112
buffer_load_dword v69, v181, s[44:47], s52 offen
s_mov_b32 s52, 2146304
buffer_load_dword v70, v181, s[44:47], s52 offen
s_mov_b32 s52, 2154496
buffer_load_dword v71, v181, s[44:47], s52 offen
s_mov_b32 s52, 2359296
buffer_load_dword v72, v181, s[44:47], s52 offen
s_mov_b32 s52, 2367488
buffer_load_dword v73, v181, s[44:47], s52 offen
s_mov_b32 s52, 2375680
buffer_load_dword v74, v181, s[44:47], s52 offen
s_mov_b32 s52, 2383872
buffer_load_dword v75, v181, s[44:47], s52 offen
s_mov_b32 s52, 2392064
buffer_load_dword v76, v181, s[44:47], s52 offen
s_mov_b32 s52, 2400256
buffer_load_dword v77, v181, s[44:47], s52 offen
s_mov_b32 s52, 2408448
buffer_load_dword v78, v181, s[44:47], s52 offen
s_mov_b32 s52, 2416640
buffer_load_dword v79, v181, s[44:47], s52 offen
s_mov_b32 s52, 2621440
buffer_load_dword v80, v181, s[44:47], s52 offen
s_mov_b32 s52, 2629632
buffer_load_dword v81, v181, s[44:47], s52 offen
s_mov_b32 s52, 2637824
buffer_load_dword v82, v181, s[44:47], s52 offen
s_mov_b32 s52, 2646016
buffer_load_dword v83, v181, s[44:47], s52 offen
s_mov_b32 s52, 2654208
buffer_load_dword v84, v181, s[44:47], s52 offen
s_mov_b32 s52, 2662400
buffer_load_dword v85, v181, s[44:47], s52 offen
s_mov_b32 s52, 2670592
buffer_load_dword v86, v181, s[44:47], s52 offen
s_mov_b32 s52, 2678784
buffer_load_dword v87, v181, s[44:47], s52 offen
s_mov_b32 s52, 2883584
buffer_load_dword v88, v181, s[44:47], s52 offen
s_mov_b32 s52, 2891776
buffer_load_dword v89, v181, s[44:47], s52 offen
s_mov_b32 s52, 2899968
buffer_load_dword v90, v181, s[44:47], s52 offen
s_mov_b32 s52, 2908160
buffer_load_dword v91, v181, s[44:47], s52 offen
s_mov_b32 s52, 2916352
buffer_load_dword v92, v181, s[44:47], s52 offen
s_mov_b32 s52, 2924544
buffer_load_dword v93, v181, s[44:47], s52 offen
s_mov_b32 s52, 2932736
buffer_load_dword v94, v181, s[44:47], s52 offen
s_mov_b32 s52, 2940928
buffer_load_dword v95, v181, s[44:47], s52 offen
s_mov_b32 s52, 3145728
buffer_load_dword v96, v181, s[44:47], s52 offen
s_mov_b32 s52, 3153920
buffer_load_dword v97, v181, s[44:47], s52 offen
s_mov_b32 s52, 3162112
buffer_load_dword v98, v181, s[44:47], s52 offen
s_mov_b32 s52, 3170304
buffer_load_dword v99, v181, s[44:47], s52 offen
s_mov_b32 s52, 3178496
buffer_load_dword v100, v181, s[44:47], s52 offen
s_mov_b32 s52, 3186688
buffer_load_dword v101, v181, s[44:47], s52 offen
s_mov_b32 s52, 3194880
buffer_load_dword v102, v181, s[44:47], s52 offen
s_mov_b32 s52, 3203072
buffer_load_dword v103, v181, s[44:47], s52 offen
s_mov_b32 s52, 3407872
buffer_load_dword v104, v181, s[44:47], s52 offen
s_mov_b32 s52, 3416064
buffer_load_dword v105, v181, s[44:47], s52 offen
s_mov_b32 s52, 3424256
buffer_load_dword v106, v181, s[44:47], s52 offen
s_mov_b32 s52, 3432448
buffer_load_dword v107, v181, s[44:47], s52 offen
s_mov_b32 s52, 3440640
buffer_load_dword v108, v181, s[44:47], s52 offen
s_mov_b32 s52, 3448832
buffer_load_dword v109, v181, s[44:47], s52 offen
s_mov_b32 s52, 3457024
buffer_load_dword v110, v181, s[44:47], s52 offen
s_mov_b32 s52, 3465216
buffer_load_dword v111, v181, s[44:47], s52 offen
s_mov_b32 s52, 3670016
buffer_load_dword v112, v181, s[44:47], s52 offen
s_mov_b32 s52, 3678208
buffer_load_dword v113, v181, s[44:47], s52 offen
s_mov_b32 s52, 3686400
buffer_load_dword v114, v181, s[44:47], s52 offen
s_mov_b32 s52, 3694592
buffer_load_dword v115, v181, s[44:47], s52 offen
s_mov_b32 s52, 3702784
buffer_load_dword v116, v181, s[44:47], s52 offen
s_mov_b32 s52, 3710976
buffer_load_dword v117, v181, s[44:47], s52 offen
s_mov_b32 s52, 3719168
buffer_load_dword v118, v181, s[44:47], s52 offen
s_mov_b32 s52, 3727360
buffer_load_dword v119, v181, s[44:47], s52 offen
s_mov_b32 s52, 3932160
buffer_load_dword v120, v181, s[44:47], s52 offen
s_mov_b32 s52, 3940352
buffer_load_dword v121, v181, s[44:47], s52 offen
s_mov_b32 s52, 3948544
buffer_load_dword v122, v181, s[44:47], s52 offen
s_mov_b32 s52, 3956736
buffer_load_dword v123, v181, s[44:47], s52 offen
s_mov_b32 s52, 3964928
buffer_load_dword v124, v181, s[44:47], s52 offen
s_mov_b32 s52, 3973120
buffer_load_dword v125, v181, s[44:47], s52 offen
s_mov_b32 s52, 3981312
buffer_load_dword v126, v181, s[44:47], s52 offen
s_mov_b32 s52, 3989504
buffer_load_dword v127, v181, s[44:47], s52 offen
s_waitcnt vmcnt(63)
v_perm_b32 v183, v1, v0, s57
v_perm_b32 v184, v1, v0, s58
v_accvgpr_write_b32 a0, v183
v_accvgpr_write_b32 a4, v184
v_perm_b32 v183, v3, v2, s57
v_perm_b32 v184, v3, v2, s58
v_accvgpr_write_b32 a1, v183
v_accvgpr_write_b32 a5, v184
v_perm_b32 v183, v5, v4, s57
v_perm_b32 v184, v5, v4, s58
v_accvgpr_write_b32 a2, v183
v_accvgpr_write_b32 a6, v184
v_perm_b32 v183, v7, v6, s57
v_perm_b32 v184, v7, v6, s58
v_accvgpr_write_b32 a3, v183
v_accvgpr_write_b32 a7, v184
s_mov_b32 s52, 0
buffer_load_dword v0, v181, s[48:51], s52 offen
s_mov_b32 s52, 8192
buffer_load_dword v1, v181, s[48:51], s52 offen
s_mov_b32 s52, 16384
buffer_load_dword v2, v181, s[48:51], s52 offen
s_mov_b32 s52, 24576
buffer_load_dword v3, v181, s[48:51], s52 offen
s_mov_b32 s52, 32768
buffer_load_dword v4, v181, s[48:51], s52 offen
s_mov_b32 s52, 40960
buffer_load_dword v5, v181, s[48:51], s52 offen
s_mov_b32 s52, 49152
buffer_load_dword v6, v181, s[48:51], s52 offen
s_mov_b32 s52, 57344
buffer_load_dword v7, v181, s[48:51], s52 offen
v_perm_b32 v183, v9, v8, s57
v_perm_b32 v184, v9, v8, s58
v_accvgpr_write_b32 a8, v183
v_accvgpr_write_b32 a12, v184
v_perm_b32 v183, v11, v10, s57
v_perm_b32 v184, v11, v10, s58
v_accvgpr_write_b32 a9, v183
v_accvgpr_write_b32 a13, v184
v_perm_b32 v183, v13, v12, s57
v_perm_b32 v184, v13, v12, s58
v_accvgpr_write_b32 a10, v183
v_accvgpr_write_b32 a14, v184
v_perm_b32 v183, v15, v14, s57
v_perm_b32 v184, v15, v14, s58
v_accvgpr_write_b32 a11, v183
v_accvgpr_write_b32 a15, v184
s_mov_b32 s52, 262144
buffer_load_dword v8, v181, s[48:51], s52 offen
s_mov_b32 s52, 270336
buffer_load_dword v9, v181, s[48:51], s52 offen
s_mov_b32 s52, 278528
buffer_load_dword v10, v181, s[48:51], s52 offen
s_mov_b32 s52, 286720
buffer_load_dword v11, v181, s[48:51], s52 offen
s_mov_b32 s52, 294912
buffer_load_dword v12, v181, s[48:51], s52 offen
s_mov_b32 s52, 303104
buffer_load_dword v13, v181, s[48:51], s52 offen
s_mov_b32 s52, 311296
buffer_load_dword v14, v181, s[48:51], s52 offen
s_mov_b32 s52, 319488
buffer_load_dword v15, v181, s[48:51], s52 offen
v_perm_b32 v183, v17, v16, s57
v_perm_b32 v184, v17, v16, s58
v_accvgpr_write_b32 a16, v183
v_accvgpr_write_b32 a20, v184
v_perm_b32 v183, v19, v18, s57
v_perm_b32 v184, v19, v18, s58
v_accvgpr_write_b32 a17, v183
v_accvgpr_write_b32 a21, v184
v_perm_b32 v183, v21, v20, s57
v_perm_b32 v184, v21, v20, s58
v_accvgpr_write_b32 a18, v183
v_accvgpr_write_b32 a22, v184
v_perm_b32 v183, v23, v22, s57
v_perm_b32 v184, v23, v22, s58
v_accvgpr_write_b32 a19, v183
v_accvgpr_write_b32 a23, v184
s_mov_b32 s52, 524288
buffer_load_dword v16, v181, s[48:51], s52 offen
s_mov_b32 s52, 532480
buffer_load_dword v17, v181, s[48:51], s52 offen
s_mov_b32 s52, 540672
buffer_load_dword v18, v181, s[48:51], s52 offen
s_mov_b32 s52, 548864
buffer_load_dword v19, v181, s[48:51], s52 offen
s_mov_b32 s52, 557056
buffer_load_dword v20, v181, s[48:51], s52 offen
s_mov_b32 s52, 565248
buffer_load_dword v21, v181, s[48:51], s52 offen
s_mov_b32 s52, 573440
buffer_load_dword v22, v181, s[48:51], s52 offen
s_mov_b32 s52, 581632
buffer_load_dword v23, v181, s[48:51], s52 offen
v_perm_b32 v183, v25, v24, s57
v_perm_b32 v184, v25, v24, s58
v_accvgpr_write_b32 a24, v183
v_accvgpr_write_b32 a28, v184
v_perm_b32 v183, v27, v26, s57
v_perm_b32 v184, v27, v26, s58
v_accvgpr_write_b32 a25, v183
v_accvgpr_write_b32 a29, v184
v_perm_b32 v183, v29, v28, s57
v_perm_b32 v184, v29, v28, s58
v_accvgpr_write_b32 a26, v183
v_accvgpr_write_b32 a30, v184
v_perm_b32 v183, v31, v30, s57
v_perm_b32 v184, v31, v30, s58
v_accvgpr_write_b32 a27, v183
v_accvgpr_write_b32 a31, v184
s_mov_b32 s52, 786432
buffer_load_dword v24, v181, s[48:51], s52 offen
s_mov_b32 s52, 794624
buffer_load_dword v25, v181, s[48:51], s52 offen
s_mov_b32 s52, 802816
buffer_load_dword v26, v181, s[48:51], s52 offen
s_mov_b32 s52, 811008
buffer_load_dword v27, v181, s[48:51], s52 offen
s_mov_b32 s52, 819200
buffer_load_dword v28, v181, s[48:51], s52 offen
s_mov_b32 s52, 827392
buffer_load_dword v29, v181, s[48:51], s52 offen
s_mov_b32 s52, 835584
buffer_load_dword v30, v181, s[48:51], s52 offen
s_mov_b32 s52, 843776
buffer_load_dword v31, v181, s[48:51], s52 offen
v_perm_b32 v183, v33, v32, s57
v_perm_b32 v184, v33, v32, s58
v_accvgpr_write_b32 a32, v183
v_accvgpr_write_b32 a36, v184
v_perm_b32 v183, v35, v34, s57
v_perm_b32 v184, v35, v34, s58
v_accvgpr_write_b32 a33, v183
v_accvgpr_write_b32 a37, v184
v_perm_b32 v183, v37, v36, s57
v_perm_b32 v184, v37, v36, s58
v_accvgpr_write_b32 a34, v183
v_accvgpr_write_b32 a38, v184
v_perm_b32 v183, v39, v38, s57
v_perm_b32 v184, v39, v38, s58
v_accvgpr_write_b32 a35, v183
v_accvgpr_write_b32 a39, v184
s_mov_b32 s52, 1048576
buffer_load_dword v32, v181, s[48:51], s52 offen
s_mov_b32 s52, 1056768
buffer_load_dword v33, v181, s[48:51], s52 offen
s_mov_b32 s52, 1064960
buffer_load_dword v34, v181, s[48:51], s52 offen
s_mov_b32 s52, 1073152
buffer_load_dword v35, v181, s[48:51], s52 offen
s_mov_b32 s52, 1081344
buffer_load_dword v36, v181, s[48:51], s52 offen
s_mov_b32 s52, 1089536
buffer_load_dword v37, v181, s[48:51], s52 offen
s_mov_b32 s52, 1097728
buffer_load_dword v38, v181, s[48:51], s52 offen
s_mov_b32 s52, 1105920
buffer_load_dword v39, v181, s[48:51], s52 offen
v_perm_b32 v183, v41, v40, s57
v_perm_b32 v184, v41, v40, s58
v_accvgpr_write_b32 a40, v183
v_accvgpr_write_b32 a44, v184
v_perm_b32 v183, v43, v42, s57
v_perm_b32 v184, v43, v42, s58
v_accvgpr_write_b32 a41, v183
v_accvgpr_write_b32 a45, v184
v_perm_b32 v183, v45, v44, s57
v_perm_b32 v184, v45, v44, s58
v_accvgpr_write_b32 a42, v183
v_accvgpr_write_b32 a46, v184
v_perm_b32 v183, v47, v46, s57
v_perm_b32 v184, v47, v46, s58
v_accvgpr_write_b32 a43, v183
v_accvgpr_write_b32 a47, v184
s_mov_b32 s52, 1310720
buffer_load_dword v40, v181, s[48:51], s52 offen
s_mov_b32 s52, 1318912
buffer_load_dword v41, v181, s[48:51], s52 offen
s_mov_b32 s52, 1327104
buffer_load_dword v42, v181, s[48:51], s52 offen
s_mov_b32 s52, 1335296
buffer_load_dword v43, v181, s[48:51], s52 offen
s_mov_b32 s52, 1343488
buffer_load_dword v44, v181, s[48:51], s52 offen
s_mov_b32 s52, 1351680
buffer_load_dword v45, v181, s[48:51], s52 offen
s_mov_b32 s52, 1359872
buffer_load_dword v46, v181, s[48:51], s52 offen
s_mov_b32 s52, 1368064
buffer_load_dword v47, v181, s[48:51], s52 offen
v_perm_b32 v183, v49, v48, s57
v_perm_b32 v184, v49, v48, s58
v_accvgpr_write_b32 a48, v183
v_accvgpr_write_b32 a52, v184
v_perm_b32 v183, v51, v50, s57
v_perm_b32 v184, v51, v50, s58
v_accvgpr_write_b32 a49, v183
v_accvgpr_write_b32 a53, v184
v_perm_b32 v183, v53, v52, s57
v_perm_b32 v184, v53, v52, s58
v_accvgpr_write_b32 a50, v183
v_accvgpr_write_b32 a54, v184
v_perm_b32 v183, v55, v54, s57
v_perm_b32 v184, v55, v54, s58
v_accvgpr_write_b32 a51, v183
v_accvgpr_write_b32 a55, v184
s_mov_b32 s52, 1572864
buffer_load_dword v48, v181, s[48:51], s52 offen
s_mov_b32 s52, 1581056
buffer_load_dword v49, v181, s[48:51], s52 offen
s_mov_b32 s52, 1589248
buffer_load_dword v50, v181, s[48:51], s52 offen
s_mov_b32 s52, 1597440
buffer_load_dword v51, v181, s[48:51], s52 offen
s_mov_b32 s52, 1605632
buffer_load_dword v52, v181, s[48:51], s52 offen
s_mov_b32 s52, 1613824
buffer_load_dword v53, v181, s[48:51], s52 offen
s_mov_b32 s52, 1622016
buffer_load_dword v54, v181, s[48:51], s52 offen
s_mov_b32 s52, 1630208
buffer_load_dword v55, v181, s[48:51], s52 offen
v_perm_b32 v183, v57, v56, s57
v_perm_b32 v184, v57, v56, s58
v_accvgpr_write_b32 a56, v183
v_accvgpr_write_b32 a60, v184
v_perm_b32 v183, v59, v58, s57
v_perm_b32 v184, v59, v58, s58
v_accvgpr_write_b32 a57, v183
v_accvgpr_write_b32 a61, v184
v_perm_b32 v183, v61, v60, s57
v_perm_b32 v184, v61, v60, s58
v_accvgpr_write_b32 a58, v183
v_accvgpr_write_b32 a62, v184
v_perm_b32 v183, v63, v62, s57
v_perm_b32 v184, v63, v62, s58
v_accvgpr_write_b32 a59, v183
v_accvgpr_write_b32 a63, v184
s_mov_b32 s52, 1835008
buffer_load_dword v56, v181, s[48:51], s52 offen
s_mov_b32 s52, 1843200
buffer_load_dword v57, v181, s[48:51], s52 offen
s_mov_b32 s52, 1851392
buffer_load_dword v58, v181, s[48:51], s52 offen
s_mov_b32 s52, 1859584
buffer_load_dword v59, v181, s[48:51], s52 offen
s_mov_b32 s52, 1867776
buffer_load_dword v60, v181, s[48:51], s52 offen
s_mov_b32 s52, 1875968
buffer_load_dword v61, v181, s[48:51], s52 offen
s_mov_b32 s52, 1884160
buffer_load_dword v62, v181, s[48:51], s52 offen
s_mov_b32 s52, 1892352
buffer_load_dword v63, v181, s[48:51], s52 offen
s_waitcnt vmcnt(63)
v_perm_b32 v183, v65, v64, s57
v_perm_b32 v184, v65, v64, s58
v_accvgpr_write_b32 a64, v183
v_accvgpr_write_b32 a68, v184
v_perm_b32 v183, v67, v66, s57
v_perm_b32 v184, v67, v66, s58
v_accvgpr_write_b32 a65, v183
v_accvgpr_write_b32 a69, v184
v_perm_b32 v183, v69, v68, s57
v_perm_b32 v184, v69, v68, s58
v_accvgpr_write_b32 a66, v183
v_accvgpr_write_b32 a70, v184
v_perm_b32 v183, v71, v70, s57
v_perm_b32 v184, v71, v70, s58
v_accvgpr_write_b32 a67, v183
v_accvgpr_write_b32 a71, v184
s_mov_b32 s52, 2097152
buffer_load_dword v64, v181, s[48:51], s52 offen
s_mov_b32 s52, 2105344
buffer_load_dword v65, v181, s[48:51], s52 offen
s_mov_b32 s52, 2113536
buffer_load_dword v66, v181, s[48:51], s52 offen
s_mov_b32 s52, 2121728
buffer_load_dword v67, v181, s[48:51], s52 offen
s_mov_b32 s52, 2129920
buffer_load_dword v68, v181, s[48:51], s52 offen
s_mov_b32 s52, 2138112
buffer_load_dword v69, v181, s[48:51], s52 offen
s_mov_b32 s52, 2146304
buffer_load_dword v70, v181, s[48:51], s52 offen
s_mov_b32 s52, 2154496
buffer_load_dword v71, v181, s[48:51], s52 offen
v_perm_b32 v183, v73, v72, s57
v_perm_b32 v184, v73, v72, s58
v_accvgpr_write_b32 a72, v183
v_accvgpr_write_b32 a76, v184
v_perm_b32 v183, v75, v74, s57
v_perm_b32 v184, v75, v74, s58
v_accvgpr_write_b32 a73, v183
v_accvgpr_write_b32 a77, v184
v_perm_b32 v183, v77, v76, s57
v_perm_b32 v184, v77, v76, s58
v_accvgpr_write_b32 a74, v183
v_accvgpr_write_b32 a78, v184
v_perm_b32 v183, v79, v78, s57
v_perm_b32 v184, v79, v78, s58
v_accvgpr_write_b32 a75, v183
v_accvgpr_write_b32 a79, v184
s_mov_b32 s52, 2359296
buffer_load_dword v72, v181, s[48:51], s52 offen
s_mov_b32 s52, 2367488
buffer_load_dword v73, v181, s[48:51], s52 offen
s_mov_b32 s52, 2375680
buffer_load_dword v74, v181, s[48:51], s52 offen
s_mov_b32 s52, 2383872
buffer_load_dword v75, v181, s[48:51], s52 offen
s_mov_b32 s52, 2392064
buffer_load_dword v76, v181, s[48:51], s52 offen
s_mov_b32 s52, 2400256
buffer_load_dword v77, v181, s[48:51], s52 offen
s_mov_b32 s52, 2408448
buffer_load_dword v78, v181, s[48:51], s52 offen
s_mov_b32 s52, 2416640
buffer_load_dword v79, v181, s[48:51], s52 offen
v_perm_b32 v183, v81, v80, s57
v_perm_b32 v184, v81, v80, s58
v_accvgpr_write_b32 a80, v183
v_accvgpr_write_b32 a84, v184
v_perm_b32 v183, v83, v82, s57
v_perm_b32 v184, v83, v82, s58
v_accvgpr_write_b32 a81, v183
v_accvgpr_write_b32 a85, v184
v_perm_b32 v183, v85, v84, s57
v_perm_b32 v184, v85, v84, s58
v_accvgpr_write_b32 a82, v183
v_accvgpr_write_b32 a86, v184
v_perm_b32 v183, v87, v86, s57
v_perm_b32 v184, v87, v86, s58
v_accvgpr_write_b32 a83, v183
v_accvgpr_write_b32 a87, v184
s_mov_b32 s52, 2621440
buffer_load_dword v80, v181, s[48:51], s52 offen
s_mov_b32 s52, 2629632
buffer_load_dword v81, v181, s[48:51], s52 offen
s_mov_b32 s52, 2637824
buffer_load_dword v82, v181, s[48:51], s52 offen
s_mov_b32 s52, 2646016
buffer_load_dword v83, v181, s[48:51], s52 offen
s_mov_b32 s52, 2654208
buffer_load_dword v84, v181, s[48:51], s52 offen
s_mov_b32 s52, 2662400
buffer_load_dword v85, v181, s[48:51], s52 offen
s_mov_b32 s52, 2670592
buffer_load_dword v86, v181, s[48:51], s52 offen
s_mov_b32 s52, 2678784
buffer_load_dword v87, v181, s[48:51], s52 offen
v_perm_b32 v183, v89, v88, s57
v_perm_b32 v184, v89, v88, s58
v_accvgpr_write_b32 a88, v183
v_accvgpr_write_b32 a92, v184
v_perm_b32 v183, v91, v90, s57
v_perm_b32 v184, v91, v90, s58
v_accvgpr_write_b32 a89, v183
v_accvgpr_write_b32 a93, v184
v_perm_b32 v183, v93, v92, s57
v_perm_b32 v184, v93, v92, s58
v_accvgpr_write_b32 a90, v183
v_accvgpr_write_b32 a94, v184
v_perm_b32 v183, v95, v94, s57
v_perm_b32 v184, v95, v94, s58
v_accvgpr_write_b32 a91, v183
v_accvgpr_write_b32 a95, v184
s_mov_b32 s52, 2883584
buffer_load_dword v88, v181, s[48:51], s52 offen
s_mov_b32 s52, 2891776
buffer_load_dword v89, v181, s[48:51], s52 offen
s_mov_b32 s52, 2899968
buffer_load_dword v90, v181, s[48:51], s52 offen
s_mov_b32 s52, 2908160
buffer_load_dword v91, v181, s[48:51], s52 offen
s_mov_b32 s52, 2916352
buffer_load_dword v92, v181, s[48:51], s52 offen
s_mov_b32 s52, 2924544
buffer_load_dword v93, v181, s[48:51], s52 offen
s_mov_b32 s52, 2932736
buffer_load_dword v94, v181, s[48:51], s52 offen
s_mov_b32 s52, 2940928
buffer_load_dword v95, v181, s[48:51], s52 offen
v_perm_b32 v183, v97, v96, s57
v_perm_b32 v184, v97, v96, s58
v_accvgpr_write_b32 a96, v183
v_accvgpr_write_b32 a100, v184
v_perm_b32 v183, v99, v98, s57
v_perm_b32 v184, v99, v98, s58
v_accvgpr_write_b32 a97, v183
v_accvgpr_write_b32 a101, v184
v_perm_b32 v183, v101, v100, s57
v_perm_b32 v184, v101, v100, s58
v_accvgpr_write_b32 a98, v183
v_accvgpr_write_b32 a102, v184
v_perm_b32 v183, v103, v102, s57
v_perm_b32 v184, v103, v102, s58
v_accvgpr_write_b32 a99, v183
v_accvgpr_write_b32 a103, v184
s_mov_b32 s52, 3145728
buffer_load_dword v96, v181, s[48:51], s52 offen
s_mov_b32 s52, 3153920
buffer_load_dword v97, v181, s[48:51], s52 offen
s_mov_b32 s52, 3162112
buffer_load_dword v98, v181, s[48:51], s52 offen
s_mov_b32 s52, 3170304
buffer_load_dword v99, v181, s[48:51], s52 offen
s_mov_b32 s52, 3178496
buffer_load_dword v100, v181, s[48:51], s52 offen
s_mov_b32 s52, 3186688
buffer_load_dword v101, v181, s[48:51], s52 offen
s_mov_b32 s52, 3194880
buffer_load_dword v102, v181, s[48:51], s52 offen
s_mov_b32 s52, 3203072
buffer_load_dword v103, v181, s[48:51], s52 offen
v_perm_b32 v183, v105, v104, s57
v_perm_b32 v184, v105, v104, s58
v_accvgpr_write_b32 a104, v183
v_accvgpr_write_b32 a108, v184
v_perm_b32 v183, v107, v106, s57
v_perm_b32 v184, v107, v106, s58
v_accvgpr_write_b32 a105, v183
v_accvgpr_write_b32 a109, v184
v_perm_b32 v183, v109, v108, s57
v_perm_b32 v184, v109, v108, s58
v_accvgpr_write_b32 a106, v183
v_accvgpr_write_b32 a110, v184
v_perm_b32 v183, v111, v110, s57
v_perm_b32 v184, v111, v110, s58
v_accvgpr_write_b32 a107, v183
v_accvgpr_write_b32 a111, v184
s_mov_b32 s52, 3407872
buffer_load_dword v104, v181, s[48:51], s52 offen
s_mov_b32 s52, 3416064
buffer_load_dword v105, v181, s[48:51], s52 offen
s_mov_b32 s52, 3424256
buffer_load_dword v106, v181, s[48:51], s52 offen
s_mov_b32 s52, 3432448
buffer_load_dword v107, v181, s[48:51], s52 offen
s_mov_b32 s52, 3440640
buffer_load_dword v108, v181, s[48:51], s52 offen
s_mov_b32 s52, 3448832
buffer_load_dword v109, v181, s[48:51], s52 offen
s_mov_b32 s52, 3457024
buffer_load_dword v110, v181, s[48:51], s52 offen
s_mov_b32 s52, 3465216
buffer_load_dword v111, v181, s[48:51], s52 offen
v_perm_b32 v183, v113, v112, s57
v_perm_b32 v184, v113, v112, s58
v_accvgpr_write_b32 a112, v183
v_accvgpr_write_b32 a116, v184
v_perm_b32 v183, v115, v114, s57
v_perm_b32 v184, v115, v114, s58
v_accvgpr_write_b32 a113, v183
v_accvgpr_write_b32 a117, v184
v_perm_b32 v183, v117, v116, s57
v_perm_b32 v184, v117, v116, s58
v_accvgpr_write_b32 a114, v183
v_accvgpr_write_b32 a118, v184
v_perm_b32 v183, v119, v118, s57
v_perm_b32 v184, v119, v118, s58
v_accvgpr_write_b32 a115, v183
v_accvgpr_write_b32 a119, v184
s_mov_b32 s52, 3670016
buffer_load_dword v112, v181, s[48:51], s52 offen
s_mov_b32 s52, 3678208
buffer_load_dword v113, v181, s[48:51], s52 offen
s_mov_b32 s52, 3686400
buffer_load_dword v114, v181, s[48:51], s52 offen
s_mov_b32 s52, 3694592
buffer_load_dword v115, v181, s[48:51], s52 offen
s_mov_b32 s52, 3702784
buffer_load_dword v116, v181, s[48:51], s52 offen
s_mov_b32 s52, 3710976
buffer_load_dword v117, v181, s[48:51], s52 offen
s_mov_b32 s52, 3719168
buffer_load_dword v118, v181, s[48:51], s52 offen
s_mov_b32 s52, 3727360
buffer_load_dword v119, v181, s[48:51], s52 offen
v_perm_b32 v183, v121, v120, s57
v_perm_b32 v184, v121, v120, s58
v_accvgpr_write_b32 a120, v183
v_accvgpr_write_b32 a124, v184
v_perm_b32 v183, v123, v122, s57
v_perm_b32 v184, v123, v122, s58
v_accvgpr_write_b32 a121, v183
v_accvgpr_write_b32 a125, v184
v_perm_b32 v183, v125, v124, s57
v_perm_b32 v184, v125, v124, s58
v_accvgpr_write_b32 a122, v183
v_accvgpr_write_b32 a126, v184
v_perm_b32 v183, v127, v126, s57
v_perm_b32 v184, v127, v126, s58
v_accvgpr_write_b32 a123, v183
v_accvgpr_write_b32 a127, v184
s_mov_b32 s52, 3932160
buffer_load_dword v120, v181, s[48:51], s52 offen
s_mov_b32 s52, 3940352
buffer_load_dword v121, v181, s[48:51], s52 offen
s_mov_b32 s52, 3948544
buffer_load_dword v122, v181, s[48:51], s52 offen
s_mov_b32 s52, 3956736
buffer_load_dword v123, v181, s[48:51], s52 offen
s_mov_b32 s52, 3964928
buffer_load_dword v124, v181, s[48:51], s52 offen
s_mov_b32 s52, 3973120
buffer_load_dword v125, v181, s[48:51], s52 offen
s_mov_b32 s52, 3981312
buffer_load_dword v126, v181, s[48:51], s52 offen
s_mov_b32 s52, 3989504
buffer_load_dword v127, v181, s[48:51], s52 offen
s_cmp_eq_u32 s3, 3
s_cbranch_scc1 L_gatew
s_mov_b32 s44, s10
s_mov_b32 s45, s11
s_mov_b32 s46, 1572864
s_mov_b32 s47, 0x20000
s_waitcnt vmcnt(63)
v_perm_b32 v183, v1, v0, s57
v_perm_b32 v184, v1, v0, s58
v_accvgpr_write_b32 a128, v183
v_accvgpr_write_b32 a132, v184
v_perm_b32 v183, v3, v2, s57
v_perm_b32 v184, v3, v2, s58
v_accvgpr_write_b32 a129, v183
v_accvgpr_write_b32 a133, v184
v_perm_b32 v183, v5, v4, s57
v_perm_b32 v184, v5, v4, s58
v_accvgpr_write_b32 a130, v183
v_accvgpr_write_b32 a134, v184
v_perm_b32 v183, v7, v6, s57
v_perm_b32 v184, v7, v6, s58
v_accvgpr_write_b32 a131, v183
v_accvgpr_write_b32 a135, v184
s_mov_b32 s52, 0
buffer_load_ushort v0, v182, s[44:47], s52 offen
s_mov_b32 s52, 3072
buffer_load_ushort v1, v182, s[44:47], s52 offen
s_mov_b32 s52, 6144
buffer_load_ushort v2, v182, s[44:47], s52 offen
s_mov_b32 s52, 9216
buffer_load_ushort v3, v182, s[44:47], s52 offen
s_mov_b32 s52, 12288
buffer_load_ushort v4, v182, s[44:47], s52 offen
s_mov_b32 s52, 15360
buffer_load_ushort v5, v182, s[44:47], s52 offen
s_mov_b32 s52, 18432
buffer_load_ushort v6, v182, s[44:47], s52 offen
s_mov_b32 s52, 21504
buffer_load_ushort v7, v182, s[44:47], s52 offen
v_perm_b32 v183, v9, v8, s57
v_perm_b32 v184, v9, v8, s58
v_accvgpr_write_b32 a136, v183
v_accvgpr_write_b32 a140, v184
v_perm_b32 v183, v11, v10, s57
v_perm_b32 v184, v11, v10, s58
v_accvgpr_write_b32 a137, v183
v_accvgpr_write_b32 a141, v184
v_perm_b32 v183, v13, v12, s57
v_perm_b32 v184, v13, v12, s58
v_accvgpr_write_b32 a138, v183
v_accvgpr_write_b32 a142, v184
v_perm_b32 v183, v15, v14, s57
v_perm_b32 v184, v15, v14, s58
v_accvgpr_write_b32 a139, v183
v_accvgpr_write_b32 a143, v184
s_mov_b32 s52, 98304
buffer_load_ushort v8, v182, s[44:47], s52 offen
s_mov_b32 s52, 101376
buffer_load_ushort v9, v182, s[44:47], s52 offen
s_mov_b32 s52, 104448
buffer_load_ushort v10, v182, s[44:47], s52 offen
s_mov_b32 s52, 107520
buffer_load_ushort v11, v182, s[44:47], s52 offen
s_mov_b32 s52, 110592
buffer_load_ushort v12, v182, s[44:47], s52 offen
s_mov_b32 s52, 113664
buffer_load_ushort v13, v182, s[44:47], s52 offen
s_mov_b32 s52, 116736
buffer_load_ushort v14, v182, s[44:47], s52 offen
s_mov_b32 s52, 119808
buffer_load_ushort v15, v182, s[44:47], s52 offen
v_perm_b32 v183, v17, v16, s57
v_perm_b32 v184, v17, v16, s58
v_accvgpr_write_b32 a144, v183
v_accvgpr_write_b32 a148, v184
v_perm_b32 v183, v19, v18, s57
v_perm_b32 v184, v19, v18, s58
v_accvgpr_write_b32 a145, v183
v_accvgpr_write_b32 a149, v184
v_perm_b32 v183, v21, v20, s57
v_perm_b32 v184, v21, v20, s58
v_accvgpr_write_b32 a146, v183
v_accvgpr_write_b32 a150, v184
v_perm_b32 v183, v23, v22, s57
v_perm_b32 v184, v23, v22, s58
v_accvgpr_write_b32 a147, v183
v_accvgpr_write_b32 a151, v184
s_mov_b32 s52, 196608
buffer_load_ushort v16, v182, s[44:47], s52 offen
s_mov_b32 s52, 199680
buffer_load_ushort v17, v182, s[44:47], s52 offen
s_mov_b32 s52, 202752
buffer_load_ushort v18, v182, s[44:47], s52 offen
s_mov_b32 s52, 205824
buffer_load_ushort v19, v182, s[44:47], s52 offen
s_mov_b32 s52, 208896
buffer_load_ushort v20, v182, s[44:47], s52 offen
s_mov_b32 s52, 211968
buffer_load_ushort v21, v182, s[44:47], s52 offen
s_mov_b32 s52, 215040
buffer_load_ushort v22, v182, s[44:47], s52 offen
s_mov_b32 s52, 218112
buffer_load_ushort v23, v182, s[44:47], s52 offen
v_perm_b32 v183, v25, v24, s57
v_perm_b32 v184, v25, v24, s58
v_accvgpr_write_b32 a152, v183
v_accvgpr_write_b32 a156, v184
v_perm_b32 v183, v27, v26, s57
v_perm_b32 v184, v27, v26, s58
v_accvgpr_write_b32 a153, v183
v_accvgpr_write_b32 a157, v184
v_perm_b32 v183, v29, v28, s57
v_perm_b32 v184, v29, v28, s58
v_accvgpr_write_b32 a154, v183
v_accvgpr_write_b32 a158, v184
v_perm_b32 v183, v31, v30, s57
v_perm_b32 v184, v31, v30, s58
v_accvgpr_write_b32 a155, v183
v_accvgpr_write_b32 a159, v184
s_mov_b32 s52, 294912
buffer_load_ushort v24, v182, s[44:47], s52 offen
s_mov_b32 s52, 297984
buffer_load_ushort v25, v182, s[44:47], s52 offen
s_mov_b32 s52, 301056
buffer_load_ushort v26, v182, s[44:47], s52 offen
s_mov_b32 s52, 304128
buffer_load_ushort v27, v182, s[44:47], s52 offen
s_mov_b32 s52, 307200
buffer_load_ushort v28, v182, s[44:47], s52 offen
s_mov_b32 s52, 310272
buffer_load_ushort v29, v182, s[44:47], s52 offen
s_mov_b32 s52, 313344
buffer_load_ushort v30, v182, s[44:47], s52 offen
s_mov_b32 s52, 316416
buffer_load_ushort v31, v182, s[44:47], s52 offen
v_perm_b32 v183, v33, v32, s57
v_perm_b32 v184, v33, v32, s58
v_accvgpr_write_b32 a160, v183
v_accvgpr_write_b32 a164, v184
v_perm_b32 v183, v35, v34, s57
v_perm_b32 v184, v35, v34, s58
v_accvgpr_write_b32 a161, v183
v_accvgpr_write_b32 a165, v184
v_perm_b32 v183, v37, v36, s57
v_perm_b32 v184, v37, v36, s58
v_accvgpr_write_b32 a162, v183
v_accvgpr_write_b32 a166, v184
v_perm_b32 v183, v39, v38, s57
v_perm_b32 v184, v39, v38, s58
v_accvgpr_write_b32 a163, v183
v_accvgpr_write_b32 a167, v184
s_mov_b32 s52, 393216
buffer_load_ushort v32, v182, s[44:47], s52 offen
s_mov_b32 s52, 396288
buffer_load_ushort v33, v182, s[44:47], s52 offen
s_mov_b32 s52, 399360
buffer_load_ushort v34, v182, s[44:47], s52 offen
s_mov_b32 s52, 402432
buffer_load_ushort v35, v182, s[44:47], s52 offen
s_mov_b32 s52, 405504
buffer_load_ushort v36, v182, s[44:47], s52 offen
s_mov_b32 s52, 408576
buffer_load_ushort v37, v182, s[44:47], s52 offen
s_mov_b32 s52, 411648
buffer_load_ushort v38, v182, s[44:47], s52 offen
s_mov_b32 s52, 414720
buffer_load_ushort v39, v182, s[44:47], s52 offen
v_perm_b32 v183, v41, v40, s57
v_perm_b32 v184, v41, v40, s58
v_accvgpr_write_b32 a168, v183
v_accvgpr_write_b32 a172, v184
v_perm_b32 v183, v43, v42, s57
v_perm_b32 v184, v43, v42, s58
v_accvgpr_write_b32 a169, v183
v_accvgpr_write_b32 a173, v184
v_perm_b32 v183, v45, v44, s57
v_perm_b32 v184, v45, v44, s58
v_accvgpr_write_b32 a170, v183
v_accvgpr_write_b32 a174, v184
v_perm_b32 v183, v47, v46, s57
v_perm_b32 v184, v47, v46, s58
v_accvgpr_write_b32 a171, v183
v_accvgpr_write_b32 a175, v184
s_mov_b32 s52, 491520
buffer_load_ushort v40, v182, s[44:47], s52 offen
s_mov_b32 s52, 494592
buffer_load_ushort v41, v182, s[44:47], s52 offen
s_mov_b32 s52, 497664
buffer_load_ushort v42, v182, s[44:47], s52 offen
s_mov_b32 s52, 500736
buffer_load_ushort v43, v182, s[44:47], s52 offen
s_mov_b32 s52, 503808
buffer_load_ushort v44, v182, s[44:47], s52 offen
s_mov_b32 s52, 506880
buffer_load_ushort v45, v182, s[44:47], s52 offen
s_mov_b32 s52, 509952
buffer_load_ushort v46, v182, s[44:47], s52 offen
s_mov_b32 s52, 513024
buffer_load_ushort v47, v182, s[44:47], s52 offen
v_perm_b32 v183, v49, v48, s57
v_perm_b32 v184, v49, v48, s58
v_accvgpr_write_b32 a176, v183
v_accvgpr_write_b32 a180, v184
v_perm_b32 v183, v51, v50, s57
v_perm_b32 v184, v51, v50, s58
v_accvgpr_write_b32 a177, v183
v_accvgpr_write_b32 a181, v184
v_perm_b32 v183, v53, v52, s57
v_perm_b32 v184, v53, v52, s58
v_accvgpr_write_b32 a178, v183
v_accvgpr_write_b32 a182, v184
v_perm_b32 v183, v55, v54, s57
v_perm_b32 v184, v55, v54, s58
v_accvgpr_write_b32 a179, v183
v_accvgpr_write_b32 a183, v184
s_mov_b32 s52, 589824
buffer_load_ushort v48, v182, s[44:47], s52 offen
s_mov_b32 s52, 592896
buffer_load_ushort v49, v182, s[44:47], s52 offen
s_mov_b32 s52, 595968
buffer_load_ushort v50, v182, s[44:47], s52 offen
s_mov_b32 s52, 599040
buffer_load_ushort v51, v182, s[44:47], s52 offen
s_mov_b32 s52, 602112
buffer_load_ushort v52, v182, s[44:47], s52 offen
s_mov_b32 s52, 605184
buffer_load_ushort v53, v182, s[44:47], s52 offen
s_mov_b32 s52, 608256
buffer_load_ushort v54, v182, s[44:47], s52 offen
s_mov_b32 s52, 611328
buffer_load_ushort v55, v182, s[44:47], s52 offen
v_perm_b32 v183, v57, v56, s57
v_perm_b32 v184, v57, v56, s58
v_accvgpr_write_b32 a184, v183
v_accvgpr_write_b32 a188, v184
v_perm_b32 v183, v59, v58, s57
v_perm_b32 v184, v59, v58, s58
v_accvgpr_write_b32 a185, v183
v_accvgpr_write_b32 a189, v184
v_perm_b32 v183, v61, v60, s57
v_perm_b32 v184, v61, v60, s58
v_accvgpr_write_b32 a186, v183
v_accvgpr_write_b32 a190, v184
v_perm_b32 v183, v63, v62, s57
v_perm_b32 v184, v63, v62, s58
v_accvgpr_write_b32 a187, v183
v_accvgpr_write_b32 a191, v184
s_mov_b32 s52, 688128
buffer_load_ushort v56, v182, s[44:47], s52 offen
s_mov_b32 s52, 691200
buffer_load_ushort v57, v182, s[44:47], s52 offen
s_mov_b32 s52, 694272
buffer_load_ushort v58, v182, s[44:47], s52 offen
s_mov_b32 s52, 697344
buffer_load_ushort v59, v182, s[44:47], s52 offen
s_mov_b32 s52, 700416
buffer_load_ushort v60, v182, s[44:47], s52 offen
s_mov_b32 s52, 703488
buffer_load_ushort v61, v182, s[44:47], s52 offen
s_mov_b32 s52, 706560
buffer_load_ushort v62, v182, s[44:47], s52 offen
s_mov_b32 s52, 709632
buffer_load_ushort v63, v182, s[44:47], s52 offen
s_waitcnt vmcnt(63)
v_perm_b32 v183, v65, v64, s57
v_perm_b32 v184, v65, v64, s58
v_accvgpr_write_b32 a192, v183
v_accvgpr_write_b32 a196, v184
v_perm_b32 v183, v67, v66, s57
v_perm_b32 v184, v67, v66, s58
v_accvgpr_write_b32 a193, v183
v_accvgpr_write_b32 a197, v184
v_perm_b32 v183, v69, v68, s57
v_perm_b32 v184, v69, v68, s58
v_accvgpr_write_b32 a194, v183
v_accvgpr_write_b32 a198, v184
v_perm_b32 v183, v71, v70, s57
v_perm_b32 v184, v71, v70, s58
v_accvgpr_write_b32 a195, v183
v_accvgpr_write_b32 a199, v184
s_mov_b32 s52, 786432
buffer_load_ushort v64, v182, s[44:47], s52 offen
s_mov_b32 s52, 789504
buffer_load_ushort v65, v182, s[44:47], s52 offen
s_mov_b32 s52, 792576
buffer_load_ushort v66, v182, s[44:47], s52 offen
s_mov_b32 s52, 795648
buffer_load_ushort v67, v182, s[44:47], s52 offen
s_mov_b32 s52, 798720
buffer_load_ushort v68, v182, s[44:47], s52 offen
s_mov_b32 s52, 801792
buffer_load_ushort v69, v182, s[44:47], s52 offen
s_mov_b32 s52, 804864
buffer_load_ushort v70, v182, s[44:47], s52 offen
s_mov_b32 s52, 807936
buffer_load_ushort v71, v182, s[44:47], s52 offen
v_perm_b32 v183, v73, v72, s57
v_perm_b32 v184, v73, v72, s58
v_accvgpr_write_b32 a200, v183
v_accvgpr_write_b32 a204, v184
v_perm_b32 v183, v75, v74, s57
v_perm_b32 v184, v75, v74, s58
v_accvgpr_write_b32 a201, v183
v_accvgpr_write_b32 a205, v184
v_perm_b32 v183, v77, v76, s57
v_perm_b32 v184, v77, v76, s58
v_accvgpr_write_b32 a202, v183
v_accvgpr_write_b32 a206, v184
v_perm_b32 v183, v79, v78, s57
v_perm_b32 v184, v79, v78, s58
v_accvgpr_write_b32 a203, v183
v_accvgpr_write_b32 a207, v184
s_mov_b32 s52, 884736
buffer_load_ushort v72, v182, s[44:47], s52 offen
s_mov_b32 s52, 887808
buffer_load_ushort v73, v182, s[44:47], s52 offen
s_mov_b32 s52, 890880
buffer_load_ushort v74, v182, s[44:47], s52 offen
s_mov_b32 s52, 893952
buffer_load_ushort v75, v182, s[44:47], s52 offen
s_mov_b32 s52, 897024
buffer_load_ushort v76, v182, s[44:47], s52 offen
s_mov_b32 s52, 900096
buffer_load_ushort v77, v182, s[44:47], s52 offen
s_mov_b32 s52, 903168
buffer_load_ushort v78, v182, s[44:47], s52 offen
s_mov_b32 s52, 906240
buffer_load_ushort v79, v182, s[44:47], s52 offen
v_perm_b32 v183, v81, v80, s57
v_perm_b32 v184, v81, v80, s58
v_accvgpr_write_b32 a208, v183
v_accvgpr_write_b32 a212, v184
v_perm_b32 v183, v83, v82, s57
v_perm_b32 v184, v83, v82, s58
v_accvgpr_write_b32 a209, v183
v_accvgpr_write_b32 a213, v184
v_perm_b32 v183, v85, v84, s57
v_perm_b32 v184, v85, v84, s58
v_accvgpr_write_b32 a210, v183
v_accvgpr_write_b32 a214, v184
v_perm_b32 v183, v87, v86, s57
v_perm_b32 v184, v87, v86, s58
v_accvgpr_write_b32 a211, v183
v_accvgpr_write_b32 a215, v184
s_mov_b32 s52, 983040
buffer_load_ushort v80, v182, s[44:47], s52 offen
s_mov_b32 s52, 986112
buffer_load_ushort v81, v182, s[44:47], s52 offen
s_mov_b32 s52, 989184
buffer_load_ushort v82, v182, s[44:47], s52 offen
s_mov_b32 s52, 992256
buffer_load_ushort v83, v182, s[44:47], s52 offen
s_mov_b32 s52, 995328
buffer_load_ushort v84, v182, s[44:47], s52 offen
s_mov_b32 s52, 998400
buffer_load_ushort v85, v182, s[44:47], s52 offen
s_mov_b32 s52, 1001472
buffer_load_ushort v86, v182, s[44:47], s52 offen
s_mov_b32 s52, 1004544
buffer_load_ushort v87, v182, s[44:47], s52 offen
v_perm_b32 v183, v89, v88, s57
v_perm_b32 v184, v89, v88, s58
v_accvgpr_write_b32 a216, v183
v_accvgpr_write_b32 a220, v184
v_perm_b32 v183, v91, v90, s57
v_perm_b32 v184, v91, v90, s58
v_accvgpr_write_b32 a217, v183
v_accvgpr_write_b32 a221, v184
v_perm_b32 v183, v93, v92, s57
v_perm_b32 v184, v93, v92, s58
v_accvgpr_write_b32 a218, v183
v_accvgpr_write_b32 a222, v184
v_perm_b32 v183, v95, v94, s57
v_perm_b32 v184, v95, v94, s58
v_accvgpr_write_b32 a219, v183
v_accvgpr_write_b32 a223, v184
s_mov_b32 s52, 1081344
buffer_load_ushort v88, v182, s[44:47], s52 offen
s_mov_b32 s52, 1084416
buffer_load_ushort v89, v182, s[44:47], s52 offen
s_mov_b32 s52, 1087488
buffer_load_ushort v90, v182, s[44:47], s52 offen
s_mov_b32 s52, 1090560
buffer_load_ushort v91, v182, s[44:47], s52 offen
s_mov_b32 s52, 1093632
buffer_load_ushort v92, v182, s[44:47], s52 offen
s_mov_b32 s52, 1096704
buffer_load_ushort v93, v182, s[44:47], s52 offen
s_mov_b32 s52, 1099776
buffer_load_ushort v94, v182, s[44:47], s52 offen
s_mov_b32 s52, 1102848
buffer_load_ushort v95, v182, s[44:47], s52 offen
v_perm_b32 v183, v97, v96, s57
v_perm_b32 v184, v97, v96, s58
v_accvgpr_write_b32 a224, v183
v_accvgpr_write_b32 a228, v184
v_perm_b32 v183, v99, v98, s57
v_perm_b32 v184, v99, v98, s58
v_accvgpr_write_b32 a225, v183
v_accvgpr_write_b32 a229, v184
v_perm_b32 v183, v101, v100, s57
v_perm_b32 v184, v101, v100, s58
v_accvgpr_write_b32 a226, v183
v_accvgpr_write_b32 a230, v184
v_perm_b32 v183, v103, v102, s57
v_perm_b32 v184, v103, v102, s58
v_accvgpr_write_b32 a227, v183
v_accvgpr_write_b32 a231, v184
s_mov_b32 s52, 1179648
buffer_load_ushort v96, v182, s[44:47], s52 offen
s_mov_b32 s52, 1182720
buffer_load_ushort v97, v182, s[44:47], s52 offen
s_mov_b32 s52, 1185792
buffer_load_ushort v98, v182, s[44:47], s52 offen
s_mov_b32 s52, 1188864
buffer_load_ushort v99, v182, s[44:47], s52 offen
s_mov_b32 s52, 1191936
buffer_load_ushort v100, v182, s[44:47], s52 offen
s_mov_b32 s52, 1195008
buffer_load_ushort v101, v182, s[44:47], s52 offen
s_mov_b32 s52, 1198080
buffer_load_ushort v102, v182, s[44:47], s52 offen
s_mov_b32 s52, 1201152
buffer_load_ushort v103, v182, s[44:47], s52 offen
v_perm_b32 v183, v105, v104, s57
v_perm_b32 v184, v105, v104, s58
v_accvgpr_write_b32 a232, v183
v_accvgpr_write_b32 a236, v184
v_perm_b32 v183, v107, v106, s57
v_perm_b32 v184, v107, v106, s58
v_accvgpr_write_b32 a233, v183
v_accvgpr_write_b32 a237, v184
v_perm_b32 v183, v109, v108, s57
v_perm_b32 v184, v109, v108, s58
v_accvgpr_write_b32 a234, v183
v_accvgpr_write_b32 a238, v184
v_perm_b32 v183, v111, v110, s57
v_perm_b32 v184, v111, v110, s58
v_accvgpr_write_b32 a235, v183
v_accvgpr_write_b32 a239, v184
s_mov_b32 s52, 1277952
buffer_load_ushort v104, v182, s[44:47], s52 offen
s_mov_b32 s52, 1281024
buffer_load_ushort v105, v182, s[44:47], s52 offen
s_mov_b32 s52, 1284096
buffer_load_ushort v106, v182, s[44:47], s52 offen
s_mov_b32 s52, 1287168
buffer_load_ushort v107, v182, s[44:47], s52 offen
s_mov_b32 s52, 1290240
buffer_load_ushort v108, v182, s[44:47], s52 offen
s_mov_b32 s52, 1293312
buffer_load_ushort v109, v182, s[44:47], s52 offen
s_mov_b32 s52, 1296384
buffer_load_ushort v110, v182, s[44:47], s52 offen
s_mov_b32 s52, 1299456
buffer_load_ushort v111, v182, s[44:47], s52 offen
v_perm_b32 v183, v113, v112, s57
v_perm_b32 v184, v113, v112, s58
v_accvgpr_write_b32 a240, v183
v_accvgpr_write_b32 a244, v184
v_perm_b32 v183, v115, v114, s57
v_perm_b32 v184, v115, v114, s58
v_accvgpr_write_b32 a241, v183
v_accvgpr_write_b32 a245, v184
v_perm_b32 v183, v117, v116, s57
v_perm_b32 v184, v117, v116, s58
v_accvgpr_write_b32 a242, v183
v_accvgpr_write_b32 a246, v184
v_perm_b32 v183, v119, v118, s57
v_perm_b32 v184, v119, v118, s58
v_accvgpr_write_b32 a243, v183
v_accvgpr_write_b32 a247, v184
s_mov_b32 s52, 1376256
buffer_load_ushort v112, v182, s[44:47], s52 offen
s_mov_b32 s52, 1379328
buffer_load_ushort v113, v182, s[44:47], s52 offen
s_mov_b32 s52, 1382400
buffer_load_ushort v114, v182, s[44:47], s52 offen
s_mov_b32 s52, 1385472
buffer_load_ushort v115, v182, s[44:47], s52 offen
s_mov_b32 s52, 1388544
buffer_load_ushort v116, v182, s[44:47], s52 offen
s_mov_b32 s52, 1391616
buffer_load_ushort v117, v182, s[44:47], s52 offen
s_mov_b32 s52, 1394688
buffer_load_ushort v118, v182, s[44:47], s52 offen
s_mov_b32 s52, 1397760
buffer_load_ushort v119, v182, s[44:47], s52 offen
v_perm_b32 v183, v121, v120, s57
v_perm_b32 v184, v121, v120, s58
v_accvgpr_write_b32 a248, v183
v_accvgpr_write_b32 a252, v184
v_perm_b32 v183, v123, v122, s57
v_perm_b32 v184, v123, v122, s58
v_accvgpr_write_b32 a249, v183
v_accvgpr_write_b32 a253, v184
v_perm_b32 v183, v125, v124, s57
v_perm_b32 v184, v125, v124, s58
v_accvgpr_write_b32 a250, v183
v_accvgpr_write_b32 a254, v184
v_perm_b32 v183, v127, v126, s57
v_perm_b32 v184, v127, v126, s58
v_accvgpr_write_b32 a251, v183
v_accvgpr_write_b32 a255, v184
s_mov_b32 s52, 1474560
buffer_load_ushort v120, v182, s[44:47], s52 offen
s_mov_b32 s52, 1477632
buffer_load_ushort v121, v182, s[44:47], s52 offen
s_mov_b32 s52, 1480704
buffer_load_ushort v122, v182, s[44:47], s52 offen
s_mov_b32 s52, 1483776
buffer_load_ushort v123, v182, s[44:47], s52 offen
s_mov_b32 s52, 1486848
buffer_load_ushort v124, v182, s[44:47], s52 offen
s_mov_b32 s52, 1489920
buffer_load_ushort v125, v182, s[44:47], s52 offen
s_mov_b32 s52, 1492992
buffer_load_ushort v126, v182, s[44:47], s52 offen
s_mov_b32 s52, 1496064
buffer_load_ushort v127, v182, s[44:47], s52 offen
buffer_load_dword v185, off, s[40:43], 0 offset:192 sc0 sc1
s_waitcnt vmcnt(63)
v_lshl_or_b32 v192, v1, 16, v0
v_lshl_or_b32 v193, v3, 16, v2
v_lshl_or_b32 v194, v5, 16, v4
v_lshl_or_b32 v195, v7, 16, v6
v_lshl_or_b32 v196, v9, 16, v8
v_lshl_or_b32 v197, v11, 16, v10
v_lshl_or_b32 v198, v13, 16, v12
v_lshl_or_b32 v199, v15, 16, v14
v_lshl_or_b32 v200, v17, 16, v16
v_lshl_or_b32 v201, v19, 16, v18
v_lshl_or_b32 v202, v21, 16, v20
v_lshl_or_b32 v203, v23, 16, v22
v_lshl_or_b32 v204, v25, 16, v24
v_lshl_or_b32 v205, v27, 16, v26
v_lshl_or_b32 v206, v29, 16, v28
v_lshl_or_b32 v207, v31, 16, v30
v_lshl_or_b32 v208, v33, 16, v32
v_lshl_or_b32 v209, v35, 16, v34
v_lshl_or_b32 v210, v37, 16, v36
v_lshl_or_b32 v211, v39, 16, v38
v_lshl_or_b32 v212, v41, 16, v40
v_lshl_or_b32 v213, v43, 16, v42
v_lshl_or_b32 v214, v45, 16, v44
v_lshl_or_b32 v215, v47, 16, v46
v_lshl_or_b32 v216, v49, 16, v48
v_lshl_or_b32 v217, v51, 16, v50
v_lshl_or_b32 v218, v53, 16, v52
v_lshl_or_b32 v219, v55, 16, v54
v_lshl_or_b32 v220, v57, 16, v56
v_lshl_or_b32 v221, v59, 16, v58
v_lshl_or_b32 v222, v61, 16, v60
v_lshl_or_b32 v223, v63, 16, v62
s_waitcnt vmcnt(57)
v_lshl_or_b32 v224, v65, 16, v64
v_lshl_or_b32 v225, v67, 16, v66
v_lshl_or_b32 v226, v69, 16, v68
v_lshl_or_b32 v227, v71, 16, v70
s_waitcnt vmcnt(49)
v_lshl_or_b32 v228, v73, 16, v72
v_lshl_or_b32 v229, v75, 16, v74
v_lshl_or_b32 v230, v77, 16, v76
v_lshl_or_b32 v231, v79, 16, v78
s_waitcnt vmcnt(41)
v_lshl_or_b32 v232, v81, 16, v80
v_lshl_or_b32 v233, v83, 16, v82
v_lshl_or_b32 v234, v85, 16, v84
v_lshl_or_b32 v235, v87, 16, v86
s_waitcnt vmcnt(33)
v_lshl_or_b32 v236, v89, 16, v88
v_lshl_or_b32 v237, v91, 16, v90
v_lshl_or_b32 v238, v93, 16, v92
v_lshl_or_b32 v239, v95, 16, v94
s_waitcnt vmcnt(25)
v_lshl_or_b32 v240, v97, 16, v96
v_lshl_or_b32 v241, v99, 16, v98
v_lshl_or_b32 v242, v101, 16, v100
v_lshl_or_b32 v243, v103, 16, v102
s_waitcnt vmcnt(17)
v_lshl_or_b32 v244, v105, 16, v104
v_lshl_or_b32 v245, v107, 16, v106
v_lshl_or_b32 v246, v109, 16, v108
v_lshl_or_b32 v247, v111, 16, v110
s_waitcnt vmcnt(9)
v_lshl_or_b32 v248, v113, 16, v112
v_lshl_or_b32 v249, v115, 16, v114
v_lshl_or_b32 v250, v117, 16, v116
v_lshl_or_b32 v251, v119, 16, v118
s_waitcnt vmcnt(1)
v_lshl_or_b32 v252, v121, 16, v120
v_lshl_or_b32 v253, v123, 16, v122
v_lshl_or_b32 v254, v125, 16, v124
v_lshl_or_b32 v255, v127, 16, v126
s_branch L_gatew_done
L_gatew:
s_mov_b32 s44, s28
s_mov_b32 s45, s29
s_mov_b32 s46, 1024
s_mov_b32 s47, 0x20000
s_waitcnt vmcnt(63)
v_perm_b32 v183, v1, v0, s57
v_perm_b32 v184, v1, v0, s58
v_accvgpr_write_b32 a128, v183
v_accvgpr_write_b32 a132, v184
v_perm_b32 v183, v3, v2, s57
v_perm_b32 v184, v3, v2, s58
v_accvgpr_write_b32 a129, v183
v_accvgpr_write_b32 a133, v184
v_perm_b32 v183, v5, v4, s57
v_perm_b32 v184, v5, v4, s58
v_accvgpr_write_b32 a130, v183
v_accvgpr_write_b32 a134, v184
v_perm_b32 v183, v7, v6, s57
v_perm_b32 v184, v7, v6, s58
v_accvgpr_write_b32 a131, v183
v_accvgpr_write_b32 a135, v184
v_lshrrev_b32 v1, 4, v191
v_lshlrev_b32 v1, 4, v1
buffer_load_dwordx4 v[192:195], v1, s[44:47], 0 offen offset:0
buffer_load_dwordx4 v[196:199], v1, s[44:47], 0 offen offset:64
buffer_load_dwordx4 v[200:203], v1, s[44:47], 0 offen offset:128
buffer_load_dwordx4 v[204:207], v1, s[44:47], 0 offen offset:192
buffer_load_dwordx4 v[208:211], v1, s[44:47], 0 offen offset:256
buffer_load_dwordx4 v[212:215], v1, s[44:47], 0 offen offset:320
buffer_load_dwordx4 v[216:219], v1, s[44:47], 0 offen offset:384
buffer_load_dwordx4 v[220:223], v1, s[44:47], 0 offen offset:448
buffer_load_dwordx4 v[224:227], v1, s[44:47], 0 offen offset:512
buffer_load_dwordx4 v[228:231], v1, s[44:47], 0 offen offset:576
buffer_load_dwordx4 v[232:235], v1, s[44:47], 0 offen offset:640
buffer_load_dwordx4 v[236:239], v1, s[44:47], 0 offen offset:704
buffer_load_dwordx4 v[240:243], v1, s[44:47], 0 offen offset:768
buffer_load_dwordx4 v[244:247], v1, s[44:47], 0 offen offset:832
buffer_load_dwordx4 v[248:251], v1, s[44:47], 0 offen offset:896
buffer_load_dwordx4 v[252:255], v1, s[44:47], 0 offen offset:960
v_perm_b32 v183, v9, v8, s57
v_perm_b32 v184, v9, v8, s58
v_accvgpr_write_b32 a136, v183
v_accvgpr_write_b32 a140, v184
v_perm_b32 v183, v11, v10, s57
v_perm_b32 v184, v11, v10, s58
v_accvgpr_write_b32 a137, v183
v_accvgpr_write_b32 a141, v184
v_perm_b32 v183, v13, v12, s57
v_perm_b32 v184, v13, v12, s58
v_accvgpr_write_b32 a138, v183
v_accvgpr_write_b32 a142, v184
v_perm_b32 v183, v15, v14, s57
v_perm_b32 v184, v15, v14, s58
v_accvgpr_write_b32 a139, v183
v_accvgpr_write_b32 a143, v184
v_perm_b32 v183, v17, v16, s57
v_perm_b32 v184, v17, v16, s58
v_accvgpr_write_b32 a144, v183
v_accvgpr_write_b32 a148, v184
v_perm_b32 v183, v19, v18, s57
v_perm_b32 v184, v19, v18, s58
v_accvgpr_write_b32 a145, v183
v_accvgpr_write_b32 a149, v184
v_perm_b32 v183, v21, v20, s57
v_perm_b32 v184, v21, v20, s58
v_accvgpr_write_b32 a146, v183
v_accvgpr_write_b32 a150, v184
v_perm_b32 v183, v23, v22, s57
v_perm_b32 v184, v23, v22, s58
v_accvgpr_write_b32 a147, v183
v_accvgpr_write_b32 a151, v184
v_perm_b32 v183, v25, v24, s57
v_perm_b32 v184, v25, v24, s58
v_accvgpr_write_b32 a152, v183
v_accvgpr_write_b32 a156, v184
v_perm_b32 v183, v27, v26, s57
v_perm_b32 v184, v27, v26, s58
v_accvgpr_write_b32 a153, v183
v_accvgpr_write_b32 a157, v184
v_perm_b32 v183, v29, v28, s57
v_perm_b32 v184, v29, v28, s58
v_accvgpr_write_b32 a154, v183
v_accvgpr_write_b32 a158, v184
v_perm_b32 v183, v31, v30, s57
v_perm_b32 v184, v31, v30, s58
v_accvgpr_write_b32 a155, v183
v_accvgpr_write_b32 a159, v184
v_perm_b32 v183, v33, v32, s57
v_perm_b32 v184, v33, v32, s58
v_accvgpr_write_b32 a160, v183
v_accvgpr_write_b32 a164, v184
v_perm_b32 v183, v35, v34, s57
v_perm_b32 v184, v35, v34, s58
v_accvgpr_write_b32 a161, v183
v_accvgpr_write_b32 a165, v184
v_perm_b32 v183, v37, v36, s57
v_perm_b32 v184, v37, v36, s58
v_accvgpr_write_b32 a162, v183
v_accvgpr_write_b32 a166, v184
v_perm_b32 v183, v39, v38, s57
v_perm_b32 v184, v39, v38, s58
v_accvgpr_write_b32 a163, v183
v_accvgpr_write_b32 a167, v184
v_perm_b32 v183, v41, v40, s57
v_perm_b32 v184, v41, v40, s58
v_accvgpr_write_b32 a168, v183
v_accvgpr_write_b32 a172, v184
v_perm_b32 v183, v43, v42, s57
v_perm_b32 v184, v43, v42, s58
v_accvgpr_write_b32 a169, v183
v_accvgpr_write_b32 a173, v184
v_perm_b32 v183, v45, v44, s57
v_perm_b32 v184, v45, v44, s58
v_accvgpr_write_b32 a170, v183
v_accvgpr_write_b32 a174, v184
v_perm_b32 v183, v47, v46, s57
v_perm_b32 v184, v47, v46, s58
v_accvgpr_write_b32 a171, v183
v_accvgpr_write_b32 a175, v184
v_perm_b32 v183, v49, v48, s57
v_perm_b32 v184, v49, v48, s58
v_accvgpr_write_b32 a176, v183
v_accvgpr_write_b32 a180, v184
v_perm_b32 v183, v51, v50, s57
v_perm_b32 v184, v51, v50, s58
v_accvgpr_write_b32 a177, v183
v_accvgpr_write_b32 a181, v184
v_perm_b32 v183, v53, v52, s57
v_perm_b32 v184, v53, v52, s58
v_accvgpr_write_b32 a178, v183
v_accvgpr_write_b32 a182, v184
v_perm_b32 v183, v55, v54, s57
v_perm_b32 v184, v55, v54, s58
v_accvgpr_write_b32 a179, v183
v_accvgpr_write_b32 a183, v184
v_perm_b32 v183, v57, v56, s57
v_perm_b32 v184, v57, v56, s58
v_accvgpr_write_b32 a184, v183
v_accvgpr_write_b32 a188, v184
v_perm_b32 v183, v59, v58, s57
v_perm_b32 v184, v59, v58, s58
v_accvgpr_write_b32 a185, v183
v_accvgpr_write_b32 a189, v184
v_perm_b32 v183, v61, v60, s57
v_perm_b32 v184, v61, v60, s58
v_accvgpr_write_b32 a186, v183
v_accvgpr_write_b32 a190, v184
v_perm_b32 v183, v63, v62, s57
v_perm_b32 v184, v63, v62, s58
v_accvgpr_write_b32 a187, v183
v_accvgpr_write_b32 a191, v184
s_waitcnt vmcnt(63)
v_perm_b32 v183, v65, v64, s57
v_perm_b32 v184, v65, v64, s58
v_accvgpr_write_b32 a192, v183
v_accvgpr_write_b32 a196, v184
v_perm_b32 v183, v67, v66, s57
v_perm_b32 v184, v67, v66, s58
v_accvgpr_write_b32 a193, v183
v_accvgpr_write_b32 a197, v184
v_perm_b32 v183, v69, v68, s57
v_perm_b32 v184, v69, v68, s58
v_accvgpr_write_b32 a194, v183
v_accvgpr_write_b32 a198, v184
v_perm_b32 v183, v71, v70, s57
v_perm_b32 v184, v71, v70, s58
v_accvgpr_write_b32 a195, v183
v_accvgpr_write_b32 a199, v184
v_perm_b32 v183, v73, v72, s57
v_perm_b32 v184, v73, v72, s58
v_accvgpr_write_b32 a200, v183
v_accvgpr_write_b32 a204, v184
v_perm_b32 v183, v75, v74, s57
v_perm_b32 v184, v75, v74, s58
v_accvgpr_write_b32 a201, v183
v_accvgpr_write_b32 a205, v184
v_perm_b32 v183, v77, v76, s57
v_perm_b32 v184, v77, v76, s58
v_accvgpr_write_b32 a202, v183
v_accvgpr_write_b32 a206, v184
v_perm_b32 v183, v79, v78, s57
v_perm_b32 v184, v79, v78, s58
v_accvgpr_write_b32 a203, v183
v_accvgpr_write_b32 a207, v184
s_waitcnt vmcnt(56)
v_perm_b32 v183, v81, v80, s57
v_perm_b32 v184, v81, v80, s58
v_accvgpr_write_b32 a208, v183
v_accvgpr_write_b32 a212, v184
v_perm_b32 v183, v83, v82, s57
v_perm_b32 v184, v83, v82, s58
v_accvgpr_write_b32 a209, v183
v_accvgpr_write_b32 a213, v184
v_perm_b32 v183, v85, v84, s57
v_perm_b32 v184, v85, v84, s58
v_accvgpr_write_b32 a210, v183
v_accvgpr_write_b32 a214, v184
v_perm_b32 v183, v87, v86, s57
v_perm_b32 v184, v87, v86, s58
v_accvgpr_write_b32 a211, v183
v_accvgpr_write_b32 a215, v184
s_waitcnt vmcnt(48)
v_perm_b32 v183, v89, v88, s57
v_perm_b32 v184, v89, v88, s58
v_accvgpr_write_b32 a216, v183
v_accvgpr_write_b32 a220, v184
v_perm_b32 v183, v91, v90, s57
v_perm_b32 v184, v91, v90, s58
v_accvgpr_write_b32 a217, v183
v_accvgpr_write_b32 a221, v184
v_perm_b32 v183, v93, v92, s57
v_perm_b32 v184, v93, v92, s58
v_accvgpr_write_b32 a218, v183
v_accvgpr_write_b32 a222, v184
v_perm_b32 v183, v95, v94, s57
v_perm_b32 v184, v95, v94, s58
v_accvgpr_write_b32 a219, v183
v_accvgpr_write_b32 a223, v184
s_waitcnt vmcnt(40)
v_perm_b32 v183, v97, v96, s57
v_perm_b32 v184, v97, v96, s58
v_accvgpr_write_b32 a224, v183
v_accvgpr_write_b32 a228, v184
v_perm_b32 v183, v99, v98, s57
v_perm_b32 v184, v99, v98, s58
v_accvgpr_write_b32 a225, v183
v_accvgpr_write_b32 a229, v184
v_perm_b32 v183, v101, v100, s57
v_perm_b32 v184, v101, v100, s58
v_accvgpr_write_b32 a226, v183
v_accvgpr_write_b32 a230, v184
v_perm_b32 v183, v103, v102, s57
v_perm_b32 v184, v103, v102, s58
v_accvgpr_write_b32 a227, v183
v_accvgpr_write_b32 a231, v184
s_waitcnt vmcnt(32)
v_perm_b32 v183, v105, v104, s57
v_perm_b32 v184, v105, v104, s58
v_accvgpr_write_b32 a232, v183
v_accvgpr_write_b32 a236, v184
v_perm_b32 v183, v107, v106, s57
v_perm_b32 v184, v107, v106, s58
v_accvgpr_write_b32 a233, v183
v_accvgpr_write_b32 a237, v184
v_perm_b32 v183, v109, v108, s57
v_perm_b32 v184, v109, v108, s58
v_accvgpr_write_b32 a234, v183
v_accvgpr_write_b32 a238, v184
v_perm_b32 v183, v111, v110, s57
v_perm_b32 v184, v111, v110, s58
v_accvgpr_write_b32 a235, v183
v_accvgpr_write_b32 a239, v184
s_waitcnt vmcnt(24)
v_perm_b32 v183, v113, v112, s57
v_perm_b32 v184, v113, v112, s58
v_accvgpr_write_b32 a240, v183
v_accvgpr_write_b32 a244, v184
v_perm_b32 v183, v115, v114, s57
v_perm_b32 v184, v115, v114, s58
v_accvgpr_write_b32 a241, v183
v_accvgpr_write_b32 a245, v184
v_perm_b32 v183, v117, v116, s57
v_perm_b32 v184, v117, v116, s58
v_accvgpr_write_b32 a242, v183
v_accvgpr_write_b32 a246, v184
v_perm_b32 v183, v119, v118, s57
v_perm_b32 v184, v119, v118, s58
v_accvgpr_write_b32 a243, v183
v_accvgpr_write_b32 a247, v184
s_waitcnt vmcnt(16)
v_perm_b32 v183, v121, v120, s57
v_perm_b32 v184, v121, v120, s58
v_accvgpr_write_b32 a248, v183
v_accvgpr_write_b32 a252, v184
v_perm_b32 v183, v123, v122, s57
v_perm_b32 v184, v123, v122, s58
v_accvgpr_write_b32 a249, v183
v_accvgpr_write_b32 a253, v184
v_perm_b32 v183, v125, v124, s57
v_perm_b32 v184, v125, v124, s58
v_accvgpr_write_b32 a250, v183
v_accvgpr_write_b32 a254, v184
v_perm_b32 v183, v127, v126, s57
v_perm_b32 v184, v127, v126, s58
v_accvgpr_write_b32 a251, v183
v_accvgpr_write_b32 a255, v184
buffer_load_dword v185, off, s[40:43], 0 offset:192 sc0 sc1
L_gatew_done:
s_waitcnt vmcnt(0)
v_readfirstlane_b32 s52, v185
s_cmp_lg_u32 s52, 0
s_cbranch_scc1 L_w_init
v_mov_b32 v1, 192
L_init_1:
buffer_load_dword v2, v1, s[40:43], 0 offen sc0 sc1
s_waitcnt vmcnt(0)
v_readfirstlane_b32 s52, v2
s_cmp_lg_u32 s52, 0
s_cbranch_scc1 L_init_1_ok
s_sub_u32 s56, s56, 1
s_cbranch_scc0 L_init_1
s_endpgm
L_init_1_ok:
L_w_init:
s_mov_b32 s63, 0
s_mov_b32 s70, 61440
s_cmp_eq_u32 s3, 2
s_cbranch_scc1 L_p1_1
L_p1_0:
s_waitcnt vmcnt(0)
s_barrier
s_cmp_lg_u32 s3, 0
s_cbranch_scc1 L_fl_2
s_mov_b64 exec, 1
v_mov_b32 v183, 1
buffer_store_dword v183, off, s[36:39], s70 sc0 sc1
s_mov_b64 exec, -1
L_fl_2:
s_lshl_b32 s70, s60, 6
s_add_u32 s70, s70, s64
s_lshl_b32 s70, s70, 2
v_add_u32 v185, s65, v176
s_xor_b32 s65, s65, 32768
s_add_u32 s66, s64, 7
s_cmp_ge_u32 s66, 64
s_cbranch_scc1 L_p1_0_nodma
s_cmp_eq_u32 s63, 0
s_cbranch_scc1 L_p1_0_nodma
s_lshl_b32 s52, s66, 15
s_lshl_b32 s53, s3, 8
s_add_u32 s52, s52, s53
s_lshl_b32 s53, s3, 13
s_add_u32 s53, s53, s65
s_add_u32 m0, s53, 0
s_add_u32 s54, s52, 0
buffer_load_dwordx4 v177, s[92:95], s54 offen lds
s_add_u32 m0, s53, 1024
s_add_u32 s54, s52, 16384
buffer_load_dwordx4 v177, s[92:95], s54 offen lds
s_add_u32 m0, s53, 2048
s_add_u32 s54, s52, 64
buffer_load_dwordx4 v177, s[92:95], s54 offen lds
s_add_u32 m0, s53, 3072
s_add_u32 s54, s52, 16448
buffer_load_dwordx4 v177, s[92:95], s54 offen lds
s_add_u32 m0, s53, 4096
s_add_u32 s54, s52, 128
buffer_load_dwordx4 v177, s[92:95], s54 offen lds
s_add_u32 m0, s53, 5120
s_add_u32 s54, s52, 16512
buffer_load_dwordx4 v177, s[92:95], s54 offen lds
s_add_u32 m0, s53, 6144
s_add_u32 s54, s52, 192
buffer_load_dwordx4 v177, s[92:95], s54 offen lds
s_add_u32 m0, s53, 7168
s_add_u32 s54, s52, 16576
buffer_load_dwordx4 v177, s[92:95], s54 offen lds
L_p1_0_nodma:
ds_read_b128 v[0:3], v185 offset:0
ds_read_b128 v[4:7], v185 offset:1024
ds_read_b128 v[8:11], v185 offset:2048
ds_read_b128 v[12:15], v185 offset:3072
ds_read_b128 v[16:19], v185 offset:4096
ds_read_b128 v[20:23], v185 offset:5120
ds_read_b128 v[24:27], v185 offset:6144
ds_read_b128 v[28:31], v185 offset:7168
s_waitcnt lgkmcnt(6)
v_mfma_f32_16x16x32_bf16 v[32:35], a[0:3], v[0:3], 0
v_mfma_f32_16x16x32_bf16 v[36:39], a[4:7], v[0:3], 0
v_mfma_f32_16x16x32_bf16 v[40:43], a[0:3], v[4:7], 0
v_mfma_f32_16x16x32_bf16 v[44:47], a[4:7], v[4:7], 0
v_mfma_f32_16x16x32_bf16 v[48:51], v[0:3], a[128:131], 0
v_mfma_f32_16x16x32_bf16 v[56:59], v[0:3], a[132:135], 0
v_mfma_f32_16x16x32_bf16 v[52:55], v[4:7], a[128:131], 0
v_mfma_f32_16x16x32_bf16 v[60:63], v[4:7], a[132:135], 0
v_mfma_f32_16x16x32_bf16 v[64:67], v[192:195], v[0:3], 0
v_mfma_f32_16x16x32_bf16 v[68:71], v[192:195], v[4:7], 0
ds_read_b128 v[0:3], v185 offset:8192
ds_read_b128 v[4:7], v185 offset:9216
s_waitcnt lgkmcnt(6)
v_mfma_f32_16x16x32_bf16 v[32:35], a[8:11], v[8:11], v[32:35]
v_mfma_f32_16x16x32_bf16 v[36:39], a[12:15], v[8:11], v[36:39]
v_mfma_f32_16x16x32_bf16 v[40:43], a[8:11], v[12:15], v[40:43]
v_mfma_f32_16x16x32_bf16 v[44:47], a[12:15], v[12:15], v[44:47]
v_mfma_f32_16x16x32_bf16 v[48:51], v[8:11], a[136:139], v[48:51]
v_mfma_f32_16x16x32_bf16 v[56:59], v[8:11], a[140:143], v[56:59]
v_mfma_f32_16x16x32_bf16 v[52:55], v[12:15], a[136:139], v[52:55]
v_mfma_f32_16x16x32_bf16 v[60:63], v[12:15], a[140:143], v[60:63]
v_mfma_f32_16x16x32_bf16 v[64:67], v[196:199], v[8:11], v[64:67]
v_mfma_f32_16x16x32_bf16 v[68:71], v[196:199], v[12:15], v[68:71]
ds_read_b128 v[8:11], v185 offset:10240
ds_read_b128 v[12:15], v185 offset:11264
s_waitcnt lgkmcnt(6)
v_mfma_f32_16x16x32_bf16 v[32:35], a[16:19], v[16:19], v[32:35]
v_mfma_f32_16x16x32_bf16 v[36:39], a[20:23], v[16:19], v[36:39]
v_mfma_f32_16x16x32_bf16 v[40:43], a[16:19], v[20:23], v[40:43]
v_mfma_f32_16x16x32_bf16 v[44:47], a[20:23], v[20:23], v[44:47]
v_mfma_f32_16x16x32_bf16 v[48:51], v[16:19], a[144:147], v[48:51]
v_mfma_f32_16x16x32_bf16 v[56:59], v[16:19], a[148:151], v[56:59]
v_mfma_f32_16x16x32_bf16 v[52:55], v[20:23], a[144:147], v[52:55]
v_mfma_f32_16x16x32_bf16 v[60:63], v[20:23], a[148:151], v[60:63]
v_mfma_f32_16x16x32_bf16 v[64:67], v[200:203], v[16:19], v[64:67]
v_mfma_f32_16x16x32_bf16 v[68:71], v[200:203], v[20:23], v[68:71]
ds_read_b128 v[16:19], v185 offset:12288
ds_read_b128 v[20:23], v185 offset:13312
s_waitcnt lgkmcnt(6)
v_mfma_f32_16x16x32_bf16 v[32:35], a[24:27], v[24:27], v[32:35]
v_mfma_f32_16x16x32_bf16 v[36:39], a[28:31], v[24:27], v[36:39]
v_mfma_f32_16x16x32_bf16 v[40:43], a[24:27], v[28:31], v[40:43]
v_mfma_f32_16x16x32_bf16 v[44:47], a[28:31], v[28:31], v[44:47]
v_mfma_f32_16x16x32_bf16 v[48:51], v[24:27], a[152:155], v[48:51]
v_mfma_f32_16x16x32_bf16 v[56:59], v[24:27], a[156:159], v[56:59]
v_mfma_f32_16x16x32_bf16 v[52:55], v[28:31], a[152:155], v[52:55]
v_mfma_f32_16x16x32_bf16 v[60:63], v[28:31], a[156:159], v[60:63]
v_mfma_f32_16x16x32_bf16 v[64:67], v[204:207], v[24:27], v[64:67]
v_mfma_f32_16x16x32_bf16 v[68:71], v[204:207], v[28:31], v[68:71]
ds_read_b128 v[24:27], v185 offset:14336
ds_read_b128 v[28:31], v185 offset:15360
s_waitcnt lgkmcnt(6)
v_mfma_f32_16x16x32_bf16 v[32:35], a[32:35], v[0:3], v[32:35]
v_mfma_f32_16x16x32_bf16 v[36:39], a[36:39], v[0:3], v[36:39]
v_mfma_f32_16x16x32_bf16 v[40:43], a[32:35], v[4:7], v[40:43]
v_mfma_f32_16x16x32_bf16 v[44:47], a[36:39], v[4:7], v[44:47]
v_mfma_f32_16x16x32_bf16 v[48:51], v[0:3], a[160:163], v[48:51]
v_mfma_f32_16x16x32_bf16 v[56:59], v[0:3], a[164:167], v[56:59]
v_mfma_f32_16x16x32_bf16 v[52:55], v[4:7], a[160:163], v[52:55]
v_mfma_f32_16x16x32_bf16 v[60:63], v[4:7], a[164:167], v[60:63]
v_mfma_f32_16x16x32_bf16 v[64:67], v[208:211], v[0:3], v[64:67]
v_mfma_f32_16x16x32_bf16 v[68:71], v[208:211], v[4:7], v[68:71]
ds_read_b128 v[0:3], v185 offset:16384
ds_read_b128 v[4:7], v185 offset:17408
s_waitcnt lgkmcnt(6)
v_mfma_f32_16x16x32_bf16 v[32:35], a[40:43], v[8:11], v[32:35]
v_mfma_f32_16x16x32_bf16 v[36:39], a[44:47], v[8:11], v[36:39]
v_mfma_f32_16x16x32_bf16 v[40:43], a[40:43], v[12:15], v[40:43]
v_mfma_f32_16x16x32_bf16 v[44:47], a[44:47], v[12:15], v[44:47]
v_mfma_f32_16x16x32_bf16 v[48:51], v[8:11], a[168:171], v[48:51]
v_mfma_f32_16x16x32_bf16 v[56:59], v[8:11], a[172:175], v[56:59]
v_mfma_f32_16x16x32_bf16 v[52:55], v[12:15], a[168:171], v[52:55]
v_mfma_f32_16x16x32_bf16 v[60:63], v[12:15], a[172:175], v[60:63]
v_mfma_f32_16x16x32_bf16 v[64:67], v[212:215], v[8:11], v[64:67]
v_mfma_f32_16x16x32_bf16 v[68:71], v[212:215], v[12:15], v[68:71]
ds_read_b128 v[8:11], v185 offset:18432
ds_read_b128 v[12:15], v185 offset:19456
s_waitcnt lgkmcnt(6)
v_mfma_f32_16x16x32_bf16 v[32:35], a[48:51], v[16:19], v[32:35]
v_mfma_f32_16x16x32_bf16 v[36:39], a[52:55], v[16:19], v[36:39]
v_mfma_f32_16x16x32_bf16 v[40:43], a[48:51], v[20:23], v[40:43]
v_mfma_f32_16x16x32_bf16 v[44:47], a[52:55], v[20:23], v[44:47]
v_mfma_f32_16x16x32_bf16 v[48:51], v[16:19], a[176:179], v[48:51]
v_mfma_f32_16x16x32_bf16 v[56:59], v[16:19], a[180:183], v[56:59]
v_mfma_f32_16x16x32_bf16 v[52:55], v[20:23], a[176:179], v[52:55]
v_mfma_f32_16x16x32_bf16 v[60:63], v[20:23], a[180:183], v[60:63]
v_mfma_f32_16x16x32_bf16 v[64:67], v[216:219], v[16:19], v[64:67]
v_mfma_f32_16x16x32_bf16 v[68:71], v[216:219], v[20:23], v[68:71]
ds_read_b128 v[16:19], v185 offset:20480
ds_read_b128 v[20:23], v185 offset:21504
s_waitcnt lgkmcnt(6)
v_mfma_f32_16x16x32_bf16 v[32:35], a[56:59], v[24:27], v[32:35]
v_mfma_f32_16x16x32_bf16 v[36:39], a[60:63], v[24:27], v[36:39]
v_mfma_f32_16x16x32_bf16 v[40:43], a[56:59], v[28:31], v[40:43]
v_mfma_f32_16x16x32_bf16 v[44:47], a[60:63], v[28:31], v[44:47]
v_mfma_f32_16x16x32_bf16 v[48:51], v[24:27], a[184:187], v[48:51]
v_mfma_f32_16x16x32_bf16 v[56:59], v[24:27], a[188:191], v[56:59]
v_mfma_f32_16x16x32_bf16 v[52:55], v[28:31], a[184:187], v[52:55]
v_mfma_f32_16x16x32_bf16 v[60:63], v[28:31], a[188:191], v[60:63]
v_mfma_f32_16x16x32_bf16 v[64:67], v[220:223], v[24:27], v[64:67]
v_mfma_f32_16x16x32_bf16 v[68:71], v[220:223], v[28:31], v[68:71]
ds_read_b128 v[24:27], v185 offset:22528
ds_read_b128 v[28:31], v185 offset:23552
s_waitcnt lgkmcnt(6)
v_mfma_f32_16x16x32_bf16 v[32:35], a[64:67], v[0:3], v[32:35]
v_mfma_f32_16x16x32_bf16 v[36:39], a[68:71], v[0:3], v[36:39]
v_mfma_f32_16x16x32_bf16 v[40:43], a[64:67], v[4:7], v[40:43]
v_mfma_f32_16x16x32_bf16 v[44:47], a[68:71], v[4:7], v[44:47]
v_mfma_f32_16x16x32_bf16 v[48:51], v[0:3], a[192:195], v[48:51]
v_mfma_f32_16x16x32_bf16 v[56:59], v[0:3], a[196:199], v[56:59]
v_mfma_f32_16x16x32_bf16 v[52:55], v[4:7], a[192:195], v[52:55]
v_mfma_f32_16x16x32_bf16 v[60:63], v[4:7], a[196:199], v[60:63]
v_mfma_f32_16x16x32_bf16 v[64:67], v[224:227], v[0:3], v[64:67]
v_mfma_f32_16x16x32_bf16 v[68:71], v[224:227], v[4:7], v[68:71]
ds_read_b128 v[0:3], v185 offset:24576
ds_read_b128 v[4:7], v185 offset:25600
s_waitcnt lgkmcnt(6)
v_mfma_f32_16x16x32_bf16 v[32:35], a[72:75], v[8:11], v[32:35]
v_mfma_f32_16x16x32_bf16 v[36:39], a[76:79], v[8:11], v[36:39]
v_mfma_f32_16x16x32_bf16 v[40:43], a[72:75], v[12:15], v[40:43]
v_mfma_f32_16x16x32_bf16 v[44:47], a[76:79], v[12:15], v[44:47]
v_mfma_f32_16x16x32_bf16 v[48:51], v[8:11], a[200:203], v[48:51]
v_mfma_f32_16x16x32_bf16 v[56:59], v[8:11], a[204:207], v[56:59]
v_mfma_f32_16x16x32_bf16 v[52:55], v[12:15], a[200:203], v[52:55]
v_mfma_f32_16x16x32_bf16 v[60:63], v[12:15], a[204:207], v[60:63]
v_mfma_f32_16x16x32_bf16 v[64:67], v[228:231], v[8:11], v[64:67]
v_mfma_f32_16x16x32_bf16 v[68:71], v[228:231], v[12:15], v[68:71]
ds_read_b128 v[8:11], v185 offset:26624
ds_read_b128 v[12:15], v185 offset:27648
s_waitcnt lgkmcnt(6)
v_mfma_f32_16x16x32_bf16 v[32:35], a[80:83], v[16:19], v[32:35]
v_mfma_f32_16x16x32_bf16 v[36:39], a[84:87], v[16:19], v[36:39]
v_mfma_f32_16x16x32_bf16 v[40:43], a[80:83], v[20:23], v[40:43]
v_mfma_f32_16x16x32_bf16 v[44:47], a[84:87], v[20:23], v[44:47]
v_mfma_f32_16x16x32_bf16 v[48:51], v[16:19], a[208:211], v[48:51]
v_mfma_f32_16x16x32_bf16 v[56:59], v[16:19], a[212:215], v[56:59]
v_mfma_f32_16x16x32_bf16 v[52:55], v[20:23], a[208:211], v[52:55]
v_mfma_f32_16x16x32_bf16 v[60:63], v[20:23], a[212:215], v[60:63]
v_mfma_f32_16x16x32_bf16 v[64:67], v[232:235], v[16:19], v[64:67]
v_mfma_f32_16x16x32_bf16 v[68:71], v[232:235], v[20:23], v[68:71]
ds_read_b128 v[16:19], v185 offset:28672
ds_read_b128 v[20:23], v185 offset:29696
s_waitcnt lgkmcnt(6)
v_mfma_f32_16x16x32_bf16 v[32:35], a[88:91], v[24:27], v[32:35]
v_mfma_f32_16x16x32_bf16 v[36:39], a[92:95], v[24:27], v[36:39]
v_mfma_f32_16x16x32_bf16 v[40:43], a[88:91], v[28:31], v[40:43]
v_mfma_f32_16x16x32_bf16 v[44:47], a[92:95], v[28:31], v[44:47]
v_mfma_f32_16x16x32_bf16 v[48:51], v[24:27], a[216:219], v[48:51]
v_mfma_f32_16x16x32_bf16 v[56:59], v[24:27], a[220:223], v[56:59]
v_mfma_f32_16x16x32_bf16 v[52:55], v[28:31], a[216:219], v[52:55]
v_mfma_f32_16x16x32_bf16 v[60:63], v[28:31], a[220:223], v[60:63]
v_mfma_f32_16x16x32_bf16 v[64:67], v[236:239], v[24:27], v[64:67]
v_mfma_f32_16x16x32_bf16 v[68:71], v[236:239], v[28:31], v[68:71]
ds_read_b128 v[24:27], v185 offset:30720
ds_read_b128 v[28:31], v185 offset:31744
s_waitcnt lgkmcnt(6)
v_mfma_f32_16x16x32_bf16 v[32:35], a[96:99], v[0:3], v[32:35]
v_mfma_f32_16x16x32_bf16 v[36:39], a[100:103], v[0:3], v[36:39]
v_mfma_f32_16x16x32_bf16 v[40:43], a[96:99], v[4:7], v[40:43]
v_mfma_f32_16x16x32_bf16 v[44:47], a[100:103], v[4:7], v[44:47]
v_mfma_f32_16x16x32_bf16 v[48:51], v[0:3], a[224:227], v[48:51]
v_mfma_f32_16x16x32_bf16 v[56:59], v[0:3], a[228:231], v[56:59]
v_mfma_f32_16x16x32_bf16 v[52:55], v[4:7], a[224:227], v[52:55]
v_mfma_f32_16x16x32_bf16 v[60:63], v[4:7], a[228:231], v[60:63]
v_mfma_f32_16x16x32_bf16 v[64:67], v[240:243], v[0:3], v[64:67]
v_mfma_f32_16x16x32_bf16 v[68:71], v[240:243], v[4:7], v[68:71]
s_waitcnt lgkmcnt(4)
v_mfma_f32_16x16x32_bf16 v[32:35], a[104:107], v[8:11], v[32:35]
v_mfma_f32_16x16x32_bf16 v[36:39], a[108:111], v[8:11], v[36:39]
v_mfma_f32_16x16x32_bf16 v[40:43], a[104:107], v[12:15], v[40:43]
v_mfma_f32_16x16x32_bf16 v[44:47], a[108:111], v[12:15], v[44:47]
v_mfma_f32_16x16x32_bf16 v[48:51], v[8:11], a[232:235], v[48:51]
v_mfma_f32_16x16x32_bf16 v[56:59], v[8:11], a[236:239], v[56:59]
v_mfma_f32_16x16x32_bf16 v[52:55], v[12:15], a[232:235], v[52:55]
v_mfma_f32_16x16x32_bf16 v[60:63], v[12:15], a[236:239], v[60:63]
v_mfma_f32_16x16x32_bf16 v[64:67], v[244:247], v[8:11], v[64:67]
v_mfma_f32_16x16x32_bf16 v[68:71], v[244:247], v[12:15], v[68:71]
s_waitcnt lgkmcnt(2)
v_mfma_f32_16x16x32_bf16 v[32:35], a[112:115], v[16:19], v[32:35]
v_mfma_f32_16x16x32_bf16 v[36:39], a[116:119], v[16:19], v[36:39]
v_mfma_f32_16x16x32_bf16 v[40:43], a[112:115], v[20:23], v[40:43]
v_mfma_f32_16x16x32_bf16 v[44:47], a[116:119], v[20:23], v[44:47]
v_mfma_f32_16x16x32_bf16 v[48:51], v[16:19], a[240:243], v[48:51]
v_mfma_f32_16x16x32_bf16 v[56:59], v[16:19], a[244:247], v[56:59]
v_mfma_f32_16x16x32_bf16 v[52:55], v[20:23], a[240:243], v[52:55]
v_mfma_f32_16x16x32_bf16 v[60:63], v[20:23], a[244:247], v[60:63]
v_mfma_f32_16x16x32_bf16 v[64:67], v[248:251], v[16:19], v[64:67]
v_mfma_f32_16x16x32_bf16 v[68:71], v[248:251], v[20:23], v[68:71]
s_waitcnt lgkmcnt(0)
v_mfma_f32_16x16x32_bf16 v[32:35], a[120:123], v[24:27], v[32:35]
v_mfma_f32_16x16x32_bf16 v[36:39], a[124:127], v[24:27], v[36:39]
v_mfma_f32_16x16x32_bf16 v[40:43], a[120:123], v[28:31], v[40:43]
v_mfma_f32_16x16x32_bf16 v[44:47], a[124:127], v[28:31], v[44:47]
v_mfma_f32_16x16x32_bf16 v[48:51], v[24:27], a[248:251], v[48:51]
v_mfma_f32_16x16x32_bf16 v[56:59], v[24:27], a[252:255], v[56:59]
v_mfma_f32_16x16x32_bf16 v[52:55], v[28:31], a[248:251], v[52:55]
v_mfma_f32_16x16x32_bf16 v[60:63], v[28:31], a[252:255], v[60:63]
v_mfma_f32_16x16x32_bf16 v[64:67], v[252:255], v[24:27], v[64:67]
v_mfma_f32_16x16x32_bf16 v[68:71], v[252:255], v[28:31], v[68:71]
s_lshl_b32 s66, s64, 5
s_add_u32 s66, s66, s60
s_lshl_b32 s66, s66, 14
s_add_u32 s66, s66, 16777216
s_lshl_b32 s52, s3, 10
s_add_u32 s67, s66, s52
s_add_u32 s68, s67, 4096
s_lshl_b32 s52, s3, 11
s_add_u32 s66, s66, s52
s_add_u32 s66, s66, 8192
v_cvt_pk_bf16_f32 v72, v32, v36
v_cvt_pk_bf16_f32 v73, v33, v37
v_cvt_pk_bf16_f32 v74, v34, v38
v_cvt_pk_bf16_f32 v75, v35, v39
buffer_store_dwordx4 v[72:75], v176, s[36:39], s67 offen sc0 sc1
v_cvt_pk_bf16_f32 v76, v40, v44
v_cvt_pk_bf16_f32 v77, v41, v45
v_cvt_pk_bf16_f32 v78, v42, v46
v_cvt_pk_bf16_f32 v79, v43, v47
buffer_store_dwordx4 v[76:79], v176, s[36:39], s68 offen sc0 sc1
v_cvt_pk_bf16_f32 v80, v48, v49
v_cvt_pk_bf16_f32 v81, v50, v51
buffer_store_dwordx2 v[80:81], v178, s[36:39], s66 offen offset:0 sc0 sc1
v_cvt_pk_bf16_f32 v82, v52, v53
v_cvt_pk_bf16_f32 v83, v54, v55
buffer_store_dwordx2 v[82:83], v178, s[36:39], s66 offen offset:256 sc0 sc1
v_cvt_pk_bf16_f32 v84, v56, v57
v_cvt_pk_bf16_f32 v85, v58, v59
buffer_store_dwordx2 v[84:85], v178, s[36:39], s66 offen offset:1024 sc0 sc1
v_cvt_pk_bf16_f32 v86, v60, v61
v_cvt_pk_bf16_f32 v87, v62, v63
buffer_store_dwordx2 v[86:87], v178, s[36:39], s66 offen offset:1280 sc0 sc1
s_lshl_b32 s66, s60, 17
s_lshl_b32 s52, s64, 10
s_add_u32 s66, s66, s52
s_add_u32 s66, s66, 9437184
s_cmp_eq_u32 s3, 1
s_cbranch_scc0 L_p1_0_nk
v_cvt_pk_bf16_f32 v88, v64, v65
v_cvt_pk_bf16_f32 v89, v66, v67
v_cvt_pk_bf16_f32 v90, v68, v69
v_cvt_pk_bf16_f32 v91, v70, v71
buffer_store_dwordx2 v[88:89], v179, s[36:39], s66 offen offset:0 sc0 sc1
buffer_store_dwordx2 v[90:91], v179, s[36:39], s66 offen offset:256 sc0 sc1
s_branch L_p1_0_end
L_p1_0_nk:
s_cmp_eq_u32 s3, 0
s_cbranch_scc0 L_p1_0_gate
v_mul_f32 v64, 0x3eb8aa3b, v64
v_mul_f32 v65, 0x3eb8aa3b, v65
v_mul_f32 v66, 0x3eb8aa3b, v66
v_mul_f32 v67, 0x3eb8aa3b, v67
v_mul_f32 v68, 0x3eb8aa3b, v68
v_mul_f32 v69, 0x3eb8aa3b, v69
v_mul_f32 v70, 0x3eb8aa3b, v70
v_mul_f32 v71, 0x3eb8aa3b, v71
v_cvt_pk_bf16_f32 v88, v64, v65
v_cvt_pk_bf16_f32 v89, v66, v67
v_cvt_pk_bf16_f32 v90, v68, v69
v_cvt_pk_bf16_f32 v91, v70, v71
s_lshl_b32 s52, s63, 10
s_add_u32 s52, s52, 131072
v_add_u32 v183, s52, v179
ds_write_b64 v183, v[88:89] offset:0
ds_write_b64 v183, v[90:91] offset:256
s_branch L_p1_0_end
L_p1_0_gate:
v_mul_f32 v64, 0xbfb8aa3b, v64
v_exp_f32 v64, v64
s_nop 0
v_add_f32 v64, 1.0, v64
v_rcp_f32 v64, v64
v_mul_f32 v68, 0xbfb8aa3b, v68
v_exp_f32 v68, v68
s_nop 0
v_add_f32 v68, 1.0, v68
v_rcp_f32 v68, v68
s_lshl_b32 s52, s63, 7
s_add_u32 s52, s52, 151552
v_and_b32 v183, 15, v191
v_lshlrev_b32 v183, 2, v183
v_add_u32 v183, s52, v183
ds_write2_b32 v183, v64, v68 offset0:0 offset1:16
L_p1_0_end:
s_cmp_eq_u32 s63, 0
s_cbranch_scc0 L_p1_0_nx
s_waitcnt vmcnt(0)
s_barrier
s_cmp_lg_u32 s3, 0
s_cbranch_scc1 L_fl_3
s_mov_b64 exec, 1
v_mov_b32 v183, 1
buffer_store_dword v183, off, s[36:39], s70 sc0 sc1
s_mov_b64 exec, -1
L_fl_3:
s_add_u32 s66, s64, 7
s_lshl_b32 s52, s66, 15
s_lshl_b32 s53, s3, 8
s_add_u32 s52, s52, s53
s_lshl_b32 s53, s3, 13
s_add_u32 s53, s53, s65
s_add_u32 m0, s53, 0
s_add_u32 s54, s52, 0
buffer_load_dwordx4 v177, s[92:95], s54 offen lds
s_add_u32 m0, s53, 1024
s_add_u32 s54, s52, 16384
buffer_load_dwordx4 v177, s[92:95], s54 offen lds
s_add_u32 m0, s53, 2048
s_add_u32 s54, s52, 64
buffer_load_dwordx4 v177, s[92:95], s54 offen lds
s_add_u32 m0, s53, 3072
s_add_u32 s54, s52, 16448
buffer_load_dwordx4 v177, s[92:95], s54 offen lds
s_add_u32 m0, s53, 4096
s_add_u32 s54, s52, 128
buffer_load_dwordx4 v177, s[92:95], s54 offen lds
s_add_u32 m0, s53, 5120
s_add_u32 s54, s52, 16512
buffer_load_dwordx4 v177, s[92:95], s54 offen lds
s_add_u32 m0, s53, 6144
s_add_u32 s54, s52, 192
buffer_load_dwordx4 v177, s[92:95], s54 offen lds
s_add_u32 m0, s53, 7168
s_add_u32 s54, s52, 16576
buffer_load_dwordx4 v177, s[92:95], s54 offen lds
L_p1_0_nx:
s_waitcnt lgkmcnt(0)
s_add_u32 s63, s63, 1
s_add_u32 s64, s64, 7
s_cmp_lt_u32 s64, 64
s_cbranch_scc1 L_p1_0
s_branch L_p1_done
L_p1_1:
s_waitcnt vmcnt(0)
s_barrier
s_cmp_lg_u32 s3, 0
s_cbranch_scc1 L_fl_4
s_mov_b64 exec, 1
v_mov_b32 v183, 1
buffer_store_dword v183, off, s[36:39], s70 sc0 sc1
s_mov_b64 exec, -1
L_fl_4:
s_lshl_b32 s70, s60, 6
s_add_u32 s70, s70, s64
s_lshl_b32 s70, s70, 2
v_add_u32 v185, s65, v176
s_xor_b32 s65, s65, 32768
s_add_u32 s66, s64, 7
s_cmp_ge_u32 s66, 64
s_cbranch_scc1 L_p1_1_nodma
s_cmp_eq_u32 s63, 0
s_cbranch_scc1 L_p1_1_nodma
s_lshl_b32 s52, s66, 15
s_lshl_b32 s53, s3, 8
s_add_u32 s52, s52, s53
s_lshl_b32 s53, s3, 13
s_add_u32 s53, s53, s65
s_add_u32 m0, s53, 0
s_add_u32 s54, s52, 0
buffer_load_dwordx4 v177, s[92:95], s54 offen lds
s_add_u32 m0, s53, 1024
s_add_u32 s54, s52, 16384
buffer_load_dwordx4 v177, s[92:95], s54 offen lds
s_add_u32 m0, s53, 2048
s_add_u32 s54, s52, 64
buffer_load_dwordx4 v177, s[92:95], s54 offen lds
s_add_u32 m0, s53, 3072
s_add_u32 s54, s52, 16448
buffer_load_dwordx4 v177, s[92:95], s54 offen lds
s_add_u32 m0, s53, 4096
s_add_u32 s54, s52, 128
buffer_load_dwordx4 v177, s[92:95], s54 offen lds
s_add_u32 m0, s53, 5120
s_add_u32 s54, s52, 16512
buffer_load_dwordx4 v177, s[92:95], s54 offen lds
s_add_u32 m0, s53, 6144
s_add_u32 s54, s52, 192
buffer_load_dwordx4 v177, s[92:95], s54 offen lds
s_add_u32 m0, s53, 7168
s_add_u32 s54, s52, 16576
buffer_load_dwordx4 v177, s[92:95], s54 offen lds
L_p1_1_nodma:
ds_read_b128 v[0:3], v185 offset:0
ds_read_b128 v[4:7], v185 offset:1024
ds_read_b128 v[8:11], v185 offset:2048
ds_read_b128 v[12:15], v185 offset:3072
ds_read_b128 v[16:19], v185 offset:4096
ds_read_b128 v[20:23], v185 offset:5120
ds_read_b128 v[24:27], v185 offset:6144
ds_read_b128 v[28:31], v185 offset:7168
s_waitcnt lgkmcnt(6)
v_mfma_f32_16x16x32_bf16 v[32:35], a[0:3], v[0:3], 0
v_mfma_f32_16x16x32_bf16 v[36:39], a[4:7], v[0:3], 0
v_mfma_f32_16x16x32_bf16 v[40:43], a[0:3], v[4:7], 0
v_mfma_f32_16x16x32_bf16 v[44:47], a[4:7], v[4:7], 0
v_mfma_f32_16x16x32_bf16 v[48:51], v[0:3], a[128:131], 0
v_mfma_f32_16x16x32_bf16 v[56:59], v[0:3], a[132:135], 0
v_mfma_f32_16x16x32_bf16 v[52:55], v[4:7], a[128:131], 0
v_mfma_f32_16x16x32_bf16 v[60:63], v[4:7], a[132:135], 0
v_mfma_f32_16x16x32_bf16 v[64:67], v[0:3], v[192:195], 0
v_mfma_f32_16x16x32_bf16 v[68:71], v[4:7], v[192:195], 0
ds_read_b128 v[0:3], v185 offset:8192
ds_read_b128 v[4:7], v185 offset:9216
s_waitcnt lgkmcnt(6)
v_mfma_f32_16x16x32_bf16 v[32:35], a[8:11], v[8:11], v[32:35]
v_mfma_f32_16x16x32_bf16 v[36:39], a[12:15], v[8:11], v[36:39]
v_mfma_f32_16x16x32_bf16 v[40:43], a[8:11], v[12:15], v[40:43]
v_mfma_f32_16x16x32_bf16 v[44:47], a[12:15], v[12:15], v[44:47]
v_mfma_f32_16x16x32_bf16 v[48:51], v[8:11], a[136:139], v[48:51]
v_mfma_f32_16x16x32_bf16 v[56:59], v[8:11], a[140:143], v[56:59]
v_mfma_f32_16x16x32_bf16 v[52:55], v[12:15], a[136:139], v[52:55]
v_mfma_f32_16x16x32_bf16 v[60:63], v[12:15], a[140:143], v[60:63]
v_mfma_f32_16x16x32_bf16 v[64:67], v[8:11], v[196:199], v[64:67]
v_mfma_f32_16x16x32_bf16 v[68:71], v[12:15], v[196:199], v[68:71]
ds_read_b128 v[8:11], v185 offset:10240
ds_read_b128 v[12:15], v185 offset:11264
s_waitcnt lgkmcnt(6)
v_mfma_f32_16x16x32_bf16 v[32:35], a[16:19], v[16:19], v[32:35]
v_mfma_f32_16x16x32_bf16 v[36:39], a[20:23], v[16:19], v[36:39]
v_mfma_f32_16x16x32_bf16 v[40:43], a[16:19], v[20:23], v[40:43]
v_mfma_f32_16x16x32_bf16 v[44:47], a[20:23], v[20:23], v[44:47]
v_mfma_f32_16x16x32_bf16 v[48:51], v[16:19], a[144:147], v[48:51]
v_mfma_f32_16x16x32_bf16 v[56:59], v[16:19], a[148:151], v[56:59]
v_mfma_f32_16x16x32_bf16 v[52:55], v[20:23], a[144:147], v[52:55]
v_mfma_f32_16x16x32_bf16 v[60:63], v[20:23], a[148:151], v[60:63]
v_mfma_f32_16x16x32_bf16 v[64:67], v[16:19], v[200:203], v[64:67]
v_mfma_f32_16x16x32_bf16 v[68:71], v[20:23], v[200:203], v[68:71]
ds_read_b128 v[16:19], v185 offset:12288
ds_read_b128 v[20:23], v185 offset:13312
s_waitcnt lgkmcnt(6)
v_mfma_f32_16x16x32_bf16 v[32:35], a[24:27], v[24:27], v[32:35]
v_mfma_f32_16x16x32_bf16 v[36:39], a[28:31], v[24:27], v[36:39]
v_mfma_f32_16x16x32_bf16 v[40:43], a[24:27], v[28:31], v[40:43]
v_mfma_f32_16x16x32_bf16 v[44:47], a[28:31], v[28:31], v[44:47]
v_mfma_f32_16x16x32_bf16 v[48:51], v[24:27], a[152:155], v[48:51]
v_mfma_f32_16x16x32_bf16 v[56:59], v[24:27], a[156:159], v[56:59]
v_mfma_f32_16x16x32_bf16 v[52:55], v[28:31], a[152:155], v[52:55]
v_mfma_f32_16x16x32_bf16 v[60:63], v[28:31], a[156:159], v[60:63]
v_mfma_f32_16x16x32_bf16 v[64:67], v[24:27], v[204:207], v[64:67]
v_mfma_f32_16x16x32_bf16 v[68:71], v[28:31], v[204:207], v[68:71]
ds_read_b128 v[24:27], v185 offset:14336
ds_read_b128 v[28:31], v185 offset:15360
s_waitcnt lgkmcnt(6)
v_mfma_f32_16x16x32_bf16 v[32:35], a[32:35], v[0:3], v[32:35]
v_mfma_f32_16x16x32_bf16 v[36:39], a[36:39], v[0:3], v[36:39]
v_mfma_f32_16x16x32_bf16 v[40:43], a[32:35], v[4:7], v[40:43]
v_mfma_f32_16x16x32_bf16 v[44:47], a[36:39], v[4:7], v[44:47]
v_mfma_f32_16x16x32_bf16 v[48:51], v[0:3], a[160:163], v[48:51]
v_mfma_f32_16x16x32_bf16 v[56:59], v[0:3], a[164:167], v[56:59]
v_mfma_f32_16x16x32_bf16 v[52:55], v[4:7], a[160:163], v[52:55]
v_mfma_f32_16x16x32_bf16 v[60:63], v[4:7], a[164:167], v[60:63]
v_mfma_f32_16x16x32_bf16 v[64:67], v[0:3], v[208:211], v[64:67]
v_mfma_f32_16x16x32_bf16 v[68:71], v[4:7], v[208:211], v[68:71]
ds_read_b128 v[0:3], v185 offset:16384
ds_read_b128 v[4:7], v185 offset:17408
s_waitcnt lgkmcnt(6)
v_mfma_f32_16x16x32_bf16 v[32:35], a[40:43], v[8:11], v[32:35]
v_mfma_f32_16x16x32_bf16 v[36:39], a[44:47], v[8:11], v[36:39]
v_mfma_f32_16x16x32_bf16 v[40:43], a[40:43], v[12:15], v[40:43]
v_mfma_f32_16x16x32_bf16 v[44:47], a[44:47], v[12:15], v[44:47]
v_mfma_f32_16x16x32_bf16 v[48:51], v[8:11], a[168:171], v[48:51]
v_mfma_f32_16x16x32_bf16 v[56:59], v[8:11], a[172:175], v[56:59]
v_mfma_f32_16x16x32_bf16 v[52:55], v[12:15], a[168:171], v[52:55]
v_mfma_f32_16x16x32_bf16 v[60:63], v[12:15], a[172:175], v[60:63]
v_mfma_f32_16x16x32_bf16 v[64:67], v[8:11], v[212:215], v[64:67]
v_mfma_f32_16x16x32_bf16 v[68:71], v[12:15], v[212:215], v[68:71]
ds_read_b128 v[8:11], v185 offset:18432
ds_read_b128 v[12:15], v185 offset:19456
s_waitcnt lgkmcnt(6)
v_mfma_f32_16x16x32_bf16 v[32:35], a[48:51], v[16:19], v[32:35]
v_mfma_f32_16x16x32_bf16 v[36:39], a[52:55], v[16:19], v[36:39]
v_mfma_f32_16x16x32_bf16 v[40:43], a[48:51], v[20:23], v[40:43]
v_mfma_f32_16x16x32_bf16 v[44:47], a[52:55], v[20:23], v[44:47]
v_mfma_f32_16x16x32_bf16 v[48:51], v[16:19], a[176:179], v[48:51]
v_mfma_f32_16x16x32_bf16 v[56:59], v[16:19], a[180:183], v[56:59]
v_mfma_f32_16x16x32_bf16 v[52:55], v[20:23], a[176:179], v[52:55]
v_mfma_f32_16x16x32_bf16 v[60:63], v[20:23], a[180:183], v[60:63]
v_mfma_f32_16x16x32_bf16 v[64:67], v[16:19], v[216:219], v[64:67]
v_mfma_f32_16x16x32_bf16 v[68:71], v[20:23], v[216:219], v[68:71]
ds_read_b128 v[16:19], v185 offset:20480
ds_read_b128 v[20:23], v185 offset:21504
s_waitcnt lgkmcnt(6)
v_mfma_f32_16x16x32_bf16 v[32:35], a[56:59], v[24:27], v[32:35]
v_mfma_f32_16x16x32_bf16 v[36:39], a[60:63], v[24:27], v[36:39]
v_mfma_f32_16x16x32_bf16 v[40:43], a[56:59], v[28:31], v[40:43]
v_mfma_f32_16x16x32_bf16 v[44:47], a[60:63], v[28:31], v[44:47]
v_mfma_f32_16x16x32_bf16 v[48:51], v[24:27], a[184:187], v[48:51]
v_mfma_f32_16x16x32_bf16 v[56:59], v[24:27], a[188:191], v[56:59]
v_mfma_f32_16x16x32_bf16 v[52:55], v[28:31], a[184:187], v[52:55]
v_mfma_f32_16x16x32_bf16 v[60:63], v[28:31], a[188:191], v[60:63]
v_mfma_f32_16x16x32_bf16 v[64:67], v[24:27], v[220:223], v[64:67]
v_mfma_f32_16x16x32_bf16 v[68:71], v[28:31], v[220:223], v[68:71]
ds_read_b128 v[24:27], v185 offset:22528
ds_read_b128 v[28:31], v185 offset:23552
s_waitcnt lgkmcnt(6)
v_mfma_f32_16x16x32_bf16 v[32:35], a[64:67], v[0:3], v[32:35]
v_mfma_f32_16x16x32_bf16 v[36:39], a[68:71], v[0:3], v[36:39]
v_mfma_f32_16x16x32_bf16 v[40:43], a[64:67], v[4:7], v[40:43]
v_mfma_f32_16x16x32_bf16 v[44:47], a[68:71], v[4:7], v[44:47]
v_mfma_f32_16x16x32_bf16 v[48:51], v[0:3], a[192:195], v[48:51]
v_mfma_f32_16x16x32_bf16 v[56:59], v[0:3], a[196:199], v[56:59]
v_mfma_f32_16x16x32_bf16 v[52:55], v[4:7], a[192:195], v[52:55]
v_mfma_f32_16x16x32_bf16 v[60:63], v[4:7], a[196:199], v[60:63]
v_mfma_f32_16x16x32_bf16 v[64:67], v[0:3], v[224:227], v[64:67]
v_mfma_f32_16x16x32_bf16 v[68:71], v[4:7], v[224:227], v[68:71]
ds_read_b128 v[0:3], v185 offset:24576
ds_read_b128 v[4:7], v185 offset:25600
s_waitcnt lgkmcnt(6)
v_mfma_f32_16x16x32_bf16 v[32:35], a[72:75], v[8:11], v[32:35]
v_mfma_f32_16x16x32_bf16 v[36:39], a[76:79], v[8:11], v[36:39]
v_mfma_f32_16x16x32_bf16 v[40:43], a[72:75], v[12:15], v[40:43]
v_mfma_f32_16x16x32_bf16 v[44:47], a[76:79], v[12:15], v[44:47]
v_mfma_f32_16x16x32_bf16 v[48:51], v[8:11], a[200:203], v[48:51]
v_mfma_f32_16x16x32_bf16 v[56:59], v[8:11], a[204:207], v[56:59]
v_mfma_f32_16x16x32_bf16 v[52:55], v[12:15], a[200:203], v[52:55]
v_mfma_f32_16x16x32_bf16 v[60:63], v[12:15], a[204:207], v[60:63]
v_mfma_f32_16x16x32_bf16 v[64:67], v[8:11], v[228:231], v[64:67]
v_mfma_f32_16x16x32_bf16 v[68:71], v[12:15], v[228:231], v[68:71]
ds_read_b128 v[8:11], v185 offset:26624
ds_read_b128 v[12:15], v185 offset:27648
s_waitcnt lgkmcnt(6)
v_mfma_f32_16x16x32_bf16 v[32:35], a[80:83], v[16:19], v[32:35]
v_mfma_f32_16x16x32_bf16 v[36:39], a[84:87], v[16:19], v[36:39]
v_mfma_f32_16x16x32_bf16 v[40:43], a[80:83], v[20:23], v[40:43]
v_mfma_f32_16x16x32_bf16 v[44:47], a[84:87], v[20:23], v[44:47]
v_mfma_f32_16x16x32_bf16 v[48:51], v[16:19], a[208:211], v[48:51]
v_mfma_f32_16x16x32_bf16 v[56:59], v[16:19], a[212:215], v[56:59]
v_mfma_f32_16x16x32_bf16 v[52:55], v[20:23], a[208:211], v[52:55]
v_mfma_f32_16x16x32_bf16 v[60:63], v[20:23], a[212:215], v[60:63]
v_mfma_f32_16x16x32_bf16 v[64:67], v[16:19], v[232:235], v[64:67]
v_mfma_f32_16x16x32_bf16 v[68:71], v[20:23], v[232:235], v[68:71]
ds_read_b128 v[16:19], v185 offset:28672
ds_read_b128 v[20:23], v185 offset:29696
s_waitcnt lgkmcnt(6)
v_mfma_f32_16x16x32_bf16 v[32:35], a[88:91], v[24:27], v[32:35]
v_mfma_f32_16x16x32_bf16 v[36:39], a[92:95], v[24:27], v[36:39]
v_mfma_f32_16x16x32_bf16 v[40:43], a[88:91], v[28:31], v[40:43]
v_mfma_f32_16x16x32_bf16 v[44:47], a[92:95], v[28:31], v[44:47]
v_mfma_f32_16x16x32_bf16 v[48:51], v[24:27], a[216:219], v[48:51]
v_mfma_f32_16x16x32_bf16 v[56:59], v[24:27], a[220:223], v[56:59]
v_mfma_f32_16x16x32_bf16 v[52:55], v[28:31], a[216:219], v[52:55]
v_mfma_f32_16x16x32_bf16 v[60:63], v[28:31], a[220:223], v[60:63]
v_mfma_f32_16x16x32_bf16 v[64:67], v[24:27], v[236:239], v[64:67]
v_mfma_f32_16x16x32_bf16 v[68:71], v[28:31], v[236:239], v[68:71]
ds_read_b128 v[24:27], v185 offset:30720
ds_read_b128 v[28:31], v185 offset:31744
s_waitcnt lgkmcnt(6)
v_mfma_f32_16x16x32_bf16 v[32:35], a[96:99], v[0:3], v[32:35]
v_mfma_f32_16x16x32_bf16 v[36:39], a[100:103], v[0:3], v[36:39]
v_mfma_f32_16x16x32_bf16 v[40:43], a[96:99], v[4:7], v[40:43]
v_mfma_f32_16x16x32_bf16 v[44:47], a[100:103], v[4:7], v[44:47]
v_mfma_f32_16x16x32_bf16 v[48:51], v[0:3], a[224:227], v[48:51]
v_mfma_f32_16x16x32_bf16 v[56:59], v[0:3], a[228:231], v[56:59]
v_mfma_f32_16x16x32_bf16 v[52:55], v[4:7], a[224:227], v[52:55]
v_mfma_f32_16x16x32_bf16 v[60:63], v[4:7], a[228:231], v[60:63]
v_mfma_f32_16x16x32_bf16 v[64:67], v[0:3], v[240:243], v[64:67]
v_mfma_f32_16x16x32_bf16 v[68:71], v[4:7], v[240:243], v[68:71]
s_waitcnt lgkmcnt(4)
v_mfma_f32_16x16x32_bf16 v[32:35], a[104:107], v[8:11], v[32:35]
v_mfma_f32_16x16x32_bf16 v[36:39], a[108:111], v[8:11], v[36:39]
v_mfma_f32_16x16x32_bf16 v[40:43], a[104:107], v[12:15], v[40:43]
v_mfma_f32_16x16x32_bf16 v[44:47], a[108:111], v[12:15], v[44:47]
v_mfma_f32_16x16x32_bf16 v[48:51], v[8:11], a[232:235], v[48:51]
v_mfma_f32_16x16x32_bf16 v[56:59], v[8:11], a[236:239], v[56:59]
v_mfma_f32_16x16x32_bf16 v[52:55], v[12:15], a[232:235], v[52:55]
v_mfma_f32_16x16x32_bf16 v[60:63], v[12:15], a[236:239], v[60:63]
v_mfma_f32_16x16x32_bf16 v[64:67], v[8:11], v[244:247], v[64:67]
v_mfma_f32_16x16x32_bf16 v[68:71], v[12:15], v[244:247], v[68:71]
s_waitcnt lgkmcnt(2)
v_mfma_f32_16x16x32_bf16 v[32:35], a[112:115], v[16:19], v[32:35]
v_mfma_f32_16x16x32_bf16 v[36:39], a[116:119], v[16:19], v[36:39]
v_mfma_f32_16x16x32_bf16 v[40:43], a[112:115], v[20:23], v[40:43]
v_mfma_f32_16x16x32_bf16 v[44:47], a[116:119], v[20:23], v[44:47]
v_mfma_f32_16x16x32_bf16 v[48:51], v[16:19], a[240:243], v[48:51]
v_mfma_f32_16x16x32_bf16 v[56:59], v[16:19], a[244:247], v[56:59]
v_mfma_f32_16x16x32_bf16 v[52:55], v[20:23], a[240:243], v[52:55]
v_mfma_f32_16x16x32_bf16 v[60:63], v[20:23], a[244:247], v[60:63]
v_mfma_f32_16x16x32_bf16 v[64:67], v[16:19], v[248:251], v[64:67]
v_mfma_f32_16x16x32_bf16 v[68:71], v[20:23], v[248:251], v[68:71]
s_waitcnt lgkmcnt(0)
v_mfma_f32_16x16x32_bf16 v[32:35], a[120:123], v[24:27], v[32:35]
v_mfma_f32_16x16x32_bf16 v[36:39], a[124:127], v[24:27], v[36:39]
v_mfma_f32_16x16x32_bf16 v[40:43], a[120:123], v[28:31], v[40:43]
v_mfma_f32_16x16x32_bf16 v[44:47], a[124:127], v[28:31], v[44:47]
v_mfma_f32_16x16x32_bf16 v[48:51], v[24:27], a[248:251], v[48:51]
v_mfma_f32_16x16x32_bf16 v[56:59], v[24:27], a[252:255], v[56:59]
v_mfma_f32_16x16x32_bf16 v[52:55], v[28:31], a[248:251], v[52:55]
v_mfma_f32_16x16x32_bf16 v[60:63], v[28:31], a[252:255], v[60:63]
v_mfma_f32_16x16x32_bf16 v[64:67], v[24:27], v[252:255], v[64:67]
v_mfma_f32_16x16x32_bf16 v[68:71], v[28:31], v[252:255], v[68:71]
s_lshl_b32 s66, s64, 5
s_add_u32 s66, s66, s60
s_lshl_b32 s66, s66, 14
s_add_u32 s66, s66, 16777216
s_lshl_b32 s52, s3, 10
s_add_u32 s67, s66, s52
s_add_u32 s68, s67, 4096
s_lshl_b32 s52, s3, 11
s_add_u32 s66, s66, s52
s_add_u32 s66, s66, 8192
v_cvt_pk_bf16_f32 v72, v32, v36
v_cvt_pk_bf16_f32 v73, v33, v37
v_cvt_pk_bf16_f32 v74, v34, v38
v_cvt_pk_bf16_f32 v75, v35, v39
buffer_store_dwordx4 v[72:75], v176, s[36:39], s67 offen sc0 sc1
v_cvt_pk_bf16_f32 v76, v40, v44
v_cvt_pk_bf16_f32 v77, v41, v45
v_cvt_pk_bf16_f32 v78, v42, v46
v_cvt_pk_bf16_f32 v79, v43, v47
buffer_store_dwordx4 v[76:79], v176, s[36:39], s68 offen sc0 sc1
v_cvt_pk_bf16_f32 v80, v48, v49
v_cvt_pk_bf16_f32 v81, v50, v51
buffer_store_dwordx2 v[80:81], v178, s[36:39], s66 offen offset:0 sc0 sc1
v_cvt_pk_bf16_f32 v82, v52, v53
v_cvt_pk_bf16_f32 v83, v54, v55
buffer_store_dwordx2 v[82:83], v178, s[36:39], s66 offen offset:256 sc0 sc1
v_cvt_pk_bf16_f32 v84, v56, v57
v_cvt_pk_bf16_f32 v85, v58, v59
buffer_store_dwordx2 v[84:85], v178, s[36:39], s66 offen offset:1024 sc0 sc1
v_cvt_pk_bf16_f32 v86, v60, v61
v_cvt_pk_bf16_f32 v87, v62, v63
buffer_store_dwordx2 v[86:87], v178, s[36:39], s66 offen offset:1280 sc0 sc1
s_lshl_b32 s66, s60, 17
s_lshl_b32 s52, s64, 10
s_add_u32 s66, s66, s52
s_add_u32 s66, s66, 9502720
v_cvt_pk_bf16_f32 v88, v64, v65
v_cvt_pk_bf16_f32 v89, v66, v67
v_cvt_pk_bf16_f32 v90, v68, v69
v_cvt_pk_bf16_f32 v91, v70, v71
buffer_store_dwordx2 v[88:89], v180, s[36:39], s66 offen offset:0 sc0 sc1
buffer_store_dwordx2 v[90:91], v180, s[36:39], s66 offen offset:512 sc0 sc1
L_p1_1_end:
s_cmp_eq_u32 s63, 0
s_cbranch_scc0 L_p1_1_nx
s_waitcnt vmcnt(0)
s_barrier
s_cmp_lg_u32 s3, 0
s_cbranch_scc1 L_fl_5
s_mov_b64 exec, 1
v_mov_b32 v183, 1
buffer_store_dword v183, off, s[36:39], s70 sc0 sc1
s_mov_b64 exec, -1
L_fl_5:
s_add_u32 s66, s64, 7
s_lshl_b32 s52, s66, 15
s_lshl_b32 s53, s3, 8
s_add_u32 s52, s52, s53
s_lshl_b32 s53, s3, 13
s_add_u32 s53, s53, s65
s_add_u32 m0, s53, 0
s_add_u32 s54, s52, 0
buffer_load_dwordx4 v177, s[92:95], s54 offen lds
s_add_u32 m0, s53, 1024
s_add_u32 s54, s52, 16384
buffer_load_dwordx4 v177, s[92:95], s54 offen lds
s_add_u32 m0, s53, 2048
s_add_u32 s54, s52, 64
buffer_load_dwordx4 v177, s[92:95], s54 offen lds
s_add_u32 m0, s53, 3072
s_add_u32 s54, s52, 16448
buffer_load_dwordx4 v177, s[92:95], s54 offen lds
s_add_u32 m0, s53, 4096
s_add_u32 s54, s52, 128
buffer_load_dwordx4 v177, s[92:95], s54 offen lds
s_add_u32 m0, s53, 5120
s_add_u32 s54, s52, 16512
buffer_load_dwordx4 v177, s[92:95], s54 offen lds
s_add_u32 m0, s53, 6144
s_add_u32 s54, s52, 192
buffer_load_dwordx4 v177, s[92:95], s54 offen lds
s_add_u32 m0, s53, 7168
s_add_u32 s54, s52, 16576
buffer_load_dwordx4 v177, s[92:95], s54 offen lds
L_p1_1_nx:
s_waitcnt lgkmcnt(0)
s_add_u32 s63, s63, 1
s_add_u32 s64, s64, 7
s_cmp_lt_u32 s64, 64
s_cbranch_scc1 L_p1_1
L_p1_done:
s_waitcnt vmcnt(0)
s_barrier
s_cmp_lg_u32 s3, 0
s_cbranch_scc1 L_fl_6
s_mov_b64 exec, 1
v_mov_b32 v183, 1
buffer_store_dword v183, off, s[36:39], s70 sc0 sc1
s_mov_b64 exec, -1
L_fl_6:
s_lshl_b32 s66, s60, 3
s_add_u32 s66, s66, s61
s_lshl_b32 s66, s66, 2
s_add_u32 s66, s66, 24576
s_cmp_lg_u32 s3, 1
s_cbranch_scc1 L_fl_7
s_mov_b64 exec, 1
v_mov_b32 v183, 1
buffer_store_dword v183, off, s[36:39], s66 sc0 sc1
s_mov_b64 exec, -1
L_fl_7:
s_mov_b32 s44, s18
s_mov_b32 s45, s19
s_mov_b32 s46, 4194304
s_mov_b32 s47, 0x20000
s_mov_b32 s48, s24
s_mov_b32 s49, s25
s_mov_b32 s50, 4194304
s_mov_b32 s51, 0x20000
v_and_b32 v1, 31, v191
v_lshrrev_b32 v2, 5, v191
s_lshl_b32 s52, s3, 8
v_lshlrev_b32 v182, 13, v2
v_lshl_add_u32 v182, v1, 3, v182
v_add_u32 v182, s52, v182
s_mul_i32 s66, s3, 16640
s_add_u32 s66, s66, 64512
v_lshlrev_b32 v3, 8, v2
v_lshl_add_u32 v3, v1, 4, v3
v_add_u32 v4, 512, v3
v_mov_b32 v5, 1024
v_cmp_gt_u32 vcc, 16, v1
v_mov_b32 v8, 0x3f803f80
v_mov_b32 v9, 0x3f803f80
v_cndmask_b32 v3, v5, v3, vcc
v_cndmask_b32 v4, v5, v4, vcc
v_add_u32 v174, s66, v3
v_add_u32 v175, s66, v4
v_mov_b32 v10, 0x3f803f80
v_mov_b32 v11, 0x3f803f80
v_and_b32 v5, 15, v1
v_mul_u32_u24 v5, 1040, v5
v_add_u32 v5, s66, v5
ds_write_b128 v5, v[8:11] offset:1024
s_mov_b32 s52, 0
buffer_load_dword v192, v181, s[44:47], s52 offen
s_mov_b32 s52, 8192
buffer_load_dword v193, v181, s[44:47], s52 offen
s_mov_b32 s52, 16384
buffer_load_dword v194, v181, s[44:47], s52 offen
s_mov_b32 s52, 24576
buffer_load_dword v195, v181, s[44:47], s52 offen
s_mov_b32 s52, 32768
buffer_load_dword v196, v181, s[44:47], s52 offen
s_mov_b32 s52, 40960
buffer_load_dword v197, v181, s[44:47], s52 offen
s_mov_b32 s52, 49152
buffer_load_dword v198, v181, s[44:47], s52 offen
s_mov_b32 s52, 57344
buffer_load_dword v199, v181, s[44:47], s52 offen
s_mov_b32 s52, 262144
buffer_load_dword v200, v181, s[44:47], s52 offen
s_mov_b32 s52, 270336
buffer_load_dword v201, v181, s[44:47], s52 offen
s_mov_b32 s52, 278528
buffer_load_dword v202, v181, s[44:47], s52 offen
s_mov_b32 s52, 286720
buffer_load_dword v203, v181, s[44:47], s52 offen
s_mov_b32 s52, 294912
buffer_load_dword v204, v181, s[44:47], s52 offen
s_mov_b32 s52, 303104
buffer_load_dword v205, v181, s[44:47], s52 offen
s_mov_b32 s52, 311296
buffer_load_dword v206, v181, s[44:47], s52 offen
s_mov_b32 s52, 319488
buffer_load_dword v207, v181, s[44:47], s52 offen
s_mov_b32 s52, 524288
buffer_load_dword v208, v181, s[44:47], s52 offen
s_mov_b32 s52, 532480
buffer_load_dword v209, v181, s[44:47], s52 offen
s_mov_b32 s52, 540672
buffer_load_dword v210, v181, s[44:47], s52 offen
s_mov_b32 s52, 548864
buffer_load_dword v211, v181, s[44:47], s52 offen
s_mov_b32 s52, 557056
buffer_load_dword v212, v181, s[44:47], s52 offen
s_mov_b32 s52, 565248
buffer_load_dword v213, v181, s[44:47], s52 offen
s_mov_b32 s52, 573440
buffer_load_dword v214, v181, s[44:47], s52 offen
s_mov_b32 s52, 581632
buffer_load_dword v215, v181, s[44:47], s52 offen
s_mov_b32 s52, 786432
buffer_load_dword v216, v181, s[44:47], s52 offen
s_mov_b32 s52, 794624
buffer_load_dword v217, v181, s[44:47], s52 offen
s_mov_b32 s52, 802816
buffer_load_dword v218, v181, s[44:47], s52 offen
s_mov_b32 s52, 811008
buffer_load_dword v219, v181, s[44:47], s52 offen
s_mov_b32 s52, 819200
buffer_load_dword v220, v181, s[44:47], s52 offen
s_mov_b32 s52, 827392
buffer_load_dword v221, v181, s[44:47], s52 offen
s_mov_b32 s52, 835584
buffer_load_dword v222, v181, s[44:47], s52 offen
s_mov_b32 s52, 843776
buffer_load_dword v223, v181, s[44:47], s52 offen
s_mov_b32 s64, s61
s_mov_b32 s65, 0
s_lshl_b32 s52, s64, 15
s_lshl_b32 s53, s3, 8
s_add_u32 s52, s52, s53
s_lshl_b32 s53, s3, 13
s_add_u32 s53, s53, s65
s_add_u32 m0, s53, 0
s_add_u32 s54, s52, 0
buffer_load_dwordx4 v177, s[92:95], s54 offen lds
s_add_u32 m0, s53, 1024
s_add_u32 s54, s52, 16384
buffer_load_dwordx4 v177, s[92:95], s54 offen lds
s_add_u32 m0, s53, 2048
s_add_u32 s54, s52, 64
buffer_load_dwordx4 v177, s[92:95], s54 offen lds
s_add_u32 m0, s53, 3072
s_add_u32 s54, s52, 16448
buffer_load_dwordx4 v177, s[92:95], s54 offen lds
s_add_u32 m0, s53, 4096
s_add_u32 s54, s52, 128
buffer_load_dwordx4 v177, s[92:95], s54 offen lds
s_add_u32 m0, s53, 5120
s_add_u32 s54, s52, 16512
buffer_load_dwordx4 v177, s[92:95], s54 offen lds
s_add_u32 m0, s53, 6144
s_add_u32 s54, s52, 192
buffer_load_dwordx4 v177, s[92:95], s54 offen lds
s_add_u32 m0, s53, 7168
s_add_u32 s54, s52, 16576
buffer_load_dwordx4 v177, s[92:95], s54 offen lds
s_lshl_b32 s67, s60, 5
s_add_u32 s67, s67, 24576
v_min_u32 v183, 6, v191
v_lshlrev_b32 v183, 2, v183
L_po_8:
buffer_load_dword v184, v183, s[36:39], s67 offen sc1
s_waitcnt vmcnt(0)
v_cmp_eq_u32 vcc, 0, v184
s_cbranch_vccz L_po_8_ok
s_sub_u32 s56, s56, 1
s_cbranch_scc0 L_po_8
s_endpgm
L_po_8_ok:
s_lshl_b32 s67, s60, 17
s_lshl_b32 s52, s3, 14
s_add_u32 s67, s67, s52
s_add_u32 s67, s67, 9437184
buffer_load_dwordx4 v[0:3], v176, s[36:39], s67 offen offset:0 sc1
buffer_load_dwordx4 v[4:7], v176, s[36:39], s67 offen offset:1024 sc1
buffer_load_dwordx4 v[8:11], v176, s[36:39], s67 offen offset:2048 sc1
buffer_load_dwordx4 v[12:15], v176, s[36:39], s67 offen offset:3072 sc1
s_add_u32 s67, s67, 4096
buffer_load_dwordx4 v[16:19], v176, s[36:39], s67 offen offset:0 sc1
buffer_load_dwordx4 v[20:23], v176, s[36:39], s67 offen offset:1024 sc1
buffer_load_dwordx4 v[24:27], v176, s[36:39], s67 offen offset:2048 sc1
buffer_load_dwordx4 v[28:31], v176, s[36:39], s67 offen offset:3072 sc1
s_add_u32 s67, s67, 4096
buffer_load_dwordx4 v[32:35], v176, s[36:39], s67 offen offset:0 sc1
buffer_load_dwordx4 v[36:39], v176, s[36:39], s67 offen offset:1024 sc1
buffer_load_dwordx4 v[40:43], v176, s[36:39], s67 offen offset:2048 sc1
buffer_load_dwordx4 v[44:47], v176, s[36:39], s67 offen offset:3072 sc1
s_add_u32 s67, s67, 4096
buffer_load_dwordx4 v[48:51], v176, s[36:39], s67 offen offset:0 sc1
buffer_load_dwordx4 v[52:55], v176, s[36:39], s67 offen offset:1024 sc1
buffer_load_dwordx4 v[56:59], v176, s[36:39], s67 offen offset:2048 sc1
buffer_load_dwordx4 v[60:63], v176, s[36:39], s67 offen offset:3072 sc1
s_add_u32 s67, s67, 53248
s_add_u32 m0, s66, 0
s_add_u32 s52, s67, 0
buffer_load_dwordx4 v176, s[36:39], s52 offen sc1 lds
s_add_u32 m0, s66, 1040
s_add_u32 s52, s67, 1024
buffer_load_dwordx4 v176, s[36:39], s52 offen sc1 lds
s_add_u32 m0, s66, 2080
s_add_u32 s52, s67, 2048
buffer_load_dwordx4 v176, s[36:39], s52 offen sc1 lds
s_add_u32 m0, s66, 3120
s_add_u32 s52, s67, 3072
buffer_load_dwordx4 v176, s[36:39], s52 offen sc1 lds
s_add_u32 m0, s66, 4160
s_add_u32 s52, s67, 4096
buffer_load_dwordx4 v176, s[36:39], s52 offen sc1 lds
s_add_u32 m0, s66, 5200
s_add_u32 s52, s67, 5120
buffer_load_dwordx4 v176, s[36:39], s52 offen sc1 lds
s_add_u32 m0, s66, 6240
s_add_u32 s52, s67, 6144
buffer_load_dwordx4 v176, s[36:39], s52 offen sc1 lds
s_add_u32 m0, s66, 7280
s_add_u32 s52, s67, 7168
buffer_load_dwordx4 v176, s[36:39], s52 offen sc1 lds
s_add_u32 m0, s66, 8320
s_add_u32 s52, s67, 8192
buffer_load_dwordx4 v176, s[36:39], s52 offen sc1 lds
s_add_u32 m0, s66, 9360
s_add_u32 s52, s67, 9216
buffer_load_dwordx4 v176, s[36:39], s52 offen sc1 lds
s_add_u32 m0, s66, 10400
s_add_u32 s52, s67, 10240
buffer_load_dwordx4 v176, s[36:39], s52 offen sc1 lds
s_add_u32 m0, s66, 11440
s_add_u32 s52, s67, 11264
buffer_load_dwordx4 v176, s[36:39], s52 offen sc1 lds
s_add_u32 m0, s66, 12480
s_add_u32 s52, s67, 12288
buffer_load_dwordx4 v176, s[36:39], s52 offen sc1 lds
s_add_u32 m0, s66, 13520
s_add_u32 s52, s67, 13312
buffer_load_dwordx4 v176, s[36:39], s52 offen sc1 lds
s_add_u32 m0, s66, 14560
s_add_u32 s52, s67, 14336
buffer_load_dwordx4 v176, s[36:39], s52 offen sc1 lds
s_add_u32 m0, s66, 15600
s_add_u32 s52, s67, 15360
buffer_load_dwordx4 v176, s[36:39], s52 offen sc1 lds
s_mov_b32 s63, 0
L_p2:
s_lshl_b32 s52, s63, 10
s_add_u32 s52, s52, 131072
v_add_u32 v183, s52, v176
ds_read_b128 v[152:155], v183 offset:0
s_waitcnt vmcnt(0)
s_cmp_eq_u32 s63, 1
s_cbranch_scc1 L_ch1
s_cmp_eq_u32 s63, 2
s_cbranch_scc1 L_ch2
s_cmp_eq_u32 s63, 3
s_cbranch_scc1 L_ch3
s_cmp_eq_u32 s63, 4
s_cbranch_scc1 L_ch4
s_cmp_eq_u32 s63, 5
s_cbranch_scc1 L_ch5
s_cmp_eq_u32 s63, 6
s_cbranch_scc1 L_ch6
s_cmp_eq_u32 s63, 7
s_cbranch_scc1 L_ch7
L_ch_ret:
s_waitcnt lgkmcnt(0)
v_mfma_f32_32x32x16_bf16 v[64:79], v[0:3], v[152:155], 0
v_mfma_f32_32x32x16_bf16 v[80:95], v[4:7], v[152:155], 0
ds_read_b128 v[156:159], v174 offset:0
ds_read_b128 v[160:163], v175 offset:0
s_nop 7
v_mfma_f32_32x32x16_bf16 v[96:111], v[8:11], v[152:155], 0
v_max_f32 v172, v64, v65
v_max_f32 v173, v66, v67
v_max3_f32 v172, v172, v68, v69
v_max3_f32 v173, v173, v70, v71
v_max3_f32 v172, v172, v72, v73
v_max3_f32 v173, v173, v74, v75
v_max3_f32 v172, v172, v76, v77
v_max3_f32 v173, v173, v78, v79
v_mfma_f32_32x32x16_bf16 v[64:79], v[12:15], v[152:155], 0
v_max3_f32 v172, v172, v80, v81
v_max3_f32 v173, v173, v82, v83
v_max3_f32 v172, v172, v84, v85
v_max3_f32 v173, v173, v86, v87
v_max3_f32 v172, v172, v88, v89
v_max3_f32 v173, v173, v90, v91
v_max3_f32 v172, v172, v92, v93
v_max3_f32 v173, v173, v94, v95
v_mfma_f32_32x32x16_bf16 v[80:95], v[16:19], v[152:155], 0
v_max3_f32 v172, v172, v96, v97
v_max3_f32 v173, v173, v98, v99
v_max3_f32 v172, v172, v100, v101
v_max3_f32 v173, v173, v102, v103
v_max3_f32 v172, v172, v104, v105
v_max3_f32 v173, v173, v106, v107
v_max3_f32 v172, v172, v108, v109
v_max3_f32 v173, v173, v110, v111
v_mfma_f32_32x32x16_bf16 v[96:111], v[20:23], v[152:155], 0
v_max3_f32 v172, v172, v64, v65
v_max3_f32 v173, v173, v66, v67
v_max3_f32 v172, v172, v68, v69
v_max3_f32 v173, v173, v70, v71
v_max3_f32 v172, v172, v72, v73
v_max3_f32 v173, v173, v74, v75
v_max3_f32 v172, v172, v76, v77
v_max3_f32 v173, v173, v78, v79
v_mfma_f32_32x32x16_bf16 v[64:79], v[24:27], v[152:155], 0
v_max3_f32 v172, v172, v80, v81
v_max3_f32 v173, v173, v82, v83
v_max3_f32 v172, v172, v84, v85
v_max3_f32 v173, v173, v86, v87
v_max3_f32 v172, v172, v88, v89
v_max3_f32 v173, v173, v90, v91
v_max3_f32 v172, v172, v92, v93
v_max3_f32 v173, v173, v94, v95
v_mfma_f32_32x32x16_bf16 v[80:95], v[28:31], v[152:155], 0
v_max3_f32 v172, v172, v96, v97
v_max3_f32 v173, v173, v98, v99
v_max3_f32 v172, v172, v100, v101
v_max3_f32 v173, v173, v102, v103
v_max3_f32 v172, v172, v104, v105
v_max3_f32 v173, v173, v106, v107
v_max3_f32 v172, v172, v108, v109
v_max3_f32 v173, v173, v110, v111
v_mfma_f32_32x32x16_bf16 v[96:111], v[32:35], v[152:155], 0
v_max3_f32 v172, v172, v64, v65
v_max3_f32 v173, v173, v66, v67
v_max3_f32 v172, v172, v68, v69
v_max3_f32 v173, v173, v70, v71
v_max3_f32 v172, v172, v72, v73
v_max3_f32 v173, v173, v74, v75
v_max3_f32 v172, v172, v76, v77
v_max3_f32 v173, v173, v78, v79
v_mfma_f32_32x32x16_bf16 v[64:79], v[36:39], v[152:155], 0
v_max3_f32 v172, v172, v80, v81
v_max3_f32 v173, v173, v82, v83
v_max3_f32 v172, v172, v84, v85
v_max3_f32 v173, v173, v86, v87
v_max3_f32 v172, v172, v88, v89
v_max3_f32 v173, v173, v90, v91
v_max3_f32 v172, v172, v92, v93
v_max3_f32 v173, v173, v94, v95
v_mfma_f32_32x32x16_bf16 v[80:95], v[40:43], v[152:155], 0
v_max3_f32 v172, v172, v96, v97
v_max3_f32 v173, v173, v98, v99
v_max3_f32 v172, v172, v100, v101
v_max3_f32 v173, v173, v102, v103
v_max3_f32 v172, v172, v104, v105
v_max3_f32 v173, v173, v106, v107
v_max3_f32 v172, v172, v108, v109
v_max3_f32 v173, v173, v110, v111
v_mfma_f32_32x32x16_bf16 v[96:111], v[44:47], v[152:155], 0
v_max3_f32 v172, v172, v64, v65
v_max3_f32 v173, v173, v66, v67
v_max3_f32 v172, v172, v68, v69
v_max3_f32 v173, v173, v70, v71
v_max3_f32 v172, v172, v72, v73
v_max3_f32 v173, v173, v74, v75
v_max3_f32 v172, v172, v76, v77
v_max3_f32 v173, v173, v78, v79
v_mfma_f32_32x32x16_bf16 v[64:79], v[48:51], v[152:155], 0
v_max3_f32 v172, v172, v80, v81
v_max3_f32 v173, v173, v82, v83
v_max3_f32 v172, v172, v84, v85
v_max3_f32 v173, v173, v86, v87
v_max3_f32 v172, v172, v88, v89
v_max3_f32 v173, v173, v90, v91
v_max3_f32 v172, v172, v92, v93
v_max3_f32 v173, v173, v94, v95
v_mfma_f32_32x32x16_bf16 v[80:95], v[52:55], v[152:155], 0
v_max3_f32 v172, v172, v96, v97
v_max3_f32 v173, v173, v98, v99
v_max3_f32 v172, v172, v100, v101
v_max3_f32 v173, v173, v102, v103
v_max3_f32 v172, v172, v104, v105
v_max3_f32 v173, v173, v106, v107
v_max3_f32 v172, v172, v108, v109
v_max3_f32 v173, v173, v110, v111
v_mfma_f32_32x32x16_bf16 v[96:111], v[56:59], v[152:155], 0
v_max3_f32 v172, v172, v64, v65
v_max3_f32 v173, v173, v66, v67
v_max3_f32 v172, v172, v68, v69
v_max3_f32 v173, v173, v70, v71
v_max3_f32 v172, v172, v72, v73
v_max3_f32 v173, v173, v74, v75
v_max3_f32 v172, v172, v76, v77
v_max3_f32 v173, v173, v78, v79
v_mfma_f32_32x32x16_bf16 v[64:79], v[60:63], v[152:155], 0
v_max3_f32 v172, v172, v80, v81
v_max3_f32 v173, v173, v82, v83
v_max3_f32 v172, v172, v84, v85
v_max3_f32 v173, v173, v86, v87
v_max3_f32 v172, v172, v88, v89
v_max3_f32 v173, v173, v90, v91
v_max3_f32 v172, v172, v92, v93
v_max3_f32 v173, v173, v94, v95
v_max3_f32 v172, v172, v96, v97
v_max3_f32 v173, v173, v98, v99
v_max3_f32 v172, v172, v100, v101
v_max3_f32 v173, v173, v102, v103
v_max3_f32 v172, v172, v104, v105
v_max3_f32 v173, v173, v106, v107
v_max3_f32 v172, v172, v108, v109
v_max3_f32 v173, v173, v110, v111
s_nop 3
v_max3_f32 v172, v172, v64, v65
v_max3_f32 v173, v173, v66, v67
v_max3_f32 v172, v172, v68, v69
v_max3_f32 v173, v173, v70, v71
v_max3_f32 v172, v172, v72, v73
v_max3_f32 v173, v173, v74, v75
v_max3_f32 v172, v172, v76, v77
v_max3_f32 v173, v173, v78, v79
v_max_f32 v172, v172, v173
v_max_f32 v173, v172, v172
s_nop 1
v_permlane32_swap_b32 v172, v173
v_max_f32 v172, v172, v173
v_sub_f32 v112, 0, v172
v_sub_f32 v113, 0, v172
v_sub_f32 v114, 0, v172
v_sub_f32 v115, 0, v172
v_sub_f32 v116, 0, v172
v_sub_f32 v117, 0, v172
v_sub_f32 v118, 0, v172
v_sub_f32 v119, 0, v172
v_sub_f32 v120, 0, v172
v_sub_f32 v121, 0, v172
v_sub_f32 v122, 0, v172
v_sub_f32 v123, 0, v172
v_sub_f32 v124, 0, v172
v_sub_f32 v125, 0, v172
v_sub_f32 v126, 0, v172
v_sub_f32 v127, 0, v172
s_nop 1
v_mfma_f32_32x32x16_bf16 v[64:79], v[0:3], v[152:155], v[112:127]
s_nop 7
v_mfma_f32_32x32x16_bf16 v[80:95], v[4:7], v[152:155], v[112:127]
ds_read_b128 v[164:167], v174 offset:1040
ds_read_b128 v[168:171], v175 offset:1040
s_nop 1
v_exp_f32 v64, v64
v_exp_f32 v65, v65
v_exp_f32 v66, v66
v_exp_f32 v67, v67
v_exp_f32 v68, v68
v_exp_f32 v69, v69
v_exp_f32 v70, v70
v_exp_f32 v71, v71
v_exp_f32 v72, v72
v_cvt_pk_bf16_f32 v144, v64, v65
v_cvt_pk_bf16_f32 v145, v66, v67
v_cvt_pk_bf16_f32 v146, v68, v69
v_cvt_pk_bf16_f32 v147, v70, v71
v_exp_f32 v73, v73
v_exp_f32 v74, v74
s_waitcnt lgkmcnt(2)
v_mfma_f32_32x32x16_bf16 v[128:143], v[156:159], v[144:147], 0
v_exp_f32 v75, v75
v_exp_f32 v76, v76
v_exp_f32 v77, v77
v_exp_f32 v78, v78
v_exp_f32 v79, v79
v_cvt_pk_bf16_f32 v148, v72, v73
v_cvt_pk_bf16_f32 v149, v74, v75
v_cvt_pk_bf16_f32 v150, v76, v77
v_cvt_pk_bf16_f32 v151, v78, v79
s_nop 1
v_mfma_f32_32x32x16_bf16 v[128:143], v[160:163], v[148:151], v[128:143]
v_mfma_f32_32x32x16_bf16 v[64:79], v[8:11], v[152:155], v[112:127]
ds_read_b128 v[156:159], v174 offset:2080
ds_read_b128 v[160:163], v175 offset:2080
v_exp_f32 v80, v80
v_exp_f32 v81, v81
v_exp_f32 v82, v82
v_exp_f32 v83, v83
v_exp_f32 v84, v84
v_exp_f32 v85, v85
v_exp_f32 v86, v86
v_exp_f32 v87, v87
v_exp_f32 v88, v88
v_cvt_pk_bf16_f32 v144, v80, v81
v_cvt_pk_bf16_f32 v145, v82, v83
v_cvt_pk_bf16_f32 v146, v84, v85
v_cvt_pk_bf16_f32 v147, v86, v87
v_exp_f32 v89, v89
v_exp_f32 v90, v90
s_waitcnt lgkmcnt(2)
v_mfma_f32_32x32x16_bf16 v[128:143], v[164:167], v[144:147], v[128:143]
v_exp_f32 v91, v91
v_exp_f32 v92, v92
v_exp_f32 v93, v93
v_exp_f32 v94, v94
v_exp_f32 v95, v95
v_cvt_pk_bf16_f32 v148, v88, v89
v_cvt_pk_bf16_f32 v149, v90, v91
v_cvt_pk_bf16_f32 v150, v92, v93
v_cvt_pk_bf16_f32 v151, v94, v95
s_nop 1
v_mfma_f32_32x32x16_bf16 v[128:143], v[168:171], v[148:151], v[128:143]
v_mfma_f32_32x32x16_bf16 v[80:95], v[12:15], v[152:155], v[112:127]
ds_read_b128 v[164:167], v174 offset:3120
ds_read_b128 v[168:171], v175 offset:3120
v_exp_f32 v64, v64
v_exp_f32 v65, v65
v_exp_f32 v66, v66
v_exp_f32 v67, v67
v_exp_f32 v68, v68
v_exp_f32 v69, v69
v_exp_f32 v70, v70
v_exp_f32 v71, v71
v_exp_f32 v72, v72
v_cvt_pk_bf16_f32 v144, v64, v65
v_cvt_pk_bf16_f32 v145, v66, v67
v_cvt_pk_bf16_f32 v146, v68, v69
v_cvt_pk_bf16_f32 v147, v70, v71
v_exp_f32 v73, v73
v_exp_f32 v74, v74
s_waitcnt lgkmcnt(2)
v_mfma_f32_32x32x16_bf16 v[128:143], v[156:159], v[144:147], v[128:143]
v_exp_f32 v75, v75
v_exp_f32 v76, v76
v_exp_f32 v77, v77
v_exp_f32 v78, v78
v_exp_f32 v79, v79
v_cvt_pk_bf16_f32 v148, v72, v73
v_cvt_pk_bf16_f32 v149, v74, v75
v_cvt_pk_bf16_f32 v150, v76, v77
v_cvt_pk_bf16_f32 v151, v78, v79
s_nop 1
v_mfma_f32_32x32x16_bf16 v[128:143], v[160:163], v[148:151], v[128:143]
v_mfma_f32_32x32x16_bf16 v[64:79], v[16:19], v[152:155], v[112:127]
ds_read_b128 v[156:159], v174 offset:4160
ds_read_b128 v[160:163], v175 offset:4160
v_exp_f32 v80, v80
v_exp_f32 v81, v81
v_exp_f32 v82, v82
v_exp_f32 v83, v83
v_exp_f32 v84, v84
v_exp_f32 v85, v85
v_exp_f32 v86, v86
v_exp_f32 v87, v87
v_exp_f32 v88, v88
v_cvt_pk_bf16_f32 v144, v80, v81
v_cvt_pk_bf16_f32 v145, v82, v83
v_cvt_pk_bf16_f32 v146, v84, v85
v_cvt_pk_bf16_f32 v147, v86, v87
v_exp_f32 v89, v89
v_exp_f32 v90, v90
s_waitcnt lgkmcnt(2)
v_mfma_f32_32x32x16_bf16 v[128:143], v[164:167], v[144:147], v[128:143]
v_exp_f32 v91, v91
v_exp_f32 v92, v92
v_exp_f32 v93, v93
v_exp_f32 v94, v94
v_exp_f32 v95, v95
v_cvt_pk_bf16_f32 v148, v88, v89
v_cvt_pk_bf16_f32 v149, v90, v91
v_cvt_pk_bf16_f32 v150, v92, v93
v_cvt_pk_bf16_f32 v151, v94, v95
s_nop 1
v_mfma_f32_32x32x16_bf16 v[128:143], v[168:171], v[148:151], v[128:143]
v_mfma_f32_32x32x16_bf16 v[80:95], v[20:23], v[152:155], v[112:127]
ds_read_b128 v[164:167], v174 offset:5200
ds_read_b128 v[168:171], v175 offset:5200
v_exp_f32 v64, v64
v_exp_f32 v65, v65
v_exp_f32 v66, v66
v_exp_f32 v67, v67
v_exp_f32 v68, v68
v_exp_f32 v69, v69
v_exp_f32 v70, v70
v_exp_f32 v71, v71
v_exp_f32 v72, v72
v_cvt_pk_bf16_f32 v144, v64, v65
v_cvt_pk_bf16_f32 v145, v66, v67
v_cvt_pk_bf16_f32 v146, v68, v69
v_cvt_pk_bf16_f32 v147, v70, v71
v_exp_f32 v73, v73
v_exp_f32 v74, v74
s_waitcnt lgkmcnt(2)
v_mfma_f32_32x32x16_bf16 v[128:143], v[156:159], v[144:147], v[128:143]
v_exp_f32 v75, v75
v_exp_f32 v76, v76
v_exp_f32 v77, v77
v_exp_f32 v78, v78
v_exp_f32 v79, v79
v_cvt_pk_bf16_f32 v148, v72, v73
v_cvt_pk_bf16_f32 v149, v74, v75
v_cvt_pk_bf16_f32 v150, v76, v77
v_cvt_pk_bf16_f32 v151, v78, v79
s_nop 1
v_mfma_f32_32x32x16_bf16 v[128:143], v[160:163], v[148:151], v[128:143]
v_mfma_f32_32x32x16_bf16 v[64:79], v[24:27], v[152:155], v[112:127]
ds_read_b128 v[156:159], v174 offset:6240
ds_read_b128 v[160:163], v175 offset:6240
v_exp_f32 v80, v80
v_exp_f32 v81, v81
v_exp_f32 v82, v82
v_exp_f32 v83, v83
v_exp_f32 v84, v84
v_exp_f32 v85, v85
v_exp_f32 v86, v86
v_exp_f32 v87, v87
v_exp_f32 v88, v88
v_cvt_pk_bf16_f32 v144, v80, v81
v_cvt_pk_bf16_f32 v145, v82, v83
v_cvt_pk_bf16_f32 v146, v84, v85
v_cvt_pk_bf16_f32 v147, v86, v87
v_exp_f32 v89, v89
v_exp_f32 v90, v90
s_waitcnt lgkmcnt(2)
v_mfma_f32_32x32x16_bf16 v[128:143], v[164:167], v[144:147], v[128:143]
v_exp_f32 v91, v91
v_exp_f32 v92, v92
v_exp_f32 v93, v93
v_exp_f32 v94, v94
v_exp_f32 v95, v95
v_cvt_pk_bf16_f32 v148, v88, v89
v_cvt_pk_bf16_f32 v149, v90, v91
v_cvt_pk_bf16_f32 v150, v92, v93
v_cvt_pk_bf16_f32 v151, v94, v95
s_nop 1
v_mfma_f32_32x32x16_bf16 v[128:143], v[168:171], v[148:151], v[128:143]
v_mfma_f32_32x32x16_bf16 v[80:95], v[28:31], v[152:155], v[112:127]
ds_read_b128 v[164:167], v174 offset:7280
ds_read_b128 v[168:171], v175 offset:7280
v_exp_f32 v64, v64
v_exp_f32 v65, v65
v_exp_f32 v66, v66
v_exp_f32 v67, v67
v_exp_f32 v68, v68
v_exp_f32 v69, v69
v_exp_f32 v70, v70
v_exp_f32 v71, v71
v_exp_f32 v72, v72
v_cvt_pk_bf16_f32 v144, v64, v65
v_cvt_pk_bf16_f32 v145, v66, v67
v_cvt_pk_bf16_f32 v146, v68, v69
v_cvt_pk_bf16_f32 v147, v70, v71
v_exp_f32 v73, v73
v_exp_f32 v74, v74
s_waitcnt lgkmcnt(2)
v_mfma_f32_32x32x16_bf16 v[128:143], v[156:159], v[144:147], v[128:143]
v_exp_f32 v75, v75
v_exp_f32 v76, v76
v_exp_f32 v77, v77
v_exp_f32 v78, v78
v_exp_f32 v79, v79
v_cvt_pk_bf16_f32 v148, v72, v73
v_cvt_pk_bf16_f32 v149, v74, v75
v_cvt_pk_bf16_f32 v150, v76, v77
v_cvt_pk_bf16_f32 v151, v78, v79
s_nop 1
v_mfma_f32_32x32x16_bf16 v[128:143], v[160:163], v[148:151], v[128:143]
v_mfma_f32_32x32x16_bf16 v[64:79], v[32:35], v[152:155], v[112:127]
ds_read_b128 v[156:159], v174 offset:8320
ds_read_b128 v[160:163], v175 offset:8320
v_exp_f32 v80, v80
v_exp_f32 v81, v81
v_exp_f32 v82, v82
v_exp_f32 v83, v83
v_exp_f32 v84, v84
v_exp_f32 v85, v85
v_exp_f32 v86, v86
v_exp_f32 v87, v87
v_exp_f32 v88, v88
v_cvt_pk_bf16_f32 v144, v80, v81
v_cvt_pk_bf16_f32 v145, v82, v83
v_cvt_pk_bf16_f32 v146, v84, v85
v_cvt_pk_bf16_f32 v147, v86, v87
v_exp_f32 v89, v89
v_exp_f32 v90, v90
s_waitcnt lgkmcnt(2)
v_mfma_f32_32x32x16_bf16 v[128:143], v[164:167], v[144:147], v[128:143]
v_exp_f32 v91, v91
v_exp_f32 v92, v92
v_exp_f32 v93, v93
v_exp_f32 v94, v94
v_exp_f32 v95, v95
v_cvt_pk_bf16_f32 v148, v88, v89
v_cvt_pk_bf16_f32 v149, v90, v91
v_cvt_pk_bf16_f32 v150, v92, v93
v_cvt_pk_bf16_f32 v151, v94, v95
s_nop 1
v_mfma_f32_32x32x16_bf16 v[128:143], v[168:171], v[148:151], v[128:143]
v_mfma_f32_32x32x16_bf16 v[80:95], v[36:39], v[152:155], v[112:127]
ds_read_b128 v[164:167], v174 offset:9360
ds_read_b128 v[168:171], v175 offset:9360
v_exp_f32 v64, v64
v_exp_f32 v65, v65
v_exp_f32 v66, v66
v_exp_f32 v67, v67
v_exp_f32 v68, v68
v_exp_f32 v69, v69
v_exp_f32 v70, v70
v_exp_f32 v71, v71
v_exp_f32 v72, v72
v_cvt_pk_bf16_f32 v144, v64, v65
v_cvt_pk_bf16_f32 v145, v66, v67
v_cvt_pk_bf16_f32 v146, v68, v69
v_cvt_pk_bf16_f32 v147, v70, v71
v_exp_f32 v73, v73
v_exp_f32 v74, v74
s_waitcnt lgkmcnt(2)
v_mfma_f32_32x32x16_bf16 v[128:143], v[156:159], v[144:147], v[128:143]
v_exp_f32 v75, v75
v_exp_f32 v76, v76
v_exp_f32 v77, v77
v_exp_f32 v78, v78
v_exp_f32 v79, v79
v_cvt_pk_bf16_f32 v148, v72, v73
v_cvt_pk_bf16_f32 v149, v74, v75
v_cvt_pk_bf16_f32 v150, v76, v77
v_cvt_pk_bf16_f32 v151, v78, v79
s_nop 1
v_mfma_f32_32x32x16_bf16 v[128:143], v[160:163], v[148:151], v[128:143]
v_mfma_f32_32x32x16_bf16 v[64:79], v[40:43], v[152:155], v[112:127]
ds_read_b128 v[156:159], v174 offset:10400
ds_read_b128 v[160:163], v175 offset:10400
v_exp_f32 v80, v80
v_exp_f32 v81, v81
v_exp_f32 v82, v82
v_exp_f32 v83, v83
v_exp_f32 v84, v84
v_exp_f32 v85, v85
v_exp_f32 v86, v86
v_exp_f32 v87, v87
v_exp_f32 v88, v88
v_cvt_pk_bf16_f32 v144, v80, v81
v_cvt_pk_bf16_f32 v145, v82, v83
v_cvt_pk_bf16_f32 v146, v84, v85
v_cvt_pk_bf16_f32 v147, v86, v87
v_exp_f32 v89, v89
v_exp_f32 v90, v90
s_waitcnt lgkmcnt(2)
v_mfma_f32_32x32x16_bf16 v[128:143], v[164:167], v[144:147], v[128:143]
v_exp_f32 v91, v91
v_exp_f32 v92, v92
v_exp_f32 v93, v93
v_exp_f32 v94, v94
v_exp_f32 v95, v95
v_cvt_pk_bf16_f32 v148, v88, v89
v_cvt_pk_bf16_f32 v149, v90, v91
v_cvt_pk_bf16_f32 v150, v92, v93
v_cvt_pk_bf16_f32 v151, v94, v95
s_nop 1
v_mfma_f32_32x32x16_bf16 v[128:143], v[168:171], v[148:151], v[128:143]
v_mfma_f32_32x32x16_bf16 v[80:95], v[44:47], v[152:155], v[112:127]
ds_read_b128 v[164:167], v174 offset:11440
ds_read_b128 v[168:171], v175 offset:11440
v_exp_f32 v64, v64
v_exp_f32 v65, v65
v_exp_f32 v66, v66
v_exp_f32 v67, v67
v_exp_f32 v68, v68
v_exp_f32 v69, v69
v_exp_f32 v70, v70
v_exp_f32 v71, v71
v_exp_f32 v72, v72
v_cvt_pk_bf16_f32 v144, v64, v65
v_cvt_pk_bf16_f32 v145, v66, v67
v_cvt_pk_bf16_f32 v146, v68, v69
v_cvt_pk_bf16_f32 v147, v70, v71
v_exp_f32 v73, v73
v_exp_f32 v74, v74
s_waitcnt lgkmcnt(2)
v_mfma_f32_32x32x16_bf16 v[128:143], v[156:159], v[144:147], v[128:143]
v_exp_f32 v75, v75
v_exp_f32 v76, v76
v_exp_f32 v77, v77
v_exp_f32 v78, v78
v_exp_f32 v79, v79
v_cvt_pk_bf16_f32 v148, v72, v73
v_cvt_pk_bf16_f32 v149, v74, v75
v_cvt_pk_bf16_f32 v150, v76, v77
v_cvt_pk_bf16_f32 v151, v78, v79
s_nop 1
v_mfma_f32_32x32x16_bf16 v[128:143], v[160:163], v[148:151], v[128:143]
v_mfma_f32_32x32x16_bf16 v[64:79], v[48:51], v[152:155], v[112:127]
ds_read_b128 v[156:159], v174 offset:12480
ds_read_b128 v[160:163], v175 offset:12480
v_exp_f32 v80, v80
v_exp_f32 v81, v81
v_exp_f32 v82, v82
v_exp_f32 v83, v83
v_exp_f32 v84, v84
v_exp_f32 v85, v85
v_exp_f32 v86, v86
v_exp_f32 v87, v87
v_exp_f32 v88, v88
v_cvt_pk_bf16_f32 v144, v80, v81
v_cvt_pk_bf16_f32 v145, v82, v83
v_cvt_pk_bf16_f32 v146, v84, v85
v_cvt_pk_bf16_f32 v147, v86, v87
v_exp_f32 v89, v89
v_exp_f32 v90, v90
s_waitcnt lgkmcnt(2)
v_mfma_f32_32x32x16_bf16 v[128:143], v[164:167], v[144:147], v[128:143]
v_exp_f32 v91, v91
v_exp_f32 v92, v92
v_exp_f32 v93, v93
v_exp_f32 v94, v94
v_exp_f32 v95, v95
v_cvt_pk_bf16_f32 v148, v88, v89
v_cvt_pk_bf16_f32 v149, v90, v91
v_cvt_pk_bf16_f32 v150, v92, v93
v_cvt_pk_bf16_f32 v151, v94, v95
s_nop 1
v_mfma_f32_32x32x16_bf16 v[128:143], v[168:171], v[148:151], v[128:143]
v_mfma_f32_32x32x16_bf16 v[80:95], v[52:55], v[152:155], v[112:127]
ds_read_b128 v[164:167], v174 offset:13520
ds_read_b128 v[168:171], v175 offset:13520
v_exp_f32 v64, v64
v_exp_f32 v65, v65
v_exp_f32 v66, v66
v_exp_f32 v67, v67
v_exp_f32 v68, v68
v_exp_f32 v69, v69
v_exp_f32 v70, v70
v_exp_f32 v71, v71
v_exp_f32 v72, v72
v_cvt_pk_bf16_f32 v144, v64, v65
v_cvt_pk_bf16_f32 v145, v66, v67
v_cvt_pk_bf16_f32 v146, v68, v69
v_cvt_pk_bf16_f32 v147, v70, v71
v_exp_f32 v73, v73
v_exp_f32 v74, v74
s_waitcnt lgkmcnt(2)
v_mfma_f32_32x32x16_bf16 v[128:143], v[156:159], v[144:147], v[128:143]
v_exp_f32 v75, v75
v_exp_f32 v76, v76
v_exp_f32 v77, v77
v_exp_f32 v78, v78
v_exp_f32 v79, v79
v_cvt_pk_bf16_f32 v148, v72, v73
v_cvt_pk_bf16_f32 v149, v74, v75
v_cvt_pk_bf16_f32 v150, v76, v77
v_cvt_pk_bf16_f32 v151, v78, v79
s_nop 1
v_mfma_f32_32x32x16_bf16 v[128:143], v[160:163], v[148:151], v[128:143]
v_mfma_f32_32x32x16_bf16 v[64:79], v[56:59], v[152:155], v[112:127]
ds_read_b128 v[156:159], v174 offset:14560
ds_read_b128 v[160:163], v175 offset:14560
v_exp_f32 v80, v80
v_exp_f32 v81, v81
v_exp_f32 v82, v82
v_exp_f32 v83, v83
v_exp_f32 v84, v84
v_exp_f32 v85, v85
v_exp_f32 v86, v86
v_exp_f32 v87, v87
v_exp_f32 v88, v88
v_cvt_pk_bf16_f32 v144, v80, v81
v_cvt_pk_bf16_f32 v145, v82, v83
v_cvt_pk_bf16_f32 v146, v84, v85
v_cvt_pk_bf16_f32 v147, v86, v87
v_exp_f32 v89, v89
v_exp_f32 v90, v90
s_waitcnt lgkmcnt(2)
v_mfma_f32_32x32x16_bf16 v[128:143], v[164:167], v[144:147], v[128:143]
v_exp_f32 v91, v91
v_exp_f32 v92, v92
v_exp_f32 v93, v93
v_exp_f32 v94, v94
v_exp_f32 v95, v95
v_cvt_pk_bf16_f32 v148, v88, v89
v_cvt_pk_bf16_f32 v149, v90, v91
v_cvt_pk_bf16_f32 v150, v92, v93
v_cvt_pk_bf16_f32 v151, v94, v95
s_nop 1
v_mfma_f32_32x32x16_bf16 v[128:143], v[168:171], v[148:151], v[128:143]
v_mfma_f32_32x32x16_bf16 v[80:95], v[60:63], v[152:155], v[112:127]
ds_read_b128 v[164:167], v174 offset:15600
ds_read_b128 v[168:171], v175 offset:15600
v_exp_f32 v64, v64
v_exp_f32 v65, v65
v_exp_f32 v66, v66
v_exp_f32 v67, v67
v_exp_f32 v68, v68
v_exp_f32 v69, v69
v_exp_f32 v70, v70
v_exp_f32 v71, v71
v_exp_f32 v72, v72
v_cvt_pk_bf16_f32 v144, v64, v65
v_cvt_pk_bf16_f32 v145, v66, v67
v_cvt_pk_bf16_f32 v146, v68, v69
v_cvt_pk_bf16_f32 v147, v70, v71
v_exp_f32 v73, v73
v_exp_f32 v74, v74
s_waitcnt lgkmcnt(2)
v_mfma_f32_32x32x16_bf16 v[128:143], v[156:159], v[144:147], v[128:143]
v_exp_f32 v75, v75
v_exp_f32 v76, v76
v_exp_f32 v77, v77
v_exp_f32 v78, v78
v_exp_f32 v79, v79
v_cvt_pk_bf16_f32 v148, v72, v73
v_cvt_pk_bf16_f32 v149, v74, v75
v_cvt_pk_bf16_f32 v150, v76, v77
v_cvt_pk_bf16_f32 v151, v78, v79
s_nop 1
v_mfma_f32_32x32x16_bf16 v[128:143], v[160:163], v[148:151], v[128:143]
s_nop 0
v_exp_f32 v80, v80
v_exp_f32 v81, v81
v_exp_f32 v82, v82
v_exp_f32 v83, v83
v_exp_f32 v84, v84
v_exp_f32 v85, v85
v_exp_f32 v86, v86
v_exp_f32 v87, v87
v_exp_f32 v88, v88
v_cvt_pk_bf16_f32 v144, v80, v81
v_cvt_pk_bf16_f32 v145, v82, v83
v_cvt_pk_bf16_f32 v146, v84, v85
v_cvt_pk_bf16_f32 v147, v86, v87
v_exp_f32 v89, v89
v_exp_f32 v90, v90
s_waitcnt lgkmcnt(0)
v_mfma_f32_32x32x16_bf16 v[128:143], v[164:167], v[144:147], v[128:143]
v_exp_f32 v91, v91
v_exp_f32 v92, v92
v_exp_f32 v93, v93
v_exp_f32 v94, v94
v_exp_f32 v95, v95
v_cvt_pk_bf16_f32 v148, v88, v89
v_cvt_pk_bf16_f32 v149, v90, v91
v_cvt_pk_bf16_f32 v150, v92, v93
v_cvt_pk_bf16_f32 v151, v94, v95
s_nop 1
v_mfma_f32_32x32x16_bf16 v[128:143], v[168:171], v[148:151], v[128:143]
s_and_b32 s52, s63, 1
s_mul_i32 s52, s52, 10240
s_add_u32 s52, s52, 32768
s_mul_i32 s53, s3, 2560
s_add_u32 s53, s53, s52
s_lshl_b32 s54, s3, 9
s_add_u32 s54, s54, s52
v_lshlrev_b32 v183, 3, v191
v_add_u32 v184, s53, v183
v_add_u32 v185, s54, v183
v_add_u32 v186, s52, v183
s_lshl_b32 s52, s63, 7
s_add_u32 s52, s52, 151552
v_and_b32 v187, 31, v191
v_lshlrev_b32 v188, 2, v187
v_add_u32 v188, s52, v188
ds_read_b32 v188, v188
v_mov_b32 v137, v172
ds_write_b64 v184, v[128:129] offset:0
ds_write_b64 v184, v[130:131] offset:512
ds_write_b64 v184, v[132:133] offset:1024
ds_write_b64 v184, v[134:135] offset:1536
ds_write_b64 v184, v[136:137] offset:2048
s_lshl_b32 s52, s63, 10
s_add_u32 s52, s52, 141312
s_lshr_b32 s53, s3, 1
s_lshl_b32 s53, s53, 4
s_add_u32 s52, s52, s53
s_and_b32 s53, s3, 1
s_lshl_b32 s53, s53, 2
s_add_u32 s52, s52, s53
v_lshrrev_b32 v183, 5, v191
v_lshlrev_b32 v183, 3, v183
v_lshl_add_u32 v183, v187, 5, v183
v_add_u32 v183, s52, v183
s_waitcnt lgkmcnt(0)
s_barrier
ds_read_b64 v[64:65], v186 offset:2048
ds_read_b64 v[66:67], v186 offset:4608
ds_read_b64 v[68:69], v186 offset:7168
ds_read_b64 v[70:71], v186 offset:9728
ds_read_b64 v[72:73], v185 offset:0
ds_read_b64 v[74:75], v185 offset:2560
ds_read_b64 v[76:77], v185 offset:5120
ds_read_b64 v[78:79], v185 offset:7680
s_waitcnt lgkmcnt(4)
v_max3_f32 v172, v65, v67, v69
v_max_f32 v172, v172, v71
v_sub_f32 v65, v65, v172
v_sub_f32 v67, v67, v172
v_sub_f32 v69, v69, v172
v_sub_f32 v71, v71, v172
v_exp_f32 v65, v65
v_exp_f32 v67, v67
v_exp_f32 v69, v69
v_exp_f32 v71, v71
s_waitcnt lgkmcnt(0)
v_mul_f32 v64, v64, v65
v_mul_f32 v72, v72, v65
v_mul_f32 v73, v73, v65
v_fma_f32 v64, v66, v67, v64
v_fma_f32 v72, v74, v67, v72
v_fma_f32 v73, v75, v67, v73
v_fma_f32 v64, v68, v69, v64
v_fma_f32 v72, v76, v69, v72
v_fma_f32 v73, v77, v69, v73
v_fma_f32 v64, v70, v71, v64
v_fma_f32 v72, v78, v71, v72
v_fma_f32 v73, v79, v71, v73
v_rcp_f32 v64, v64
s_add_u32 s63, s63, 1
v_mul_f32 v64, v64, v188
v_mul_f32 v72, v72, v64
v_mul_f32 v73, v73, v64
v_cvt_pk_bf16_f32 v72, v72, v73
ds_write_b32 v183, v72
s_cmp_lt_u32 s63, s62
s_cbranch_scc1 L_p2
s_branch L_p2_done
L_ch1:
v_perm_b32 v183, v193, v192, s57
v_perm_b32 v184, v193, v192, s58
v_accvgpr_write_b32 a0, v183
v_accvgpr_write_b32 a4, v184
v_perm_b32 v183, v195, v194, s57
v_perm_b32 v184, v195, v194, s58
v_accvgpr_write_b32 a1, v183
v_accvgpr_write_b32 a5, v184
v_perm_b32 v183, v197, v196, s57
v_perm_b32 v184, v197, v196, s58
v_accvgpr_write_b32 a2, v183
v_accvgpr_write_b32 a6, v184
v_perm_b32 v183, v199, v198, s57
v_perm_b32 v184, v199, v198, s58
v_accvgpr_write_b32 a3, v183
v_accvgpr_write_b32 a7, v184
v_perm_b32 v183, v201, v200, s57
v_perm_b32 v184, v201, v200, s58
v_accvgpr_write_b32 a8, v183
v_accvgpr_write_b32 a12, v184
v_perm_b32 v183, v203, v202, s57
v_perm_b32 v184, v203, v202, s58
v_accvgpr_write_b32 a9, v183
v_accvgpr_write_b32 a13, v184
v_perm_b32 v183, v205, v204, s57
v_perm_b32 v184, v205, v204, s58
v_accvgpr_write_b32 a10, v183
v_accvgpr_write_b32 a14, v184
v_perm_b32 v183, v207, v206, s57
v_perm_b32 v184, v207, v206, s58
v_accvgpr_write_b32 a11, v183
v_accvgpr_write_b32 a15, v184
v_perm_b32 v183, v209, v208, s57
v_perm_b32 v184, v209, v208, s58
v_accvgpr_write_b32 a16, v183
v_accvgpr_write_b32 a20, v184
v_perm_b32 v183, v211, v210, s57
v_perm_b32 v184, v211, v210, s58
v_accvgpr_write_b32 a17, v183
v_accvgpr_write_b32 a21, v184
v_perm_b32 v183, v213, v212, s57
v_perm_b32 v184, v213, v212, s58
v_accvgpr_write_b32 a18, v183
v_accvgpr_write_b32 a22, v184
v_perm_b32 v183, v215, v214, s57
v_perm_b32 v184, v215, v214, s58
v_accvgpr_write_b32 a19, v183
v_accvgpr_write_b32 a23, v184
v_perm_b32 v183, v217, v216, s57
v_perm_b32 v184, v217, v216, s58
v_accvgpr_write_b32 a24, v183
v_accvgpr_write_b32 a28, v184
v_perm_b32 v183, v219, v218, s57
v_perm_b32 v184, v219, v218, s58
v_accvgpr_write_b32 a25, v183
v_accvgpr_write_b32 a29, v184
v_perm_b32 v183, v221, v220, s57
v_perm_b32 v184, v221, v220, s58
v_accvgpr_write_b32 a26, v183
v_accvgpr_write_b32 a30, v184
v_perm_b32 v183, v223, v222, s57
v_perm_b32 v184, v223, v222, s58
v_accvgpr_write_b32 a27, v183
v_accvgpr_write_b32 a31, v184
s_mov_b32 s52, 1048576
buffer_load_dword v192, v181, s[44:47], s52 offen
s_mov_b32 s52, 1056768
buffer_load_dword v193, v181, s[44:47], s52 offen
s_mov_b32 s52, 1064960
buffer_load_dword v194, v181, s[44:47], s52 offen
s_mov_b32 s52, 1073152
buffer_load_dword v195, v181, s[44:47], s52 offen
s_mov_b32 s52, 1081344
buffer_load_dword v196, v181, s[44:47], s52 offen
s_mov_b32 s52, 1089536
buffer_load_dword v197, v181, s[44:47], s52 offen
s_mov_b32 s52, 1097728
buffer_load_dword v198, v181, s[44:47], s52 offen
s_mov_b32 s52, 1105920
buffer_load_dword v199, v181, s[44:47], s52 offen
s_mov_b32 s52, 1310720
buffer_load_dword v200, v181, s[44:47], s52 offen
s_mov_b32 s52, 1318912
buffer_load_dword v201, v181, s[44:47], s52 offen
s_mov_b32 s52, 1327104
buffer_load_dword v202, v181, s[44:47], s52 offen
s_mov_b32 s52, 1335296
buffer_load_dword v203, v181, s[44:47], s52 offen
s_mov_b32 s52, 1343488
buffer_load_dword v204, v181, s[44:47], s52 offen
s_mov_b32 s52, 1351680
buffer_load_dword v205, v181, s[44:47], s52 offen
s_mov_b32 s52, 1359872
buffer_load_dword v206, v181, s[44:47], s52 offen
s_mov_b32 s52, 1368064
buffer_load_dword v207, v181, s[44:47], s52 offen
s_mov_b32 s52, 1572864
buffer_load_dword v208, v181, s[44:47], s52 offen
s_mov_b32 s52, 1581056
buffer_load_dword v209, v181, s[44:47], s52 offen
s_mov_b32 s52, 1589248
buffer_load_dword v210, v181, s[44:47], s52 offen
s_mov_b32 s52, 1597440
buffer_load_dword v211, v181, s[44:47], s52 offen
s_mov_b32 s52, 1605632
buffer_load_dword v212, v181, s[44:47], s52 offen
s_mov_b32 s52, 1613824
buffer_load_dword v213, v181, s[44:47], s52 offen
s_mov_b32 s52, 1622016
buffer_load_dword v214, v181, s[44:47], s52 offen
s_mov_b32 s52, 1630208
buffer_load_dword v215, v181, s[44:47], s52 offen
s_mov_b32 s52, 1835008
buffer_load_dword v216, v181, s[44:47], s52 offen
s_mov_b32 s52, 1843200
buffer_load_dword v217, v181, s[44:47], s52 offen
s_mov_b32 s52, 1851392
buffer_load_dword v218, v181, s[44:47], s52 offen
s_mov_b32 s52, 1859584
buffer_load_dword v219, v181, s[44:47], s52 offen
s_mov_b32 s52, 1867776
buffer_load_dword v220, v181, s[44:47], s52 offen
s_mov_b32 s52, 1875968
buffer_load_dword v221, v181, s[44:47], s52 offen
s_mov_b32 s52, 1884160
buffer_load_dword v222, v181, s[44:47], s52 offen
s_mov_b32 s52, 1892352
buffer_load_dword v223, v181, s[44:47], s52 offen
s_branch L_ch_ret
L_ch2:
v_perm_b32 v183, v193, v192, s57
v_perm_b32 v184, v193, v192, s58
v_accvgpr_write_b32 a32, v183
v_accvgpr_write_b32 a36, v184
v_perm_b32 v183, v195, v194, s57
v_perm_b32 v184, v195, v194, s58
v_accvgpr_write_b32 a33, v183
v_accvgpr_write_b32 a37, v184
v_perm_b32 v183, v197, v196, s57
v_perm_b32 v184, v197, v196, s58
v_accvgpr_write_b32 a34, v183
v_accvgpr_write_b32 a38, v184
v_perm_b32 v183, v199, v198, s57
v_perm_b32 v184, v199, v198, s58
v_accvgpr_write_b32 a35, v183
v_accvgpr_write_b32 a39, v184
v_perm_b32 v183, v201, v200, s57
v_perm_b32 v184, v201, v200, s58
v_accvgpr_write_b32 a40, v183
v_accvgpr_write_b32 a44, v184
v_perm_b32 v183, v203, v202, s57
v_perm_b32 v184, v203, v202, s58
v_accvgpr_write_b32 a41, v183
v_accvgpr_write_b32 a45, v184
v_perm_b32 v183, v205, v204, s57
v_perm_b32 v184, v205, v204, s58
v_accvgpr_write_b32 a42, v183
v_accvgpr_write_b32 a46, v184
v_perm_b32 v183, v207, v206, s57
v_perm_b32 v184, v207, v206, s58
v_accvgpr_write_b32 a43, v183
v_accvgpr_write_b32 a47, v184
v_perm_b32 v183, v209, v208, s57
v_perm_b32 v184, v209, v208, s58
v_accvgpr_write_b32 a48, v183
v_accvgpr_write_b32 a52, v184
v_perm_b32 v183, v211, v210, s57
v_perm_b32 v184, v211, v210, s58
v_accvgpr_write_b32 a49, v183
v_accvgpr_write_b32 a53, v184
v_perm_b32 v183, v213, v212, s57
v_perm_b32 v184, v213, v212, s58
v_accvgpr_write_b32 a50, v183
v_accvgpr_write_b32 a54, v184
v_perm_b32 v183, v215, v214, s57
v_perm_b32 v184, v215, v214, s58
v_accvgpr_write_b32 a51, v183
v_accvgpr_write_b32 a55, v184
v_perm_b32 v183, v217, v216, s57
v_perm_b32 v184, v217, v216, s58
v_accvgpr_write_b32 a56, v183
v_accvgpr_write_b32 a60, v184
v_perm_b32 v183, v219, v218, s57
v_perm_b32 v184, v219, v218, s58
v_accvgpr_write_b32 a57, v183
v_accvgpr_write_b32 a61, v184
v_perm_b32 v183, v221, v220, s57
v_perm_b32 v184, v221, v220, s58
v_accvgpr_write_b32 a58, v183
v_accvgpr_write_b32 a62, v184
v_perm_b32 v183, v223, v222, s57
v_perm_b32 v184, v223, v222, s58
v_accvgpr_write_b32 a59, v183
v_accvgpr_write_b32 a63, v184
s_mov_b32 s52, 2097152
buffer_load_dword v192, v181, s[44:47], s52 offen
s_mov_b32 s52, 2105344
buffer_load_dword v193, v181, s[44:47], s52 offen
s_mov_b32 s52, 2113536
buffer_load_dword v194, v181, s[44:47], s52 offen
s_mov_b32 s52, 2121728
buffer_load_dword v195, v181, s[44:47], s52 offen
s_mov_b32 s52, 2129920
buffer_load_dword v196, v181, s[44:47], s52 offen
s_mov_b32 s52, 2138112
buffer_load_dword v197, v181, s[44:47], s52 offen
s_mov_b32 s52, 2146304
buffer_load_dword v198, v181, s[44:47], s52 offen
s_mov_b32 s52, 2154496
buffer_load_dword v199, v181, s[44:47], s52 offen
s_mov_b32 s52, 2359296
buffer_load_dword v200, v181, s[44:47], s52 offen
s_mov_b32 s52, 2367488
buffer_load_dword v201, v181, s[44:47], s52 offen
s_mov_b32 s52, 2375680
buffer_load_dword v202, v181, s[44:47], s52 offen
s_mov_b32 s52, 2383872
buffer_load_dword v203, v181, s[44:47], s52 offen
s_mov_b32 s52, 2392064
buffer_load_dword v204, v181, s[44:47], s52 offen
s_mov_b32 s52, 2400256
buffer_load_dword v205, v181, s[44:47], s52 offen
s_mov_b32 s52, 2408448
buffer_load_dword v206, v181, s[44:47], s52 offen
s_mov_b32 s52, 2416640
buffer_load_dword v207, v181, s[44:47], s52 offen
s_mov_b32 s52, 2621440
buffer_load_dword v208, v181, s[44:47], s52 offen
s_mov_b32 s52, 2629632
buffer_load_dword v209, v181, s[44:47], s52 offen
s_mov_b32 s52, 2637824
buffer_load_dword v210, v181, s[44:47], s52 offen
s_mov_b32 s52, 2646016
buffer_load_dword v211, v181, s[44:47], s52 offen
s_mov_b32 s52, 2654208
buffer_load_dword v212, v181, s[44:47], s52 offen
s_mov_b32 s52, 2662400
buffer_load_dword v213, v181, s[44:47], s52 offen
s_mov_b32 s52, 2670592
buffer_load_dword v214, v181, s[44:47], s52 offen
s_mov_b32 s52, 2678784
buffer_load_dword v215, v181, s[44:47], s52 offen
s_mov_b32 s52, 2883584
buffer_load_dword v216, v181, s[44:47], s52 offen
s_mov_b32 s52, 2891776
buffer_load_dword v217, v181, s[44:47], s52 offen
s_mov_b32 s52, 2899968
buffer_load_dword v218, v181, s[44:47], s52 offen
s_mov_b32 s52, 2908160
buffer_load_dword v219, v181, s[44:47], s52 offen
s_mov_b32 s52, 2916352
buffer_load_dword v220, v181, s[44:47], s52 offen
s_mov_b32 s52, 2924544
buffer_load_dword v221, v181, s[44:47], s52 offen
s_mov_b32 s52, 2932736
buffer_load_dword v222, v181, s[44:47], s52 offen
s_mov_b32 s52, 2940928
buffer_load_dword v223, v181, s[44:47], s52 offen
s_branch L_ch_ret
L_ch3:
v_perm_b32 v183, v193, v192, s57
v_perm_b32 v184, v193, v192, s58
v_accvgpr_write_b32 a64, v183
v_accvgpr_write_b32 a68, v184
v_perm_b32 v183, v195, v194, s57
v_perm_b32 v184, v195, v194, s58
v_accvgpr_write_b32 a65, v183
v_accvgpr_write_b32 a69, v184
v_perm_b32 v183, v197, v196, s57
v_perm_b32 v184, v197, v196, s58
v_accvgpr_write_b32 a66, v183
v_accvgpr_write_b32 a70, v184
v_perm_b32 v183, v199, v198, s57
v_perm_b32 v184, v199, v198, s58
v_accvgpr_write_b32 a67, v183
v_accvgpr_write_b32 a71, v184
v_perm_b32 v183, v201, v200, s57
v_perm_b32 v184, v201, v200, s58
v_accvgpr_write_b32 a72, v183
v_accvgpr_write_b32 a76, v184
v_perm_b32 v183, v203, v202, s57
v_perm_b32 v184, v203, v202, s58
v_accvgpr_write_b32 a73, v183
v_accvgpr_write_b32 a77, v184
v_perm_b32 v183, v205, v204, s57
v_perm_b32 v184, v205, v204, s58
v_accvgpr_write_b32 a74, v183
v_accvgpr_write_b32 a78, v184
v_perm_b32 v183, v207, v206, s57
v_perm_b32 v184, v207, v206, s58
v_accvgpr_write_b32 a75, v183
v_accvgpr_write_b32 a79, v184
v_perm_b32 v183, v209, v208, s57
v_perm_b32 v184, v209, v208, s58
v_accvgpr_write_b32 a80, v183
v_accvgpr_write_b32 a84, v184
v_perm_b32 v183, v211, v210, s57
v_perm_b32 v184, v211, v210, s58
v_accvgpr_write_b32 a81, v183
v_accvgpr_write_b32 a85, v184
v_perm_b32 v183, v213, v212, s57
v_perm_b32 v184, v213, v212, s58
v_accvgpr_write_b32 a82, v183
v_accvgpr_write_b32 a86, v184
v_perm_b32 v183, v215, v214, s57
v_perm_b32 v184, v215, v214, s58
v_accvgpr_write_b32 a83, v183
v_accvgpr_write_b32 a87, v184
v_perm_b32 v183, v217, v216, s57
v_perm_b32 v184, v217, v216, s58
v_accvgpr_write_b32 a88, v183
v_accvgpr_write_b32 a92, v184
v_perm_b32 v183, v219, v218, s57
v_perm_b32 v184, v219, v218, s58
v_accvgpr_write_b32 a89, v183
v_accvgpr_write_b32 a93, v184
v_perm_b32 v183, v221, v220, s57
v_perm_b32 v184, v221, v220, s58
v_accvgpr_write_b32 a90, v183
v_accvgpr_write_b32 a94, v184
v_perm_b32 v183, v223, v222, s57
v_perm_b32 v184, v223, v222, s58
v_accvgpr_write_b32 a91, v183
v_accvgpr_write_b32 a95, v184
s_mov_b32 s52, 3145728
buffer_load_dword v192, v181, s[44:47], s52 offen
s_mov_b32 s52, 3153920
buffer_load_dword v193, v181, s[44:47], s52 offen
s_mov_b32 s52, 3162112
buffer_load_dword v194, v181, s[44:47], s52 offen
s_mov_b32 s52, 3170304
buffer_load_dword v195, v181, s[44:47], s52 offen
s_mov_b32 s52, 3178496
buffer_load_dword v196, v181, s[44:47], s52 offen
s_mov_b32 s52, 3186688
buffer_load_dword v197, v181, s[44:47], s52 offen
s_mov_b32 s52, 3194880
buffer_load_dword v198, v181, s[44:47], s52 offen
s_mov_b32 s52, 3203072
buffer_load_dword v199, v181, s[44:47], s52 offen
s_mov_b32 s52, 3407872
buffer_load_dword v200, v181, s[44:47], s52 offen
s_mov_b32 s52, 3416064
buffer_load_dword v201, v181, s[44:47], s52 offen
s_mov_b32 s52, 3424256
buffer_load_dword v202, v181, s[44:47], s52 offen
s_mov_b32 s52, 3432448
buffer_load_dword v203, v181, s[44:47], s52 offen
s_mov_b32 s52, 3440640
buffer_load_dword v204, v181, s[44:47], s52 offen
s_mov_b32 s52, 3448832
buffer_load_dword v205, v181, s[44:47], s52 offen
s_mov_b32 s52, 3457024
buffer_load_dword v206, v181, s[44:47], s52 offen
s_mov_b32 s52, 3465216
buffer_load_dword v207, v181, s[44:47], s52 offen
s_mov_b32 s52, 3670016
buffer_load_dword v208, v181, s[44:47], s52 offen
s_mov_b32 s52, 3678208
buffer_load_dword v209, v181, s[44:47], s52 offen
s_mov_b32 s52, 3686400
buffer_load_dword v210, v181, s[44:47], s52 offen
s_mov_b32 s52, 3694592
buffer_load_dword v211, v181, s[44:47], s52 offen
s_mov_b32 s52, 3702784
buffer_load_dword v212, v181, s[44:47], s52 offen
s_mov_b32 s52, 3710976
buffer_load_dword v213, v181, s[44:47], s52 offen
s_mov_b32 s52, 3719168
buffer_load_dword v214, v181, s[44:47], s52 offen
s_mov_b32 s52, 3727360
buffer_load_dword v215, v181, s[44:47], s52 offen
s_mov_b32 s52, 3932160
buffer_load_dword v216, v181, s[44:47], s52 offen
s_mov_b32 s52, 3940352
buffer_load_dword v217, v181, s[44:47], s52 offen
s_mov_b32 s52, 3948544
buffer_load_dword v218, v181, s[44:47], s52 offen
s_mov_b32 s52, 3956736
buffer_load_dword v219, v181, s[44:47], s52 offen
s_mov_b32 s52, 3964928
buffer_load_dword v220, v181, s[44:47], s52 offen
s_mov_b32 s52, 3973120
buffer_load_dword v221, v181, s[44:47], s52 offen
s_mov_b32 s52, 3981312
buffer_load_dword v222, v181, s[44:47], s52 offen
s_mov_b32 s52, 3989504
buffer_load_dword v223, v181, s[44:47], s52 offen
s_branch L_ch_ret
L_ch4:
v_perm_b32 v183, v193, v192, s57
v_perm_b32 v184, v193, v192, s58
v_accvgpr_write_b32 a96, v183
v_accvgpr_write_b32 a100, v184
v_perm_b32 v183, v195, v194, s57
v_perm_b32 v184, v195, v194, s58
v_accvgpr_write_b32 a97, v183
v_accvgpr_write_b32 a101, v184
v_perm_b32 v183, v197, v196, s57
v_perm_b32 v184, v197, v196, s58
v_accvgpr_write_b32 a98, v183
v_accvgpr_write_b32 a102, v184
v_perm_b32 v183, v199, v198, s57
v_perm_b32 v184, v199, v198, s58
v_accvgpr_write_b32 a99, v183
v_accvgpr_write_b32 a103, v184
v_perm_b32 v183, v201, v200, s57
v_perm_b32 v184, v201, v200, s58
v_accvgpr_write_b32 a104, v183
v_accvgpr_write_b32 a108, v184
v_perm_b32 v183, v203, v202, s57
v_perm_b32 v184, v203, v202, s58
v_accvgpr_write_b32 a105, v183
v_accvgpr_write_b32 a109, v184
v_perm_b32 v183, v205, v204, s57
v_perm_b32 v184, v205, v204, s58
v_accvgpr_write_b32 a106, v183
v_accvgpr_write_b32 a110, v184
v_perm_b32 v183, v207, v206, s57
v_perm_b32 v184, v207, v206, s58
v_accvgpr_write_b32 a107, v183
v_accvgpr_write_b32 a111, v184
v_perm_b32 v183, v209, v208, s57
v_perm_b32 v184, v209, v208, s58
v_accvgpr_write_b32 a112, v183
v_accvgpr_write_b32 a116, v184
v_perm_b32 v183, v211, v210, s57
v_perm_b32 v184, v211, v210, s58
v_accvgpr_write_b32 a113, v183
v_accvgpr_write_b32 a117, v184
v_perm_b32 v183, v213, v212, s57
v_perm_b32 v184, v213, v212, s58
v_accvgpr_write_b32 a114, v183
v_accvgpr_write_b32 a118, v184
v_perm_b32 v183, v215, v214, s57
v_perm_b32 v184, v215, v214, s58
v_accvgpr_write_b32 a115, v183
v_accvgpr_write_b32 a119, v184
v_perm_b32 v183, v217, v216, s57
v_perm_b32 v184, v217, v216, s58
v_accvgpr_write_b32 a120, v183
v_accvgpr_write_b32 a124, v184
v_perm_b32 v183, v219, v218, s57
v_perm_b32 v184, v219, v218, s58
v_accvgpr_write_b32 a121, v183
v_accvgpr_write_b32 a125, v184
v_perm_b32 v183, v221, v220, s57
v_perm_b32 v184, v221, v220, s58
v_accvgpr_write_b32 a122, v183
v_accvgpr_write_b32 a126, v184
v_perm_b32 v183, v223, v222, s57
v_perm_b32 v184, v223, v222, s58
v_accvgpr_write_b32 a123, v183
v_accvgpr_write_b32 a127, v184
s_lshl_b32 s52, s60, 17
s_add_u32 s52, s52, 0
buffer_load_dwordx2 v[192:193], v182, s[48:51], s52 offen offset:0
buffer_load_dwordx2 v[194:195], v182, s[48:51], s52 offen offset:1024
buffer_load_dwordx2 v[196:197], v182, s[48:51], s52 offen offset:2048
buffer_load_dwordx2 v[198:199], v182, s[48:51], s52 offen offset:3072
s_lshl_b32 s52, s60, 17
s_add_u32 s52, s52, 4096
buffer_load_dwordx2 v[200:201], v182, s[48:51], s52 offen offset:0
buffer_load_dwordx2 v[202:203], v182, s[48:51], s52 offen offset:1024
buffer_load_dwordx2 v[204:205], v182, s[48:51], s52 offen offset:2048
buffer_load_dwordx2 v[206:207], v182, s[48:51], s52 offen offset:3072
s_lshl_b32 s52, s60, 17
s_add_u32 s52, s52, 16384
buffer_load_dwordx2 v[208:209], v182, s[48:51], s52 offen offset:0
buffer_load_dwordx2 v[210:211], v182, s[48:51], s52 offen offset:1024
buffer_load_dwordx2 v[212:213], v182, s[48:51], s52 offen offset:2048
buffer_load_dwordx2 v[214:215], v182, s[48:51], s52 offen offset:3072
s_lshl_b32 s52, s60, 17
s_add_u32 s52, s52, 20480
buffer_load_dwordx2 v[216:217], v182, s[48:51], s52 offen offset:0
buffer_load_dwordx2 v[218:219], v182, s[48:51], s52 offen offset:1024
buffer_load_dwordx2 v[220:221], v182, s[48:51], s52 offen offset:2048
buffer_load_dwordx2 v[222:223], v182, s[48:51], s52 offen offset:3072
s_lshl_b32 s52, s60, 17
s_add_u32 s52, s52, 32768
buffer_load_dwordx2 v[224:225], v182, s[48:51], s52 offen offset:0
buffer_load_dwordx2 v[226:227], v182, s[48:51], s52 offen offset:1024
buffer_load_dwordx2 v[228:229], v182, s[48:51], s52 offen offset:2048
buffer_load_dwordx2 v[230:231], v182, s[48:51], s52 offen offset:3072
s_lshl_b32 s52, s60, 17
s_add_u32 s52, s52, 36864
buffer_load_dwordx2 v[232:233], v182, s[48:51], s52 offen offset:0
buffer_load_dwordx2 v[234:235], v182, s[48:51], s52 offen offset:1024
buffer_load_dwordx2 v[236:237], v182, s[48:51], s52 offen offset:2048
buffer_load_dwordx2 v[238:239], v182, s[48:51], s52 offen offset:3072
s_branch L_ch_ret
L_ch5:
v_perm_b32 v183, v194, v192, s57
v_perm_b32 v184, v194, v192, s58
v_perm_b32 v185, v195, v193, s57
v_perm_b32 v186, v195, v193, s58
v_accvgpr_write_b32 a128, v183
v_accvgpr_write_b32 a132, v184
v_accvgpr_write_b32 a136, v185
v_accvgpr_write_b32 a140, v186
v_perm_b32 v183, v198, v196, s57
v_perm_b32 v184, v198, v196, s58
v_perm_b32 v185, v199, v197, s57
v_perm_b32 v186, v199, v197, s58
v_accvgpr_write_b32 a129, v183
v_accvgpr_write_b32 a133, v184
v_accvgpr_write_b32 a137, v185
v_accvgpr_write_b32 a141, v186
v_perm_b32 v183, v202, v200, s57
v_perm_b32 v184, v202, v200, s58
v_perm_b32 v185, v203, v201, s57
v_perm_b32 v186, v203, v201, s58
v_accvgpr_write_b32 a130, v183
v_accvgpr_write_b32 a134, v184
v_accvgpr_write_b32 a138, v185
v_accvgpr_write_b32 a142, v186
v_perm_b32 v183, v206, v204, s57
v_perm_b32 v184, v206, v204, s58
v_perm_b32 v185, v207, v205, s57
v_perm_b32 v186, v207, v205, s58
v_accvgpr_write_b32 a131, v183
v_accvgpr_write_b32 a135, v184
v_accvgpr_write_b32 a139, v185
v_accvgpr_write_b32 a143, v186
v_perm_b32 v183, v210, v208, s57
v_perm_b32 v184, v210, v208, s58
v_perm_b32 v185, v211, v209, s57
v_perm_b32 v186, v211, v209, s58
v_accvgpr_write_b32 a144, v183
v_accvgpr_write_b32 a148, v184
v_accvgpr_write_b32 a152, v185
v_accvgpr_write_b32 a156, v186
v_perm_b32 v183, v214, v212, s57
v_perm_b32 v184, v214, v212, s58
v_perm_b32 v185, v215, v213, s57
v_perm_b32 v186, v215, v213, s58
v_accvgpr_write_b32 a145, v183
v_accvgpr_write_b32 a149, v184
v_accvgpr_write_b32 a153, v185
v_accvgpr_write_b32 a157, v186
v_perm_b32 v183, v218, v216, s57
v_perm_b32 v184, v218, v216, s58
v_perm_b32 v185, v219, v217, s57
v_perm_b32 v186, v219, v217, s58
v_accvgpr_write_b32 a146, v183
v_accvgpr_write_b32 a150, v184
v_accvgpr_write_b32 a154, v185
v_accvgpr_write_b32 a158, v186
v_perm_b32 v183, v222, v220, s57
v_perm_b32 v184, v222, v220, s58
v_perm_b32 v185, v223, v221, s57
v_perm_b32 v186, v223, v221, s58
v_accvgpr_write_b32 a147, v183
v_accvgpr_write_b32 a151, v184
v_accvgpr_write_b32 a155, v185
v_accvgpr_write_b32 a159, v186
v_perm_b32 v183, v226, v224, s57
v_perm_b32 v184, v226, v224, s58
v_perm_b32 v185, v227, v225, s57
v_perm_b32 v186, v227, v225, s58
v_accvgpr_write_b32 a160, v183
v_accvgpr_write_b32 a164, v184
v_accvgpr_write_b32 a168, v185
v_accvgpr_write_b32 a172, v186
v_perm_b32 v183, v230, v228, s57
v_perm_b32 v184, v230, v228, s58
v_perm_b32 v185, v231, v229, s57
v_perm_b32 v186, v231, v229, s58
v_accvgpr_write_b32 a161, v183
v_accvgpr_write_b32 a165, v184
v_accvgpr_write_b32 a169, v185
v_accvgpr_write_b32 a173, v186
v_perm_b32 v183, v234, v232, s57
v_perm_b32 v184, v234, v232, s58
v_perm_b32 v185, v235, v233, s57
v_perm_b32 v186, v235, v233, s58
v_accvgpr_write_b32 a162, v183
v_accvgpr_write_b32 a166, v184
v_accvgpr_write_b32 a170, v185
v_accvgpr_write_b32 a174, v186
v_perm_b32 v183, v238, v236, s57
v_perm_b32 v184, v238, v236, s58
v_perm_b32 v185, v239, v237, s57
v_perm_b32 v186, v239, v237, s58
v_accvgpr_write_b32 a163, v183
v_accvgpr_write_b32 a167, v184
v_accvgpr_write_b32 a171, v185
v_accvgpr_write_b32 a175, v186
s_lshl_b32 s52, s60, 17
s_add_u32 s52, s52, 49152
buffer_load_dwordx2 v[192:193], v182, s[48:51], s52 offen offset:0
buffer_load_dwordx2 v[194:195], v182, s[48:51], s52 offen offset:1024
buffer_load_dwordx2 v[196:197], v182, s[48:51], s52 offen offset:2048
buffer_load_dwordx2 v[198:199], v182, s[48:51], s52 offen offset:3072
s_lshl_b32 s52, s60, 17
s_add_u32 s52, s52, 53248
buffer_load_dwordx2 v[200:201], v182, s[48:51], s52 offen offset:0
buffer_load_dwordx2 v[202:203], v182, s[48:51], s52 offen offset:1024
buffer_load_dwordx2 v[204:205], v182, s[48:51], s52 offen offset:2048
buffer_load_dwordx2 v[206:207], v182, s[48:51], s52 offen offset:3072
s_lshl_b32 s52, s60, 17
s_add_u32 s52, s52, 65536
buffer_load_dwordx2 v[208:209], v182, s[48:51], s52 offen offset:0
buffer_load_dwordx2 v[210:211], v182, s[48:51], s52 offen offset:1024
buffer_load_dwordx2 v[212:213], v182, s[48:51], s52 offen offset:2048
buffer_load_dwordx2 v[214:215], v182, s[48:51], s52 offen offset:3072
s_lshl_b32 s52, s60, 17
s_add_u32 s52, s52, 69632
buffer_load_dwordx2 v[216:217], v182, s[48:51], s52 offen offset:0
buffer_load_dwordx2 v[218:219], v182, s[48:51], s52 offen offset:1024
buffer_load_dwordx2 v[220:221], v182, s[48:51], s52 offen offset:2048
buffer_load_dwordx2 v[222:223], v182, s[48:51], s52 offen offset:3072
s_lshl_b32 s52, s60, 17
s_add_u32 s52, s52, 81920
buffer_load_dwordx2 v[224:225], v182, s[48:51], s52 offen offset:0
buffer_load_dwordx2 v[226:227], v182, s[48:51], s52 offen offset:1024
buffer_load_dwordx2 v[228:229], v182, s[48:51], s52 offen offset:2048
buffer_load_dwordx2 v[230:231], v182, s[48:51], s52 offen offset:3072
s_lshl_b32 s52, s60, 17
s_add_u32 s52, s52, 86016
buffer_load_dwordx2 v[232:233], v182, s[48:51], s52 offen offset:0
buffer_load_dwordx2 v[234:235], v182, s[48:51], s52 offen offset:1024
buffer_load_dwordx2 v[236:237], v182, s[48:51], s52 offen offset:2048
buffer_load_dwordx2 v[238:239], v182, s[48:51], s52 offen offset:3072
s_branch L_ch_ret
L_ch6:
v_perm_b32 v183, v194, v192, s57
v_perm_b32 v184, v194, v192, s58
v_perm_b32 v185, v195, v193, s57
v_perm_b32 v186, v195, v193, s58
v_accvgpr_write_b32 a176, v183
v_accvgpr_write_b32 a180, v184
v_accvgpr_write_b32 a184, v185
v_accvgpr_write_b32 a188, v186
v_perm_b32 v183, v198, v196, s57
v_perm_b32 v184, v198, v196, s58
v_perm_b32 v185, v199, v197, s57
v_perm_b32 v186, v199, v197, s58
v_accvgpr_write_b32 a177, v183
v_accvgpr_write_b32 a181, v184
v_accvgpr_write_b32 a185, v185
v_accvgpr_write_b32 a189, v186
v_perm_b32 v183, v202, v200, s57
v_perm_b32 v184, v202, v200, s58
v_perm_b32 v185, v203, v201, s57
v_perm_b32 v186, v203, v201, s58
v_accvgpr_write_b32 a178, v183
v_accvgpr_write_b32 a182, v184
v_accvgpr_write_b32 a186, v185
v_accvgpr_write_b32 a190, v186
v_perm_b32 v183, v206, v204, s57
v_perm_b32 v184, v206, v204, s58
v_perm_b32 v185, v207, v205, s57
v_perm_b32 v186, v207, v205, s58
v_accvgpr_write_b32 a179, v183
v_accvgpr_write_b32 a183, v184
v_accvgpr_write_b32 a187, v185
v_accvgpr_write_b32 a191, v186
v_perm_b32 v183, v210, v208, s57
v_perm_b32 v184, v210, v208, s58
v_perm_b32 v185, v211, v209, s57
v_perm_b32 v186, v211, v209, s58
v_accvgpr_write_b32 a192, v183
v_accvgpr_write_b32 a196, v184
v_accvgpr_write_b32 a200, v185
v_accvgpr_write_b32 a204, v186
v_perm_b32 v183, v214, v212, s57
v_perm_b32 v184, v214, v212, s58
v_perm_b32 v185, v215, v213, s57
v_perm_b32 v186, v215, v213, s58
v_accvgpr_write_b32 a193, v183
v_accvgpr_write_b32 a197, v184
v_accvgpr_write_b32 a201, v185
v_accvgpr_write_b32 a205, v186
v_perm_b32 v183, v218, v216, s57
v_perm_b32 v184, v218, v216, s58
v_perm_b32 v185, v219, v217, s57
v_perm_b32 v186, v219, v217, s58
v_accvgpr_write_b32 a194, v183
v_accvgpr_write_b32 a198, v184
v_accvgpr_write_b32 a202, v185
v_accvgpr_write_b32 a206, v186
v_perm_b32 v183, v222, v220, s57
v_perm_b32 v184, v222, v220, s58
v_perm_b32 v185, v223, v221, s57
v_perm_b32 v186, v223, v221, s58
v_accvgpr_write_b32 a195, v183
v_accvgpr_write_b32 a199, v184
v_accvgpr_write_b32 a203, v185
v_accvgpr_write_b32 a207, v186
v_perm_b32 v183, v226, v224, s57
v_perm_b32 v184, v226, v224, s58
v_perm_b32 v185, v227, v225, s57
v_perm_b32 v186, v227, v225, s58
v_accvgpr_write_b32 a208, v183
v_accvgpr_write_b32 a212, v184
v_accvgpr_write_b32 a216, v185
v_accvgpr_write_b32 a220, v186
v_perm_b32 v183, v230, v228, s57
v_perm_b32 v184, v230, v228, s58
v_perm_b32 v185, v231, v229, s57
v_perm_b32 v186, v231, v229, s58
v_accvgpr_write_b32 a209, v183
v_accvgpr_write_b32 a213, v184
v_accvgpr_write_b32 a217, v185
v_accvgpr_write_b32 a221, v186
v_perm_b32 v183, v234, v232, s57
v_perm_b32 v184, v234, v232, s58
v_perm_b32 v185, v235, v233, s57
v_perm_b32 v186, v235, v233, s58
v_accvgpr_write_b32 a210, v183
v_accvgpr_write_b32 a214, v184
v_accvgpr_write_b32 a218, v185
v_accvgpr_write_b32 a222, v186
v_perm_b32 v183, v238, v236, s57
v_perm_b32 v184, v238, v236, s58
v_perm_b32 v185, v239, v237, s57
v_perm_b32 v186, v239, v237, s58
v_accvgpr_write_b32 a211, v183
v_accvgpr_write_b32 a215, v184
v_accvgpr_write_b32 a219, v185
v_accvgpr_write_b32 a223, v186
s_mov_b32 s44, s12
s_mov_b32 s45, s13
s_mov_b32 s46, 524288
s_mov_b32 s47, 0x20000
s_lshl_b32 s52, s60, 17
s_add_u32 s52, s52, 98304
buffer_load_dwordx2 v[192:193], v182, s[48:51], s52 offen offset:0
buffer_load_dwordx2 v[194:195], v182, s[48:51], s52 offen offset:1024
buffer_load_dwordx2 v[196:197], v182, s[48:51], s52 offen offset:2048
buffer_load_dwordx2 v[198:199], v182, s[48:51], s52 offen offset:3072
s_lshl_b32 s52, s60, 17
s_add_u32 s52, s52, 102400
buffer_load_dwordx2 v[200:201], v182, s[48:51], s52 offen offset:0
buffer_load_dwordx2 v[202:203], v182, s[48:51], s52 offen offset:1024
buffer_load_dwordx2 v[204:205], v182, s[48:51], s52 offen offset:2048
buffer_load_dwordx2 v[206:207], v182, s[48:51], s52 offen offset:3072
s_lshl_b32 s52, s60, 17
s_add_u32 s52, s52, 114688
buffer_load_dwordx2 v[208:209], v182, s[48:51], s52 offen offset:0
buffer_load_dwordx2 v[210:211], v182, s[48:51], s52 offen offset:1024
buffer_load_dwordx2 v[212:213], v182, s[48:51], s52 offen offset:2048
buffer_load_dwordx2 v[214:215], v182, s[48:51], s52 offen offset:3072
s_lshl_b32 s52, s60, 17
s_add_u32 s52, s52, 118784
buffer_load_dwordx2 v[216:217], v182, s[48:51], s52 offen offset:0
buffer_load_dwordx2 v[218:219], v182, s[48:51], s52 offen offset:1024
buffer_load_dwordx2 v[220:221], v182, s[48:51], s52 offen offset:2048
buffer_load_dwordx2 v[222:223], v182, s[48:51], s52 offen offset:3072
s_lshl_b32 s52, s60, 14
s_add_u32 s52, s52, 0
buffer_load_dwordx2 v[224:225], v182, s[44:47], s52 offen offset:0
buffer_load_dwordx2 v[226:227], v182, s[44:47], s52 offen offset:1024
buffer_load_dwordx2 v[228:229], v182, s[44:47], s52 offen offset:2048
buffer_load_dwordx2 v[230:231], v182, s[44:47], s52 offen offset:3072
s_lshl_b32 s52, s60, 14
s_add_u32 s52, s52, 4096
buffer_load_dwordx2 v[232:233], v182, s[44:47], s52 offen offset:0
buffer_load_dwordx2 v[234:235], v182, s[44:47], s52 offen offset:1024
buffer_load_dwordx2 v[236:237], v182, s[44:47], s52 offen offset:2048
buffer_load_dwordx2 v[238:239], v182, s[44:47], s52 offen offset:3072
s_branch L_ch_ret
L_ch7:
v_perm_b32 v183, v194, v192, s57
v_perm_b32 v184, v194, v192, s58
v_perm_b32 v185, v195, v193, s57
v_perm_b32 v186, v195, v193, s58
v_accvgpr_write_b32 a224, v183
v_accvgpr_write_b32 a228, v184
v_accvgpr_write_b32 a232, v185
v_accvgpr_write_b32 a236, v186
v_perm_b32 v183, v198, v196, s57
v_perm_b32 v184, v198, v196, s58
v_perm_b32 v185, v199, v197, s57
v_perm_b32 v186, v199, v197, s58
v_accvgpr_write_b32 a225, v183
v_accvgpr_write_b32 a229, v184
v_accvgpr_write_b32 a233, v185
v_accvgpr_write_b32 a237, v186
v_perm_b32 v183, v202, v200, s57
v_perm_b32 v184, v202, v200, s58
v_perm_b32 v185, v203, v201, s57
v_perm_b32 v186, v203, v201, s58
v_accvgpr_write_b32 a226, v183
v_accvgpr_write_b32 a230, v184
v_accvgpr_write_b32 a234, v185
v_accvgpr_write_b32 a238, v186
v_perm_b32 v183, v206, v204, s57
v_perm_b32 v184, v206, v204, s58
v_perm_b32 v185, v207, v205, s57
v_perm_b32 v186, v207, v205, s58
v_accvgpr_write_b32 a227, v183
v_accvgpr_write_b32 a231, v184
v_accvgpr_write_b32 a235, v185
v_accvgpr_write_b32 a239, v186
v_perm_b32 v183, v210, v208, s57
v_perm_b32 v184, v210, v208, s58
v_perm_b32 v185, v211, v209, s57
v_perm_b32 v186, v211, v209, s58
v_accvgpr_write_b32 a240, v183
v_accvgpr_write_b32 a244, v184
v_accvgpr_write_b32 a248, v185
v_accvgpr_write_b32 a252, v186
v_perm_b32 v183, v214, v212, s57
v_perm_b32 v184, v214, v212, s58
v_perm_b32 v185, v215, v213, s57
v_perm_b32 v186, v215, v213, s58
v_accvgpr_write_b32 a241, v183
v_accvgpr_write_b32 a245, v184
v_accvgpr_write_b32 a249, v185
v_accvgpr_write_b32 a253, v186
v_perm_b32 v183, v218, v216, s57
v_perm_b32 v184, v218, v216, s58
v_perm_b32 v185, v219, v217, s57
v_perm_b32 v186, v219, v217, s58
v_accvgpr_write_b32 a242, v183
v_accvgpr_write_b32 a246, v184
v_accvgpr_write_b32 a250, v185
v_accvgpr_write_b32 a254, v186
v_perm_b32 v183, v222, v220, s57
v_perm_b32 v184, v222, v220, s58
v_perm_b32 v185, v223, v221, s57
v_perm_b32 v186, v223, v221, s58
v_accvgpr_write_b32 a243, v183
v_accvgpr_write_b32 a247, v184
v_accvgpr_write_b32 a251, v185
v_accvgpr_write_b32 a255, v186
v_perm_b32 v240, v226, v224, s57
v_perm_b32 v244, v226, v224, s58
v_perm_b32 v248, v227, v225, s57
v_perm_b32 v252, v227, v225, s58
v_perm_b32 v241, v230, v228, s57
v_perm_b32 v245, v230, v228, s58
v_perm_b32 v249, v231, v229, s57
v_perm_b32 v253, v231, v229, s58
v_perm_b32 v242, v234, v232, s57
v_perm_b32 v246, v234, v232, s58
v_perm_b32 v250, v235, v233, s57
v_perm_b32 v254, v235, v233, s58
v_perm_b32 v243, v238, v236, s57
v_perm_b32 v247, v238, v236, s58
v_perm_b32 v251, v239, v237, s57
v_perm_b32 v255, v239, v237, s58
s_branch L_ch_ret
L_p2_done:
v_and_b32 v1, 15, v191
v_lshrrev_b32 v2, 4, v191
v_and_b32 v3, 31, v191
v_lshrrev_b32 v4, 5, v191
s_and_b32 s66, s3, 1
s_lshr_b32 s67, s3, 1
v_lshrrev_b32 v5, 2, v1
v_lshlrev_b32 v5, 8, v5
v_lshl_add_u32 v5, v2, 5, v5
v_and_b32 v6, 1, v1
v_lshl_add_u32 v196, v6, 7, v5
s_lshl_b32 s52, s67, 11
s_add_u32 s52, s52, 8
v_add_u32 v197, s52, v176
s_lshl_b32 s52, s67, 12
s_add_u32 s52, s52, 8192
v_add_u32 v206, s52, v178
s_mul_i32 s52, s66, 4352
s_lshl_b32 s53, s67, 7
s_add_u32 s52, s52, s53
s_add_u32 s52, s52, 40960
v_mul_u32_u24 v5, 272, v1
v_lshl_add_u32 v5, v2, 4, v5
v_add_u32 v198, s52, v5
v_mul_u32_u24 v5, 272, v3
v_lshl_add_u32 v5, v4, 4, v5
v_add_u32 v199, 40960, v5
v_lshlrev_b32 v5, 5, v3
v_lshl_add_u32 v5, v4, 4, v5
v_add_u32 v200, 141312, v5
s_lshl_b32 s52, s3, 8
v_lshlrev_b32 v5, 12, v4
v_lshl_add_u32 v5, v3, 3, v5
v_add_u32 v201, s52, v5
v_lshlrev_b32 v5, 15, v2
v_lshl_add_u32 v5, v1, 4, v5
v_add_u32 v202, s52, v5
v_lshlrev_b32 v5, 3, v2
v_lshl_add_u32 v5, v1, 4, v5
v_add_u32 v203, s52, v5
s_lshl_b32 s52, s66, 6
s_add_u32 s52, s52, 151552
v_lshlrev_b32 v5, 2, v1
v_add_u32 v204, s52, v5
s_lshl_b32 s52, s66, 12
s_add_u32 s52, s52, 32768
v_add_u32 v205, s52, v176
s_lshl_b32 s52, s66, 4
v_add_u32 v5, s52, v1
v_lshlrev_b32 v6, 2, v2
v_sub_u32 v5, v5, v6
v_mov_b32 v6, 0xd028965f
v_cmp_gt_i32 vcc, 0, v5
s_nop 1
v_cndmask_b32 v152, 0, v6, vcc
v_cmp_gt_i32 vcc, 1, v5
s_nop 1
v_cndmask_b32 v153, 0, v6, vcc
v_cmp_gt_i32 vcc, 2, v5
s_nop 1
v_cndmask_b32 v154, 0, v6, vcc
v_cmp_gt_i32 vcc, 3, v5
s_nop 1
v_cndmask_b32 v155, 0, v6, vcc
v_cmp_gt_i32 vcc, 16, v5
s_nop 1
v_cndmask_b32 v156, 0, v6, vcc
v_cmp_gt_i32 vcc, 17, v5
s_nop 1
v_cndmask_b32 v157, 0, v6, vcc
v_cmp_gt_i32 vcc, 18, v5
s_nop 1
v_cndmask_b32 v158, 0, v6, vcc
v_cmp_gt_i32 vcc, 19, v5
s_nop 1
v_cndmask_b32 v159, 0, v6, vcc
v_mov_b32 v164, 0
v_mov_b32 v165, 0
v_mov_b32 v166, 0
v_mov_b32 v167, 0
v_mov_b32 v168, 0
v_mov_b32 v169, 0
v_mov_b32 v170, 0
v_mov_b32 v171, 0
v_mov_b32 v172, 0
v_mov_b32 v173, 0
v_mov_b32 v174, 0
v_mov_b32 v175, 0
v_mov_b32 v5, 0x3f80
v_mov_b32 v6, 0x3f800000
v_and_b32 v7, 1, v1
v_cmp_eq_u32 vcc, 1, v7
v_bfe_u32 v7, v1, 1, 2
s_nop 0
v_cndmask_b32 v5, v5, v6, vcc
v_cmp_eq_u32 vcc, 0, v7
s_nop 1
v_cndmask_b32 v192, 0, v5, vcc
v_cmp_eq_u32 vcc, 1, v7
s_nop 1
v_cndmask_b32 v193, 0, v5, vcc
v_cmp_eq_u32 vcc, 2, v7
s_nop 1
v_cndmask_b32 v194, 0, v5, vcc
v_cmp_eq_u32 vcc, 3, v7
s_nop 1
v_cndmask_b32 v195, 0, v5, vcc
s_mov_b32 s63, 0
s_mov_b32 s72, 0x3e0293ee
L_p3:
s_waitcnt vmcnt(0) lgkmcnt(0)
s_barrier
s_lshl_b32 s66, s64, 5
s_add_u32 s66, s66, s60
s_lshl_b32 s69, s66, 12
s_add_u32 s69, s69, 1048576
s_lshl_b32 s66, s66, 14
s_add_u32 s66, s66, 16777216
s_add_u32 s67, s66, 4096
ds_read_b128 v[0:3], v176 offset:0
ds_read_b128 v[4:7], v176 offset:1024
ds_read_b128 v[8:11], v176 offset:2048
ds_read_b128 v[12:15], v176 offset:3072
ds_read_b128 v[16:19], v176 offset:4096
ds_read_b128 v[20:23], v176 offset:5120
ds_read_b128 v[24:27], v176 offset:6144
ds_read_b128 v[28:31], v176 offset:7168
s_waitcnt lgkmcnt(6)
v_mfma_f32_16x16x32_bf16 v[32:35], a[0:3], v[0:3], 0
v_mfma_f32_16x16x32_bf16 v[36:39], a[4:7], v[0:3], 0
buffer_load_dwordx4 v[56:59], v176, s[36:39], s66 offen offset:0 sc1
v_mfma_f32_16x16x32_bf16 v[40:43], a[0:3], v[4:7], 0
v_mfma_f32_16x16x32_bf16 v[44:47], a[4:7], v[4:7], 0
ds_read_b128 v[0:3], v176 offset:8192
ds_read_b128 v[4:7], v176 offset:9216
s_waitcnt lgkmcnt(6)
v_mfma_f32_16x16x32_bf16 v[32:35], a[8:11], v[8:11], v[32:35]
v_mfma_f32_16x16x32_bf16 v[36:39], a[12:15], v[8:11], v[36:39]
buffer_load_dwordx4 v[60:63], v176, s[36:39], s66 offen offset:1024 sc1
v_mfma_f32_16x16x32_bf16 v[40:43], a[8:11], v[12:15], v[40:43]
v_mfma_f32_16x16x32_bf16 v[44:47], a[12:15], v[12:15], v[44:47]
ds_read_b128 v[8:11], v176 offset:10240
ds_read_b128 v[12:15], v176 offset:11264
s_waitcnt lgkmcnt(6)
v_mfma_f32_16x16x32_bf16 v[32:35], a[16:19], v[16:19], v[32:35]
v_mfma_f32_16x16x32_bf16 v[36:39], a[20:23], v[16:19], v[36:39]
buffer_load_dwordx4 v[64:67], v176, s[36:39], s66 offen offset:2048 sc1
v_mfma_f32_16x16x32_bf16 v[40:43], a[16:19], v[20:23], v[40:43]
v_mfma_f32_16x16x32_bf16 v[44:47], a[20:23], v[20:23], v[44:47]
ds_read_b128 v[16:19], v176 offset:12288
ds_read_b128 v[20:23], v176 offset:13312
s_waitcnt lgkmcnt(6)
v_mfma_f32_16x16x32_bf16 v[32:35], a[24:27], v[24:27], v[32:35]
v_mfma_f32_16x16x32_bf16 v[36:39], a[28:31], v[24:27], v[36:39]
buffer_load_dwordx4 v[68:71], v176, s[36:39], s66 offen offset:3072 sc1
v_mfma_f32_16x16x32_bf16 v[40:43], a[24:27], v[28:31], v[40:43]
v_mfma_f32_16x16x32_bf16 v[44:47], a[28:31], v[28:31], v[44:47]
ds_read_b128 v[24:27], v176 offset:14336
ds_read_b128 v[28:31], v176 offset:15360
s_waitcnt lgkmcnt(6)
v_mfma_f32_16x16x32_bf16 v[32:35], a[32:35], v[0:3], v[32:35]
v_mfma_f32_16x16x32_bf16 v[36:39], a[36:39], v[0:3], v[36:39]
buffer_load_dwordx4 v[72:75], v176, s[36:39], s67 offen offset:0 sc1
v_mfma_f32_16x16x32_bf16 v[40:43], a[32:35], v[4:7], v[40:43]
v_mfma_f32_16x16x32_bf16 v[44:47], a[36:39], v[4:7], v[44:47]
ds_read_b128 v[0:3], v176 offset:16384
ds_read_b128 v[4:7], v176 offset:17408
s_waitcnt lgkmcnt(6)
v_mfma_f32_16x16x32_bf16 v[32:35], a[40:43], v[8:11], v[32:35]
v_mfma_f32_16x16x32_bf16 v[36:39], a[44:47], v[8:11], v[36:39]
buffer_load_dwordx4 v[76:79], v176, s[36:39], s67 offen offset:1024 sc1
v_mfma_f32_16x16x32_bf16 v[40:43], a[40:43], v[12:15], v[40:43]
v_mfma_f32_16x16x32_bf16 v[44:47], a[44:47], v[12:15], v[44:47]
ds_read_b128 v[8:11], v176 offset:18432
ds_read_b128 v[12:15], v176 offset:19456
s_waitcnt lgkmcnt(6)
v_mfma_f32_16x16x32_bf16 v[32:35], a[48:51], v[16:19], v[32:35]
v_mfma_f32_16x16x32_bf16 v[36:39], a[52:55], v[16:19], v[36:39]
buffer_load_dwordx4 v[80:83], v176, s[36:39], s67 offen offset:2048 sc1
v_mfma_f32_16x16x32_bf16 v[40:43], a[48:51], v[20:23], v[40:43]
v_mfma_f32_16x16x32_bf16 v[44:47], a[52:55], v[20:23], v[44:47]
ds_read_b128 v[16:19], v176 offset:20480
ds_read_b128 v[20:23], v176 offset:21504
s_waitcnt lgkmcnt(6)
v_mfma_f32_16x16x32_bf16 v[32:35], a[56:59], v[24:27], v[32:35]
v_mfma_f32_16x16x32_bf16 v[36:39], a[60:63], v[24:27], v[36:39]
buffer_load_dwordx4 v[84:87], v176, s[36:39], s67 offen offset:3072 sc1
v_mfma_f32_16x16x32_bf16 v[40:43], a[56:59], v[28:31], v[40:43]
v_mfma_f32_16x16x32_bf16 v[44:47], a[60:63], v[28:31], v[44:47]
ds_read_b128 v[24:27], v176 offset:22528
ds_read_b128 v[28:31], v176 offset:23552
s_waitcnt lgkmcnt(6)
v_mfma_f32_16x16x32_bf16 v[32:35], a[64:67], v[0:3], v[32:35]
v_mfma_f32_16x16x32_bf16 v[36:39], a[68:71], v[0:3], v[36:39]
buffer_load_dwordx2 v[120:121], v206, s[36:39], s66 offen offset:0 sc1
v_mfma_f32_16x16x32_bf16 v[40:43], a[64:67], v[4:7], v[40:43]
v_mfma_f32_16x16x32_bf16 v[44:47], a[68:71], v[4:7], v[44:47]
ds_read_b128 v[0:3], v176 offset:24576
ds_read_b128 v[4:7], v176 offset:25600
s_waitcnt lgkmcnt(6)
v_mfma_f32_16x16x32_bf16 v[32:35], a[72:75], v[8:11], v[32:35]
v_mfma_f32_16x16x32_bf16 v[36:39], a[76:79], v[8:11], v[36:39]
buffer_load_dwordx2 v[122:123], v206, s[36:39], s66 offen offset:256 sc1
v_mfma_f32_16x16x32_bf16 v[40:43], a[72:75], v[12:15], v[40:43]
v_mfma_f32_16x16x32_bf16 v[44:47], a[76:79], v[12:15], v[44:47]
ds_read_b128 v[8:11], v176 offset:26624
ds_read_b128 v[12:15], v176 offset:27648
s_waitcnt lgkmcnt(6)
v_mfma_f32_16x16x32_bf16 v[32:35], a[80:83], v[16:19], v[32:35]
v_mfma_f32_16x16x32_bf16 v[36:39], a[84:87], v[16:19], v[36:39]
buffer_load_dwordx2 v[124:125], v206, s[36:39], s66 offen offset:1024 sc1
v_mfma_f32_16x16x32_bf16 v[40:43], a[80:83], v[20:23], v[40:43]
v_mfma_f32_16x16x32_bf16 v[44:47], a[84:87], v[20:23], v[44:47]
ds_read_b128 v[16:19], v176 offset:28672
ds_read_b128 v[20:23], v176 offset:29696
s_waitcnt lgkmcnt(6)
v_mfma_f32_16x16x32_bf16 v[32:35], a[88:91], v[24:27], v[32:35]
v_mfma_f32_16x16x32_bf16 v[36:39], a[92:95], v[24:27], v[36:39]
buffer_load_dwordx2 v[126:127], v206, s[36:39], s66 offen offset:1280 sc1
v_mfma_f32_16x16x32_bf16 v[40:43], a[88:91], v[28:31], v[40:43]
v_mfma_f32_16x16x32_bf16 v[44:47], a[92:95], v[28:31], v[44:47]
ds_read_b128 v[24:27], v176 offset:30720
ds_read_b128 v[28:31], v176 offset:31744
s_waitcnt lgkmcnt(6)
v_mfma_f32_16x16x32_bf16 v[32:35], a[96:99], v[0:3], v[32:35]
v_mfma_f32_16x16x32_bf16 v[36:39], a[100:103], v[0:3], v[36:39]
buffer_load_dwordx2 v[128:129], v206, s[36:39], s66 offen offset:2048 sc1
v_mfma_f32_16x16x32_bf16 v[40:43], a[96:99], v[4:7], v[40:43]
v_mfma_f32_16x16x32_bf16 v[44:47], a[100:103], v[4:7], v[44:47]
s_waitcnt lgkmcnt(4)
v_mfma_f32_16x16x32_bf16 v[32:35], a[104:107], v[8:11], v[32:35]
v_mfma_f32_16x16x32_bf16 v[36:39], a[108:111], v[8:11], v[36:39]
buffer_load_dwordx2 v[130:131], v206, s[36:39], s66 offen offset:2304 sc1
v_mfma_f32_16x16x32_bf16 v[40:43], a[104:107], v[12:15], v[40:43]
v_mfma_f32_16x16x32_bf16 v[44:47], a[108:111], v[12:15], v[44:47]
s_waitcnt lgkmcnt(2)
v_mfma_f32_16x16x32_bf16 v[32:35], a[112:115], v[16:19], v[32:35]
v_mfma_f32_16x16x32_bf16 v[36:39], a[116:119], v[16:19], v[36:39]
buffer_load_dwordx2 v[132:133], v206, s[36:39], s66 offen offset:3072 sc1
v_mfma_f32_16x16x32_bf16 v[40:43], a[112:115], v[20:23], v[40:43]
v_mfma_f32_16x16x32_bf16 v[44:47], a[116:119], v[20:23], v[44:47]
s_waitcnt lgkmcnt(0)
v_mfma_f32_16x16x32_bf16 v[32:35], a[120:123], v[24:27], v[32:35]
v_mfma_f32_16x16x32_bf16 v[36:39], a[124:127], v[24:27], v[36:39]
buffer_load_dwordx2 v[134:135], v206, s[36:39], s66 offen offset:3328 sc1
v_mfma_f32_16x16x32_bf16 v[40:43], a[120:123], v[28:31], v[40:43]
v_mfma_f32_16x16x32_bf16 v[44:47], a[124:127], v[28:31], v[44:47]
s_lshl_b32 s52, s3, 10
s_add_u32 s52, s52, 32768
v_add_u32 v183, s52, v176
s_lshl_b32 s52, s63, 7
v_add_u32 v187, s52, v204
ds_read_b32 v187, v187
s_nop 1
v_cvt_pk_bf16_f32 v48, v32, v36
v_cvt_pk_bf16_f32 v49, v33, v37
v_cvt_pk_bf16_f32 v50, v34, v38
v_cvt_pk_bf16_f32 v51, v35, v39
ds_write_b128 v183, v[48:51] offset:0
v_cvt_pk_bf16_f32 v52, v40, v44
v_cvt_pk_bf16_f32 v53, v41, v45
v_cvt_pk_bf16_f32 v54, v42, v46
v_cvt_pk_bf16_f32 v55, v43, v47
ds_write_b128 v183, v[52:55] offset:4096
s_waitcnt lgkmcnt(0)
s_barrier
ds_read_b128 v[104:107], v205 offset:0
ds_read_b128 v[108:111], v205 offset:1024
ds_read_b128 v[112:115], v205 offset:2048
ds_read_b128 v[116:119], v205 offset:3072
s_add_u32 s66, s64, 7
s_cmp_ge_u32 s66, 64
s_cbranch_scc1 L_p3_nodma
s_lshl_b32 s52, s66, 15
s_lshl_b32 s53, s3, 8
s_add_u32 s52, s52, s53
s_lshl_b32 s53, s3, 13
s_add_u32 s53, s53, s65
s_add_u32 m0, s53, 0
s_add_u32 s54, s52, 0
buffer_load_dwordx4 v177, s[92:95], s54 offen lds
s_add_u32 m0, s53, 1024
s_add_u32 s54, s52, 16384
buffer_load_dwordx4 v177, s[92:95], s54 offen lds
s_add_u32 m0, s53, 2048
s_add_u32 s54, s52, 64
buffer_load_dwordx4 v177, s[92:95], s54 offen lds
s_add_u32 m0, s53, 3072
s_add_u32 s54, s52, 16448
buffer_load_dwordx4 v177, s[92:95], s54 offen lds
s_add_u32 m0, s53, 4096
s_add_u32 s54, s52, 128
buffer_load_dwordx4 v177, s[92:95], s54 offen lds
s_add_u32 m0, s53, 5120
s_add_u32 s54, s52, 16512
buffer_load_dwordx4 v177, s[92:95], s54 offen lds
s_add_u32 m0, s53, 6144
s_add_u32 s54, s52, 192
buffer_load_dwordx4 v177, s[92:95], s54 offen lds
s_add_u32 m0, s53, 7168
s_add_u32 s54, s52, 16576
buffer_load_dwordx4 v177, s[92:95], s54 offen lds
L_p3_nodma:
s_waitcnt vmcnt(8)
s_waitcnt lgkmcnt(3)
v_mfma_f32_16x16x32_bf16 v[140:143], v[56:59], v[104:107], v[152:155]
v_mfma_f32_16x16x32_bf16 v[144:147], v[72:75], v[104:107], v[156:159]
s_waitcnt lgkmcnt(2)
v_mfma_f32_16x16x32_bf16 v[140:143], v[60:63], v[108:111], v[140:143]
v_mfma_f32_16x16x32_bf16 v[144:147], v[76:79], v[108:111], v[144:147]
s_waitcnt lgkmcnt(1)
v_mfma_f32_16x16x32_bf16 v[140:143], v[64:67], v[112:115], v[140:143]
v_mfma_f32_16x16x32_bf16 v[144:147], v[80:83], v[112:115], v[144:147]
s_waitcnt lgkmcnt(0)
v_mfma_f32_16x16x32_bf16 v[140:143], v[68:71], v[116:119], v[140:143]
v_mfma_f32_16x16x32_bf16 v[144:147], v[84:87], v[116:119], v[144:147]
s_cmp_eq_u32 s63, 0
s_cbranch_scc1 L_p3_nored
s_lshl_b32 s66, s71, 7
s_add_u32 s66, s66, 16384
v_min_u32 v183, 31, v191
v_lshlrev_b32 v183, 2, v183
L_po_9:
buffer_load_dword v184, v183, s[36:39], s66 offen sc1
s_waitcnt vmcnt(0)
v_cmp_eq_u32 vcc, 0, v184
s_cbranch_vccz L_po_9_ok
s_sub_u32 s56, s56, 1
s_cbranch_scc0 L_po_9
s_endpgm
L_po_9_ok:
s_lshl_b32 s66, s71, 20
s_lshl_b32 s52, s60, 10
s_add_u32 s66, s66, s52
s_add_u32 s66, s66, 50331648
buffer_load_dwordx4 v[208:211], v202, s[36:39], s66 offen sc1
s_add_u32 s66, s66, 131072
buffer_load_dwordx4 v[212:215], v202, s[36:39], s66 offen sc1
s_add_u32 s66, s66, 131072
buffer_load_dwordx4 v[216:219], v202, s[36:39], s66 offen sc1
s_add_u32 s66, s66, 131072
buffer_load_dwordx4 v[220:223], v202, s[36:39], s66 offen sc1
s_add_u32 s66, s66, 131072
buffer_load_dwordx4 v[224:227], v202, s[36:39], s66 offen sc1
s_add_u32 s66, s66, 131072
buffer_load_dwordx4 v[228:231], v202, s[36:39], s66 offen sc1
s_add_u32 s66, s66, 131072
buffer_load_dwordx4 v[232:235], v202, s[36:39], s66 offen sc1
s_add_u32 s66, s66, 131072
buffer_load_dwordx4 v[236:239], v202, s[36:39], s66 offen sc1
s_waitcnt vmcnt(7)
v_mfma_f32_16x16x32_bf16 v[148:151], v[192:195], v[208:211], 0
s_waitcnt vmcnt(6)
v_mfma_f32_16x16x32_bf16 v[148:151], v[192:195], v[212:215], v[148:151]
s_waitcnt vmcnt(5)
v_mfma_f32_16x16x32_bf16 v[148:151], v[192:195], v[216:219], v[148:151]
s_waitcnt vmcnt(4)
v_mfma_f32_16x16x32_bf16 v[148:151], v[192:195], v[220:223], v[148:151]
s_waitcnt vmcnt(3)
v_mfma_f32_16x16x32_bf16 v[148:151], v[192:195], v[224:227], v[148:151]
s_waitcnt vmcnt(2)
v_mfma_f32_16x16x32_bf16 v[148:151], v[192:195], v[228:231], v[148:151]
s_waitcnt vmcnt(1)
v_mfma_f32_16x16x32_bf16 v[148:151], v[192:195], v[232:235], v[148:151]
s_waitcnt vmcnt(0)
v_mfma_f32_16x16x32_bf16 v[148:151], v[192:195], v[236:239], v[148:151]
s_lshl_b32 s66, s71, 5
s_add_u32 s66, s66, s60
s_lshl_b32 s66, s66, 10
s_nop 4
v_cvt_pk_bf16_f32 v188, v148, v149
v_cvt_pk_bf16_f32 v189, v150, v151
s_mov_b32 exec_hi, 0
buffer_store_dwordx2 v[188:189], v203, s[96:99], s66 offen
s_mov_b32 exec_hi, -1
L_p3_nored:
s_lshl_b32 s66, s60, 6
s_add_u32 s66, s66, s64
s_lshl_b32 s66, s66, 2
s_add_u32 s66, s66, 8192
v_min_u32 v183, 0, v191
v_lshlrev_b32 v183, 2, v183
L_po_10:
buffer_load_dword v184, v183, s[36:39], s66 offen sc1
s_waitcnt vmcnt(0)
v_cmp_eq_u32 vcc, 0, v184
s_cbranch_vccz L_po_10_ok
s_sub_u32 s56, s56, 1
s_cbranch_scc0 L_po_10
s_endpgm
L_po_10_ok:
buffer_load_dwordx2 v[88:89], v196, s[36:39], s69 offen offset:0 sc1
buffer_load_dwordx2 v[90:91], v196, s[36:39], s69 offen offset:16 sc1
buffer_load_dwordx2 v[92:93], v196, s[36:39], s69 offen offset:1024 sc1
buffer_load_dwordx2 v[94:95], v196, s[36:39], s69 offen offset:1040 sc1
buffer_load_dwordx2 v[96:97], v196, s[36:39], s69 offen offset:2048 sc1
buffer_load_dwordx2 v[98:99], v196, s[36:39], s69 offen offset:2064 sc1
buffer_load_dwordx2 v[100:101], v196, s[36:39], s69 offen offset:3072 sc1
buffer_load_dwordx2 v[102:103], v196, s[36:39], s69 offen offset:3088 sc1
buffer_load_dwordx2 v[136:137], v197, s[36:39], s69 offen offset:0 sc1
buffer_load_dwordx2 v[138:139], v197, s[36:39], s69 offen offset:1024 sc1
v_max3_f32 v183, v140, v141, v142
v_max3_f32 v183, v183, v143, v144
v_max3_f32 v183, v183, v145, v146
v_max_f32 v183, v183, v147
v_sub_f32 v187, 1.0, v187
s_waitcnt vmcnt(8)
v_mfma_f32_16x16x32_bf16 v[148:151], v[88:91], v[104:107], 0
s_waitcnt vmcnt(6)
v_mfma_f32_16x16x32_bf16 v[148:151], v[92:95], v[108:111], v[148:151]
s_waitcnt vmcnt(4)
v_mfma_f32_16x16x32_bf16 v[148:151], v[96:99], v[112:115], v[148:151]
s_waitcnt vmcnt(2)
v_mfma_f32_16x16x32_bf16 v[148:151], v[100:103], v[116:119], v[148:151]
s_nop 7
v_max3_f32 v183, v183, v148, v149
v_max_f32 v184, v183, v183
s_nop 1
v_permlane16_swap_b32 v183, v184
v_max_f32 v185, v183, v184
v_max_f32 v183, v183, v184
s_nop 1
v_permlane32_swap_b32 v183, v185
v_max_f32 v183, v183, v185
v_mul_f32 v183, s72, v183
v_fma_f32 v140, v140, s72, -v183
v_fma_f32 v141, v141, s72, -v183
v_fma_f32 v142, v142, s72, -v183
v_fma_f32 v143, v143, s72, -v183
v_fma_f32 v144, v144, s72, -v183
v_fma_f32 v145, v145, s72, -v183
v_fma_f32 v146, v146, s72, -v183
v_fma_f32 v147, v147, s72, -v183
v_fma_f32 v148, v148, s72, -v183
v_fma_f32 v149, v149, s72, -v183
v_exp_f32 v140, v140
v_exp_f32 v141, v141
v_exp_f32 v142, v142
v_exp_f32 v143, v143
v_exp_f32 v144, v144
v_exp_f32 v145, v145
v_exp_f32 v146, v146
v_exp_f32 v147, v147
v_exp_f32 v148, v148
v_exp_f32 v149, v149
v_cvt_pk_bf16_f32 v160, v140, v141
v_cvt_pk_bf16_f32 v161, v142, v143
v_cvt_pk_bf16_f32 v162, v144, v145
v_cvt_pk_bf16_f32 v163, v146, v147
v_cvt_pk_bf16_f32 v166, v148, v149
v_cvt_pk_bf16_f32 v173, v148, v149
s_waitcnt vmcnt(0)
v_mfma_f32_16x16x32_bf16 v[0:3], v[120:123], v[160:163], 0
v_add_f32 v140, v140, v145
v_add_f32 v141, v141, v146
v_mfma_f32_16x16x32_bf16 v[4:7], v[124:127], v[160:163], 0
v_add_f32 v142, v142, v147
v_add_f32 v143, v143, v148
v_mfma_f32_16x16x32_bf16 v[8:11], v[128:131], v[160:163], 0
v_add_f32 v144, v144, v149
v_add_f32 v140, v140, v141
v_mfma_f32_16x16x32_bf16 v[12:15], v[132:135], v[160:163], 0
v_add_f32 v142, v142, v143
v_add_f32 v140, v140, v144
v_mfma_f32_16x16x32_bf16 v[0:3], v[136:139], v[166:169], v[0:3]
v_add_f32 v183, v140, v142
v_add_f32 v184, v140, v142
v_mfma_f32_16x16x32_bf16 v[4:7], v[136:139], v[172:175], v[4:7]
s_nop 0
v_permlane16_swap_b32 v183, v184
v_mfma_f32_16x16x32_bf16 v[8:11], v[136:139], v[164:167], v[8:11]
v_add_f32 v185, v183, v184
v_add_f32 v183, v183, v184
v_mfma_f32_16x16x32_bf16 v[12:15], v[136:139], v[170:173], v[12:15]
s_nop 0
v_permlane32_swap_b32 v183, v185
v_add_f32 v183, v183, v185
v_rcp_f32 v183, v183
s_lshl_b32 s52, s63, 10
v_add_u32 v184, s52, v200
v_mul_f32 v183, v183, v187
ds_read_b128 v[96:99], v184
v_mul_f32 v0, v0, v183
v_mul_f32 v1, v1, v183
v_mul_f32 v2, v2, v183
v_mul_f32 v3, v3, v183
v_mul_f32 v4, v4, v183
v_mul_f32 v5, v5, v183
v_mul_f32 v6, v6, v183
v_mul_f32 v7, v7, v183
v_cvt_pk_bf16_f32 v48, v0, v4
v_cvt_pk_bf16_f32 v49, v1, v5
v_cvt_pk_bf16_f32 v50, v2, v6
v_cvt_pk_bf16_f32 v51, v3, v7
ds_write_b128 v198, v[48:51] offset:0
v_mul_f32 v8, v8, v183
v_mul_f32 v9, v9, v183
v_mul_f32 v10, v10, v183
v_mul_f32 v11, v11, v183
v_mul_f32 v12, v12, v183
v_mul_f32 v13, v13, v183
v_mul_f32 v14, v14, v183
v_mul_f32 v15, v15, v183
v_cvt_pk_bf16_f32 v52, v8, v12
v_cvt_pk_bf16_f32 v53, v9, v13
v_cvt_pk_bf16_f32 v54, v10, v14
v_cvt_pk_bf16_f32 v55, v11, v15
ds_write_b128 v198, v[52:55] offset:64
s_waitcnt lgkmcnt(0)
s_barrier
ds_read_b128 v[64:67], v199 offset:0
ds_read_b128 v[68:71], v199 offset:32
ds_read_b128 v[72:75], v199 offset:64
ds_read_b128 v[76:79], v199 offset:96
ds_read_b128 v[80:83], v199 offset:128
ds_read_b128 v[84:87], v199 offset:160
ds_read_b128 v[88:91], v199 offset:192
ds_read_b128 v[92:95], v199 offset:224
s_lshl_b32 s66, s64, 5
s_add_u32 s66, s66, s60
s_lshl_b32 s70, s66, 2
s_add_u32 s70, s70, 16384
s_lshl_b32 s66, s66, 15
s_add_u32 s66, s66, 50331648
s_add_u32 s67, s66, 8192
s_add_u32 s68, s66, 16384
s_add_u32 s69, s66, 24576
v_mfma_f32_32x32x16_bf16 v[0:15], v[96:99], v[240:243], 0
v_mfma_f32_32x32x16_bf16 v[16:31], v[96:99], v[244:247], 0
v_mfma_f32_32x32x16_bf16 v[32:47], v[96:99], v[248:251], 0
v_mfma_f32_32x32x16_bf16 v[48:63], v[96:99], v[252:255], 0
s_waitcnt lgkmcnt(7)
v_mfma_f32_32x32x16_bf16 v[0:15], v[64:67], a[128:131], v[0:15]
v_mfma_f32_32x32x16_bf16 v[16:31], v[64:67], a[132:135], v[16:31]
v_mfma_f32_32x32x16_bf16 v[32:47], v[64:67], a[136:139], v[32:47]
v_mfma_f32_32x32x16_bf16 v[48:63], v[64:67], a[140:143], v[48:63]
s_waitcnt lgkmcnt(6)
v_mfma_f32_32x32x16_bf16 v[0:15], v[68:71], a[144:147], v[0:15]
v_mfma_f32_32x32x16_bf16 v[16:31], v[68:71], a[148:151], v[16:31]
v_mfma_f32_32x32x16_bf16 v[32:47], v[68:71], a[152:155], v[32:47]
v_mfma_f32_32x32x16_bf16 v[48:63], v[68:71], a[156:159], v[48:63]
s_waitcnt lgkmcnt(5)
v_mfma_f32_32x32x16_bf16 v[0:15], v[72:75], a[160:163], v[0:15]
v_mfma_f32_32x32x16_bf16 v[16:31], v[72:75], a[164:167], v[16:31]
v_mfma_f32_32x32x16_bf16 v[32:47], v[72:75], a[168:171], v[32:47]
v_mfma_f32_32x32x16_bf16 v[48:63], v[72:75], a[172:175], v[48:63]
s_waitcnt lgkmcnt(4)
v_mfma_f32_32x32x16_bf16 v[0:15], v[76:79], a[176:179], v[0:15]
v_mfma_f32_32x32x16_bf16 v[16:31], v[76:79], a[180:183], v[16:31]
v_mfma_f32_32x32x16_bf16 v[32:47], v[76:79], a[184:187], v[32:47]
v_mfma_f32_32x32x16_bf16 v[48:63], v[76:79], a[188:191], v[48:63]
s_waitcnt lgkmcnt(3)
v_mfma_f32_32x32x16_bf16 v[0:15], v[80:83], a[192:195], v[0:15]
v_mfma_f32_32x32x16_bf16 v[16:31], v[80:83], a[196:199], v[16:31]
v_mfma_f32_32x32x16_bf16 v[32:47], v[80:83], a[200:203], v[32:47]
v_mfma_f32_32x32x16_bf16 v[48:63], v[80:83], a[204:207], v[48:63]
s_waitcnt lgkmcnt(2)
v_mfma_f32_32x32x16_bf16 v[0:15], v[84:87], a[208:211], v[0:15]
v_mfma_f32_32x32x16_bf16 v[16:31], v[84:87], a[212:215], v[16:31]
v_mfma_f32_32x32x16_bf16 v[32:47], v[84:87], a[216:219], v[32:47]
v_mfma_f32_32x32x16_bf16 v[48:63], v[84:87], a[220:223], v[48:63]
s_waitcnt lgkmcnt(1)
v_mfma_f32_32x32x16_bf16 v[0:15], v[88:91], a[224:227], v[0:15]
v_mfma_f32_32x32x16_bf16 v[16:31], v[88:91], a[228:231], v[16:31]
v_mfma_f32_32x32x16_bf16 v[32:47], v[88:91], a[232:235], v[32:47]
v_mfma_f32_32x32x16_bf16 v[48:63], v[88:91], a[236:239], v[48:63]
s_waitcnt lgkmcnt(0)
v_mfma_f32_32x32x16_bf16 v[0:15], v[92:95], a[240:243], v[0:15]
v_mfma_f32_32x32x16_bf16 v[16:31], v[92:95], a[244:247], v[16:31]
v_mfma_f32_32x32x16_bf16 v[32:47], v[92:95], a[248:251], v[32:47]
v_mfma_f32_32x32x16_bf16 v[48:63], v[92:95], a[252:255], v[48:63]
s_nop 7
s_nop 3
v_cvt_pk_bf16_f32 v64, v0, v16
v_cvt_pk_bf16_f32 v65, v32, v48
buffer_store_dwordx2 v[64:65], v201, s[36:39], s66 offen offset:0 sc0 sc1
v_cvt_pk_bf16_f32 v66, v1, v17
v_cvt_pk_bf16_f32 v67, v33, v49
buffer_store_dwordx2 v[66:67], v201, s[36:39], s66 offen offset:1024 sc0 sc1
v_cvt_pk_bf16_f32 v68, v2, v18
v_cvt_pk_bf16_f32 v69, v34, v50
buffer_store_dwordx2 v[68:69], v201, s[36:39], s66 offen offset:2048 sc0 sc1
v_cvt_pk_bf16_f32 v70, v3, v19
v_cvt_pk_bf16_f32 v71, v35, v51
buffer_store_dwordx2 v[70:71], v201, s[36:39], s66 offen offset:3072 sc0 sc1
v_cvt_pk_bf16_f32 v72, v4, v20
v_cvt_pk_bf16_f32 v73, v36, v52
buffer_store_dwordx2 v[72:73], v201, s[36:39], s67 offen offset:0 sc0 sc1
v_cvt_pk_bf16_f32 v74, v5, v21
v_cvt_pk_bf16_f32 v75, v37, v53
buffer_store_dwordx2 v[74:75], v201, s[36:39], s67 offen offset:1024 sc0 sc1
v_cvt_pk_bf16_f32 v76, v6, v22
v_cvt_pk_bf16_f32 v77, v38, v54
buffer_store_dwordx2 v[76:77], v201, s[36:39], s67 offen offset:2048 sc0 sc1
v_cvt_pk_bf16_f32 v78, v7, v23
v_cvt_pk_bf16_f32 v79, v39, v55
buffer_store_dwordx2 v[78:79], v201, s[36:39], s67 offen offset:3072 sc0 sc1
v_cvt_pk_bf16_f32 v80, v8, v24
v_cvt_pk_bf16_f32 v81, v40, v56
buffer_store_dwordx2 v[80:81], v201, s[36:39], s68 offen offset:0 sc0 sc1
v_cvt_pk_bf16_f32 v82, v9, v25
v_cvt_pk_bf16_f32 v83, v41, v57
buffer_store_dwordx2 v[82:83], v201, s[36:39], s68 offen offset:1024 sc0 sc1
v_cvt_pk_bf16_f32 v84, v10, v26
v_cvt_pk_bf16_f32 v85, v42, v58
buffer_store_dwordx2 v[84:85], v201, s[36:39], s68 offen offset:2048 sc0 sc1
v_cvt_pk_bf16_f32 v86, v11, v27
v_cvt_pk_bf16_f32 v87, v43, v59
buffer_store_dwordx2 v[86:87], v201, s[36:39], s68 offen offset:3072 sc0 sc1
v_cvt_pk_bf16_f32 v88, v12, v28
v_cvt_pk_bf16_f32 v89, v44, v60
buffer_store_dwordx2 v[88:89], v201, s[36:39], s69 offen offset:0 sc0 sc1
v_cvt_pk_bf16_f32 v90, v13, v29
v_cvt_pk_bf16_f32 v91, v45, v61
buffer_store_dwordx2 v[90:91], v201, s[36:39], s69 offen offset:1024 sc0 sc1
v_cvt_pk_bf16_f32 v92, v14, v30
v_cvt_pk_bf16_f32 v93, v46, v62
buffer_store_dwordx2 v[92:93], v201, s[36:39], s69 offen offset:2048 sc0 sc1
v_cvt_pk_bf16_f32 v94, v15, v31
v_cvt_pk_bf16_f32 v95, v47, v63
buffer_store_dwordx2 v[94:95], v201, s[36:39], s69 offen offset:3072 sc0 sc1
s_mov_b32 s71, s64
s_add_u32 s63, s63, 1
s_add_u32 s64, s64, 7
s_waitcnt vmcnt(0)
s_barrier
s_cmp_lg_u32 s3, 0
s_cbranch_scc1 L_fl_11
s_mov_b64 exec, 1
v_mov_b32 v183, 1
buffer_store_dword v183, off, s[36:39], s70 sc0 sc1
s_mov_b64 exec, -1
L_fl_11:
s_cmp_lt_u32 s64, 64
s_cbranch_scc1 L_p3
s_lshl_b32 s66, s71, 7
s_add_u32 s66, s66, 16384
v_min_u32 v183, 31, v191
v_lshlrev_b32 v183, 2, v183
L_po_12:
buffer_load_dword v184, v183, s[36:39], s66 offen sc1
s_waitcnt vmcnt(0)
v_cmp_eq_u32 vcc, 0, v184
s_cbranch_vccz L_po_12_ok
s_sub_u32 s56, s56, 1
s_cbranch_scc0 L_po_12
s_endpgm
L_po_12_ok:
s_lshl_b32 s66, s71, 20
s_lshl_b32 s52, s60, 10
s_add_u32 s66, s66, s52
s_add_u32 s66, s66, 50331648
buffer_load_dwordx4 v[208:211], v202, s[36:39], s66 offen sc1
s_add_u32 s66, s66, 131072
buffer_load_dwordx4 v[212:215], v202, s[36:39], s66 offen sc1
s_add_u32 s66, s66, 131072
buffer_load_dwordx4 v[216:219], v202, s[36:39], s66 offen sc1
s_add_u32 s66, s66, 131072
buffer_load_dwordx4 v[220:223], v202, s[36:39], s66 offen sc1
s_add_u32 s66, s66, 131072
buffer_load_dwordx4 v[224:227], v202, s[36:39], s66 offen sc1
s_add_u32 s66, s66, 131072
buffer_load_dwordx4 v[228:231], v202, s[36:39], s66 offen sc1
s_add_u32 s66, s66, 131072
buffer_load_dwordx4 v[232:235], v202, s[36:39], s66 offen sc1
s_add_u32 s66, s66, 131072
buffer_load_dwordx4 v[236:239], v202, s[36:39], s66 offen sc1
s_waitcnt vmcnt(7)
v_mfma_f32_16x16x32_bf16 v[148:151], v[192:195], v[208:211], 0
s_waitcnt vmcnt(6)
v_mfma_f32_16x16x32_bf16 v[148:151], v[192:195], v[212:215], v[148:151]
s_waitcnt vmcnt(5)
v_mfma_f32_16x16x32_bf16 v[148:151], v[192:195], v[216:219], v[148:151]
s_waitcnt vmcnt(4)
v_mfma_f32_16x16x32_bf16 v[148:151], v[192:195], v[220:223], v[148:151]
s_waitcnt vmcnt(3)
v_mfma_f32_16x16x32_bf16 v[148:151], v[192:195], v[224:227], v[148:151]
s_waitcnt vmcnt(2)
v_mfma_f32_16x16x32_bf16 v[148:151], v[192:195], v[228:231], v[148:151]
s_waitcnt vmcnt(1)
v_mfma_f32_16x16x32_bf16 v[148:151], v[192:195], v[232:235], v[148:151]
s_waitcnt vmcnt(0)
v_mfma_f32_16x16x32_bf16 v[148:151], v[192:195], v[236:239], v[148:151]
s_lshl_b32 s66, s71, 5
s_add_u32 s66, s66, s60
s_lshl_b32 s66, s66, 10
s_nop 4
v_cvt_pk_bf16_f32 v188, v148, v149
v_cvt_pk_bf16_f32 v189, v150, v151
s_mov_b32 exec_hi, 0
buffer_store_dwordx2 v[188:189], v203, s[96:99], s66 offen
s_mov_b32 exec_hi, -1
s_cmp_lg_u32 s4, 32
s_cbranch_scc1 L_w_end
v_lshlrev_b32 v183, 2, v191
v_mov_b32 v184, 0
buffer_store_dword v184, v183, s[40:43], 0 offen sc0 sc1
L_w_end:
s_waitcnt vmcnt(0)
s_endpgm
L_overflow:
v_lshlrev_b32 v1, 2, v0
v_add_u32 v1, 128, v1
v_cmp_eq_u32 vcc, 0, v0
s_nop 1
v_cndmask_b32 v1, v1, 0, vcc
L_ovf_poll:
buffer_load_dword v2, v1, s[40:43], 0 offen sc0 sc1
s_waitcnt vmcnt(0)
s_mov_b32 s52, 0
v_readlane_b32 s60, v2, 0
v_readlane_b32 s61, v2, 1
v_readlane_b32 s62, v2, 2
v_readlane_b32 s63, v2, 3
v_readlane_b32 s64, v2, 4
v_readlane_b32 s65, v2, 5
v_readlane_b32 s66, v2, 6
v_readlane_b32 s67, v2, 7
s_add_u32 s52, s52, s60
s_add_u32 s52, s52, s61
s_add_u32 s52, s52, s62
s_add_u32 s52, s52, s63
s_add_u32 s52, s52, s64
s_add_u32 s52, s52, s65
s_add_u32 s52, s52, s66
s_add_u32 s52, s52, s67
s_cmp_eq_u32 s52, 256
s_cbranch_scc1 L_ovf_all
s_sub_u32 s56, s56, 1
s_cmp_lg_u32 s56, 0
s_cbranch_scc1 L_ovf_poll
L_ovf_bad:
s_movk_i32 s4, 256
s_branch L_have_slot
L_ovf_all:
s_sub_u32 s4, s4, 32
s_max_u32 s52, s60, 32
s_sub_u32 s52, s52, 32
s_cmp_gt_u32 s5, 0
s_cselect_b32 s52, s52, 0
s_add_u32 s4, s4, s52
s_max_u32 s52, s61, 32
s_sub_u32 s52, s52, 32
s_cmp_gt_u32 s5, 1
s_cselect_b32 s52, s52, 0
s_add_u32 s4, s4, s52
s_max_u32 s52, s62, 32
s_sub_u32 s52, s52, 32
s_cmp_gt_u32 s5, 2
s_cselect_b32 s52, s52, 0
s_add_u32 s4, s4, s52
s_max_u32 s52, s63, 32
s_sub_u32 s52, s52, 32
s_cmp_gt_u32 s5, 3
s_cselect_b32 s52, s52, 0
s_add_u32 s4, s4, s52
s_max_u32 s52, s64, 32
s_sub_u32 s52, s52, 32
s_cmp_gt_u32 s5, 4
s_cselect_b32 s52, s52, 0
s_add_u32 s4, s4, s52
s_max_u32 s52, s65, 32
s_sub_u32 s52, s52, 32
s_cmp_gt_u32 s5, 5
s_cselect_b32 s52, s52, 0
s_add_u32 s4, s4, s52
s_max_u32 s52, s66, 32
s_sub_u32 s52, s52, 32
s_cmp_gt_u32 s5, 6
s_cselect_b32 s52, s52, 0
s_add_u32 s4, s4, s52
s_min_u32 s52, s60, 32
s_sub_u32 s53, 32, s52
s_add_u32 s54, s52, 0
s_cmp_lt_u32 s4, s53
s_cbranch_scc1 L_ovf_found
s_sub_u32 s4, s4, s53
s_min_u32 s52, s61, 32
s_sub_u32 s53, 32, s52
s_add_u32 s54, s52, 32
s_cmp_lt_u32 s4, s53
s_cbranch_scc1 L_ovf_found
s_sub_u32 s4, s4, s53
s_min_u32 s52, s62, 32
s_sub_u32 s53, 32, s52
s_add_u32 s54, s52, 64
s_cmp_lt_u32 s4, s53
s_cbranch_scc1 L_ovf_found
s_sub_u32 s4, s4, s53
s_min_u32 s52, s63, 32
s_sub_u32 s53, 32, s52
s_add_u32 s54, s52, 96
s_cmp_lt_u32 s4, s53
s_cbranch_scc1 L_ovf_found
s_sub_u32 s4, s4, s53
s_min_u32 s52, s64, 32
s_sub_u32 s53, 32, s52
s_add_u32 s54, s52, 128
s_cmp_lt_u32 s4, s53
s_cbranch_scc1 L_ovf_found
s_sub_u32 s4, s4, s53
s_min_u32 s52, s65, 32
s_sub_u32 s53, 32, s52
s_add_u32 s54, s52, 160
s_cmp_lt_u32 s4, s53
s_cbranch_scc1 L_ovf_found
s_sub_u32 s4, s4, s53
s_min_u32 s52, s66, 32
s_sub_u32 s53, 32, s52
s_add_u32 s54, s52, 192
s_cmp_lt_u32 s4, s53
s_cbranch_scc1 L_ovf_found
s_sub_u32 s4, s4, s53
s_min_u32 s52, s67, 32
s_sub_u32 s53, 32, s52
s_add_u32 s54, s52, 224
s_cmp_lt_u32 s4, s53
s_cbranch_scc1 L_ovf_found
s_sub_u32 s4, s4, s53
s_branch L_ovf_bad
L_ovf_found:
s_add_u32 s4, s4, s54
s_branch L_have_slot
L_role_r:
s_mov_b32 s60, s4
v_and_b32 v1, 15, v0
v_lshrrev_b32 v2, 4, v0
v_lshlrev_b32 v122, 4, v0
s_lshl_b32 s52, s3, 11
v_add_u32 v107, s52, v122
s_lshl_b32 s52, s3, 15
s_add_u32 s52, s52, 32768
v_add_u32 v123, s52, v122
v_lshrrev_b32 v3, 1, v2
v_and_b32 v4, 1, v2
v_lshlrev_b32 v5, 4, v3
v_lshl_add_u32 v5, v4, 2, v5
v_lshlrev_b32 v12, 2, v3
v_lshl_add_u32 v12, v4, 3, v12
s_lshl_b32 s59, s3, 20
s_lshl_b32 s52, s60, 8
s_and_b32 s53, s3, 1
s_lshl_b32 s53, s53, 7
s_add_u32 s53, s53, s52
v_lshlrev_b32 v6, 13, v12
v_lshl_add_u32 v108, v1, 3, v6
v_add_u32 v108, s53, v108
s_lshl_b32 s53, s3, 6
s_add_u32 s53, s53, s52
v_lshl_add_u32 v109, v1, 2, v6
v_add_u32 v109, s53, v109
s_lshl_b32 s52, s60, 17
s_lshl_b32 s53, s3, 8
s_add_u32 s53, s53, s52
v_lshlrev_b32 v6, 10, v5
v_lshl_add_u32 v110, v1, 4, v6
v_add_u32 v110, s53, v110
s_cmp_lt_u32 s3, 2
s_cselect_b32 s44, s18, s20
s_cselect_b32 s45, s19, s21
s_mov_b32 s46, 4194304
s_mov_b32 s47, 0x20000
s_mov_b32 s48, s22
s_mov_b32 s49, s23
s_mov_b32 s50, 4194304
s_mov_b32 s51, 0x20000
s_mov_b32 s12, s24
s_mov_b32 s13, s25
s_mov_b32 s14, 4194304
s_mov_b32 s15, 0x20000
s_lshl_b32 s64, s60, 13
s_add_u32 s64, s64, 262144
s_lshl_b32 s66, s60, 6
s_add_u32 s66, s66, 262144
s_add_u32 s67, s66, 8192
s_mov_b32 s65, 65536
s_lshl_b32 s52, s60, 2
s_add_u32 s52, s52, s3
s_lshl_b32 s52, s52, 6
v_bfe_u32 v6, v1, 1, 1
v_lshlrev_b32 v7, 5, v6
v_lshl_add_u32 v7, v3, 4, v7
v_and_b32 v6, 1, v1
v_lshl_add_u32 v7, v6, 3, v7
v_lshl_add_u32 v7, v4, 2, v7
v_add_u32 v111, s52, v7
v_mov_b64 v[8:9], 0
v_mov_b64 v[10:11], 0
buffer_store_dwordx4 v[8:11], v107, s[36:39], s64 offen sc0 sc1
buffer_store_dwordx4 v[8:11], v107, s[36:39], s64 offen offset:1024 sc0 sc1
buffer_store_dword v8, v111, s[36:39], s65 offen sc0 sc1
s_xor_b32 s52, s59, 0
buffer_load_dwordx2 v[0:1], v108, s[44:47], s52 offen
s_xor_b32 s52, s59, 8192
buffer_load_dwordx2 v[2:3], v108, s[44:47], s52 offen
s_xor_b32 s52, s59, 131072
buffer_load_dwordx2 v[4:5], v108, s[44:47], s52 offen
s_xor_b32 s52, s59, 139264
buffer_load_dwordx2 v[6:7], v108, s[44:47], s52 offen
s_xor_b32 s52, s59, 16384
buffer_load_dwordx2 v[8:9], v108, s[44:47], s52 offen
s_xor_b32 s52, s59, 24576
buffer_load_dwordx2 v[10:11], v108, s[44:47], s52 offen
s_xor_b32 s52, s59, 147456
buffer_load_dwordx2 v[12:13], v108, s[44:47], s52 offen
s_xor_b32 s52, s59, 155648
buffer_load_dwordx2 v[14:15], v108, s[44:47], s52 offen
s_xor_b32 s52, s59, 262144
buffer_load_dwordx2 v[16:17], v108, s[44:47], s52 offen
s_xor_b32 s52, s59, 270336
buffer_load_dwordx2 v[18:19], v108, s[44:47], s52 offen
s_xor_b32 s52, s59, 393216
buffer_load_dwordx2 v[20:21], v108, s[44:47], s52 offen
s_xor_b32 s52, s59, 401408
buffer_load_dwordx2 v[22:23], v108, s[44:47], s52 offen
s_xor_b32 s52, s59, 278528
buffer_load_dwordx2 v[24:25], v108, s[44:47], s52 offen
s_xor_b32 s52, s59, 286720
buffer_load_dwordx2 v[26:27], v108, s[44:47], s52 offen
s_xor_b32 s52, s59, 409600
buffer_load_dwordx2 v[28:29], v108, s[44:47], s52 offen
s_xor_b32 s52, s59, 417792
buffer_load_dwordx2 v[30:31], v108, s[44:47], s52 offen
s_xor_b32 s52, s59, 0
buffer_load_dword v128, v109, s[48:51], s52 offen
s_xor_b32 s52, s59, 8192
buffer_load_dword v136, v109, s[48:51], s52 offen
s_xor_b32 s52, s59, 131072
buffer_load_dword v129, v109, s[48:51], s52 offen
s_xor_b32 s52, s59, 139264
buffer_load_dword v137, v109, s[48:51], s52 offen
s_xor_b32 s52, s59, 16384
buffer_load_dword v130, v109, s[48:51], s52 offen
s_xor_b32 s52, s59, 24576
buffer_load_dword v138, v109, s[48:51], s52 offen
s_xor_b32 s52, s59, 147456
buffer_load_dword v131, v109, s[48:51], s52 offen
s_xor_b32 s52, s59, 155648
buffer_load_dword v139, v109, s[48:51], s52 offen
s_xor_b32 s52, s59, 262144
buffer_load_dword v132, v109, s[48:51], s52 offen
s_xor_b32 s52, s59, 270336
buffer_load_dword v140, v109, s[48:51], s52 offen
s_xor_b32 s52, s59, 393216
buffer_load_dword v133, v109, s[48:51], s52 offen
s_xor_b32 s52, s59, 401408
buffer_load_dword v141, v109, s[48:51], s52 offen
s_xor_b32 s52, s59, 278528
buffer_load_dword v134, v109, s[48:51], s52 offen
s_xor_b32 s52, s59, 286720
buffer_load_dword v142, v109, s[48:51], s52 offen
s_xor_b32 s52, s59, 409600
buffer_load_dword v135, v109, s[48:51], s52 offen
s_xor_b32 s52, s59, 417792
buffer_load_dword v143, v109, s[48:51], s52 offen
s_xor_b32 s52, s59, 524288
buffer_load_dwordx2 v[32:33], v108, s[44:47], s52 offen
s_xor_b32 s52, s59, 532480
buffer_load_dwordx2 v[34:35], v108, s[44:47], s52 offen
s_xor_b32 s52, s59, 655360
buffer_load_dwordx2 v[36:37], v108, s[44:47], s52 offen
s_xor_b32 s52, s59, 663552
buffer_load_dwordx2 v[38:39], v108, s[44:47], s52 offen
s_xor_b32 s52, s59, 540672
buffer_load_dwordx2 v[40:41], v108, s[44:47], s52 offen
s_xor_b32 s52, s59, 548864
buffer_load_dwordx2 v[42:43], v108, s[44:47], s52 offen
s_xor_b32 s52, s59, 671744
buffer_load_dwordx2 v[44:45], v108, s[44:47], s52 offen
s_xor_b32 s52, s59, 679936
buffer_load_dwordx2 v[46:47], v108, s[44:47], s52 offen
s_xor_b32 s52, s59, 786432
buffer_load_dwordx2 v[48:49], v108, s[44:47], s52 offen
s_xor_b32 s52, s59, 794624
buffer_load_dwordx2 v[50:51], v108, s[44:47], s52 offen
s_xor_b32 s52, s59, 917504
buffer_load_dwordx2 v[52:53], v108, s[44:47], s52 offen
s_xor_b32 s52, s59, 925696
buffer_load_dwordx2 v[54:55], v108, s[44:47], s52 offen
s_xor_b32 s52, s59, 802816
buffer_load_dwordx2 v[56:57], v108, s[44:47], s52 offen
s_xor_b32 s52, s59, 811008
buffer_load_dwordx2 v[58:59], v108, s[44:47], s52 offen
s_xor_b32 s52, s59, 933888
buffer_load_dwordx2 v[60:61], v108, s[44:47], s52 offen
s_xor_b32 s52, s59, 942080
buffer_load_dwordx2 v[62:63], v108, s[44:47], s52 offen
s_xor_b32 s52, s59, 1048576
buffer_load_dword v160, v109, s[48:51], s52 offen
s_xor_b32 s52, s59, 1056768
buffer_load_dword v168, v109, s[48:51], s52 offen
s_xor_b32 s52, s59, 1179648
buffer_load_dword v161, v109, s[48:51], s52 offen
s_xor_b32 s52, s59, 1187840
buffer_load_dword v169, v109, s[48:51], s52 offen
s_xor_b32 s52, s59, 1064960
buffer_load_dword v162, v109, s[48:51], s52 offen
s_xor_b32 s52, s59, 1073152
buffer_load_dword v170, v109, s[48:51], s52 offen
s_xor_b32 s52, s59, 1196032
buffer_load_dword v163, v109, s[48:51], s52 offen
s_xor_b32 s52, s59, 1204224
buffer_load_dword v171, v109, s[48:51], s52 offen
s_xor_b32 s52, s59, 1310720
buffer_load_dword v164, v109, s[48:51], s52 offen
s_xor_b32 s52, s59, 1318912
buffer_load_dword v172, v109, s[48:51], s52 offen
s_xor_b32 s52, s59, 1441792
buffer_load_dword v165, v109, s[48:51], s52 offen
s_xor_b32 s52, s59, 1449984
buffer_load_dword v173, v109, s[48:51], s52 offen
s_xor_b32 s52, s59, 1327104
buffer_load_dword v166, v109, s[48:51], s52 offen
s_xor_b32 s52, s59, 1335296
buffer_load_dword v174, v109, s[48:51], s52 offen
s_xor_b32 s52, s59, 1458176
buffer_load_dword v167, v109, s[48:51], s52 offen
s_xor_b32 s52, s59, 1466368
buffer_load_dword v175, v109, s[48:51], s52 offen
s_mov_b32 s52, 0
buffer_load_dwordx4 v[64:67], v110, s[12:15], s52 offen
s_mov_b32 s52, 1024
buffer_load_dwordx4 v[68:71], v110, s[12:15], s52 offen
s_mov_b32 s52, 8192
buffer_load_dwordx4 v[72:75], v110, s[12:15], s52 offen
s_mov_b32 s52, 9216
buffer_load_dwordx4 v[76:79], v110, s[12:15], s52 offen
s_mov_b32 s52, 2048
buffer_load_dwordx4 v[80:83], v110, s[12:15], s52 offen
s_mov_b32 s52, 3072
buffer_load_dwordx4 v[84:87], v110, s[12:15], s52 offen
s_mov_b32 s52, 10240
buffer_load_dwordx4 v[88:91], v110, s[12:15], s52 offen
s_mov_b32 s52, 11264
buffer_load_dwordx4 v[92:95], v110, s[12:15], s52 offen
s_waitcnt vmcnt(56)
v_perm_b32 v104, v2, v0, s57
v_perm_b32 v105, v2, v0, s58
v_perm_b32 v106, v3, v1, s57
v_perm_b32 v96, v3, v1, s58
v_accvgpr_write_b32 a0, v104
v_accvgpr_write_b32 a8, v105
v_accvgpr_write_b32 a16, v106
v_perm_b32 v104, v6, v4, s57
v_perm_b32 v105, v6, v4, s58
v_perm_b32 v106, v7, v5, s57
v_perm_b32 v97, v7, v5, s58
v_accvgpr_write_b32 a1, v104
v_accvgpr_write_b32 a9, v105
v_accvgpr_write_b32 a17, v106
v_perm_b32 v104, v10, v8, s57
v_perm_b32 v105, v10, v8, s58
v_perm_b32 v106, v11, v9, s57
v_perm_b32 v98, v11, v9, s58
v_accvgpr_write_b32 a2, v104
v_accvgpr_write_b32 a10, v105
v_accvgpr_write_b32 a18, v106
v_perm_b32 v104, v14, v12, s57
v_perm_b32 v105, v14, v12, s58
v_perm_b32 v106, v15, v13, s57
v_perm_b32 v99, v15, v13, s58
v_accvgpr_write_b32 a3, v104
v_accvgpr_write_b32 a11, v105
v_accvgpr_write_b32 a19, v106
v_perm_b32 v104, v18, v16, s57
v_perm_b32 v105, v18, v16, s58
v_perm_b32 v106, v19, v17, s57
v_perm_b32 v100, v19, v17, s58
v_accvgpr_write_b32 a4, v104
v_accvgpr_write_b32 a12, v105
v_accvgpr_write_b32 a20, v106
v_perm_b32 v104, v22, v20, s57
v_perm_b32 v105, v22, v20, s58
v_perm_b32 v106, v23, v21, s57
v_perm_b32 v101, v23, v21, s58
v_accvgpr_write_b32 a5, v104
v_accvgpr_write_b32 a13, v105
v_accvgpr_write_b32 a21, v106
v_perm_b32 v104, v26, v24, s57
v_perm_b32 v105, v26, v24, s58
v_perm_b32 v106, v27, v25, s57
v_perm_b32 v102, v27, v25, s58
v_accvgpr_write_b32 a6, v104
v_accvgpr_write_b32 a14, v105
v_accvgpr_write_b32 a22, v106
v_perm_b32 v104, v30, v28, s57
v_perm_b32 v105, v30, v28, s58
v_perm_b32 v106, v31, v29, s57
v_perm_b32 v103, v31, v29, s58
v_accvgpr_write_b32 a7, v104
v_accvgpr_write_b32 a15, v105
v_accvgpr_write_b32 a23, v106
ds_write_b128 v123, v[96:99] offset:0
ds_write_b128 v123, v[100:103] offset:1024
s_waitcnt lgkmcnt(0)
s_barrier
s_cmp_lg_u32 s3, 0
s_cbranch_scc1 L_team_in
s_cmp_eq_u32 s5, 0
s_cselect_b32 s54, 0x101, 1
s_atomic_add s54, s[32:33], 4 glc
L_team_in:
s_xor_b32 s52, s59, 1048576
buffer_load_dwordx2 v[0:1], v108, s[44:47], s52 offen
s_xor_b32 s52, s59, 1056768
buffer_load_dwordx2 v[2:3], v108, s[44:47], s52 offen
s_xor_b32 s52, s59, 1179648
buffer_load_dwordx2 v[4:5], v108, s[44:47], s52 offen
s_xor_b32 s52, s59, 1187840
buffer_load_dwordx2 v[6:7], v108, s[44:47], s52 offen
s_xor_b32 s52, s59, 1064960
buffer_load_dwordx2 v[8:9], v108, s[44:47], s52 offen
s_xor_b32 s52, s59, 1073152
buffer_load_dwordx2 v[10:11], v108, s[44:47], s52 offen
s_xor_b32 s52, s59, 1196032
buffer_load_dwordx2 v[12:13], v108, s[44:47], s52 offen
s_xor_b32 s52, s59, 1204224
buffer_load_dwordx2 v[14:15], v108, s[44:47], s52 offen
s_xor_b32 s52, s59, 1310720
buffer_load_dwordx2 v[16:17], v108, s[44:47], s52 offen
s_xor_b32 s52, s59, 1318912
buffer_load_dwordx2 v[18:19], v108, s[44:47], s52 offen
s_xor_b32 s52, s59, 1441792
buffer_load_dwordx2 v[20:21], v108, s[44:47], s52 offen
s_xor_b32 s52, s59, 1449984
buffer_load_dwordx2 v[22:23], v108, s[44:47], s52 offen
s_xor_b32 s52, s59, 1327104
buffer_load_dwordx2 v[24:25], v108, s[44:47], s52 offen
s_xor_b32 s52, s59, 1335296
buffer_load_dwordx2 v[26:27], v108, s[44:47], s52 offen
s_xor_b32 s52, s59, 1458176
buffer_load_dwordx2 v[28:29], v108, s[44:47], s52 offen
s_xor_b32 s52, s59, 1466368
buffer_load_dwordx2 v[30:31], v108, s[44:47], s52 offen
s_xor_b32 s52, s59, 524288
buffer_load_dword v144, v109, s[48:51], s52 offen
s_xor_b32 s52, s59, 532480
buffer_load_dword v152, v109, s[48:51], s52 offen
s_xor_b32 s52, s59, 655360
buffer_load_dword v145, v109, s[48:51], s52 offen
s_xor_b32 s52, s59, 663552
buffer_load_dword v153, v109, s[48:51], s52 offen
s_xor_b32 s52, s59, 540672
buffer_load_dword v146, v109, s[48:51], s52 offen
s_xor_b32 s52, s59, 548864
buffer_load_dword v154, v109, s[48:51], s52 offen
s_xor_b32 s52, s59, 671744
buffer_load_dword v147, v109, s[48:51], s52 offen
s_xor_b32 s52, s59, 679936
buffer_load_dword v155, v109, s[48:51], s52 offen
s_xor_b32 s52, s59, 786432
buffer_load_dword v148, v109, s[48:51], s52 offen
s_xor_b32 s52, s59, 794624
buffer_load_dword v156, v109, s[48:51], s52 offen
s_xor_b32 s52, s59, 917504
buffer_load_dword v149, v109, s[48:51], s52 offen
s_xor_b32 s52, s59, 925696
buffer_load_dword v157, v109, s[48:51], s52 offen
s_xor_b32 s52, s59, 802816
buffer_load_dword v150, v109, s[48:51], s52 offen
s_xor_b32 s52, s59, 811008
buffer_load_dword v158, v109, s[48:51], s52 offen
s_xor_b32 s52, s59, 933888
buffer_load_dword v151, v109, s[48:51], s52 offen
s_xor_b32 s52, s59, 942080
buffer_load_dword v159, v109, s[48:51], s52 offen
s_waitcnt vmcnt(56)
v_perm_b32 v104, v34, v32, s57
v_perm_b32 v105, v34, v32, s58
v_perm_b32 v106, v35, v33, s57
v_perm_b32 v96, v35, v33, s58
v_accvgpr_write_b32 a24, v104
v_accvgpr_write_b32 a32, v105
v_accvgpr_write_b32 a40, v106
v_perm_b32 v104, v38, v36, s57
v_perm_b32 v105, v38, v36, s58
v_perm_b32 v106, v39, v37, s57
v_perm_b32 v97, v39, v37, s58
v_accvgpr_write_b32 a25, v104
v_accvgpr_write_b32 a33, v105
v_accvgpr_write_b32 a41, v106
v_perm_b32 v104, v42, v40, s57
v_perm_b32 v105, v42, v40, s58
v_perm_b32 v106, v43, v41, s57
v_perm_b32 v98, v43, v41, s58
v_accvgpr_write_b32 a26, v104
v_accvgpr_write_b32 a34, v105
v_accvgpr_write_b32 a42, v106
v_perm_b32 v104, v46, v44, s57
v_perm_b32 v105, v46, v44, s58
v_perm_b32 v106, v47, v45, s57
v_perm_b32 v99, v47, v45, s58
v_accvgpr_write_b32 a27, v104
v_accvgpr_write_b32 a35, v105
v_accvgpr_write_b32 a43, v106
v_perm_b32 v104, v50, v48, s57
v_perm_b32 v105, v50, v48, s58
v_perm_b32 v106, v51, v49, s57
v_perm_b32 v100, v51, v49, s58
v_accvgpr_write_b32 a28, v104
v_accvgpr_write_b32 a36, v105
v_accvgpr_write_b32 a44, v106
v_perm_b32 v104, v54, v52, s57
v_perm_b32 v105, v54, v52, s58
v_perm_b32 v106, v55, v53, s57
v_perm_b32 v101, v55, v53, s58
v_accvgpr_write_b32 a29, v104
v_accvgpr_write_b32 a37, v105
v_accvgpr_write_b32 a45, v106
v_perm_b32 v104, v58, v56, s57
v_perm_b32 v105, v58, v56, s58
v_perm_b32 v106, v59, v57, s57
v_perm_b32 v102, v59, v57, s58
v_accvgpr_write_b32 a30, v104
v_accvgpr_write_b32 a38, v105
v_accvgpr_write_b32 a46, v106
v_perm_b32 v104, v62, v60, s57
v_perm_b32 v105, v62, v60, s58
v_perm_b32 v106, v63, v61, s57
v_perm_b32 v103, v63, v61, s58
v_accvgpr_write_b32 a31, v104
v_accvgpr_write_b32 a39, v105
v_accvgpr_write_b32 a47, v106
ds_write_b128 v123, v[96:99] offset:2048
ds_write_b128 v123, v[100:103] offset:3072
s_waitcnt lgkmcnt(0)
s_xor_b32 s52, s59, 1572864
buffer_load_dwordx2 v[32:33], v108, s[44:47], s52 offen
s_xor_b32 s52, s59, 1581056
buffer_load_dwordx2 v[34:35], v108, s[44:47], s52 offen
s_xor_b32 s52, s59, 1703936
buffer_load_dwordx2 v[36:37], v108, s[44:47], s52 offen
s_xor_b32 s52, s59, 1712128
buffer_load_dwordx2 v[38:39], v108, s[44:47], s52 offen
s_xor_b32 s52, s59, 1589248
buffer_load_dwordx2 v[40:41], v108, s[44:47], s52 offen
s_xor_b32 s52, s59, 1597440
buffer_load_dwordx2 v[42:43], v108, s[44:47], s52 offen
s_xor_b32 s52, s59, 1720320
buffer_load_dwordx2 v[44:45], v108, s[44:47], s52 offen
s_xor_b32 s52, s59, 1728512
buffer_load_dwordx2 v[46:47], v108, s[44:47], s52 offen
s_xor_b32 s52, s59, 1835008
buffer_load_dwordx2 v[48:49], v108, s[44:47], s52 offen
s_xor_b32 s52, s59, 1843200
buffer_load_dwordx2 v[50:51], v108, s[44:47], s52 offen
s_xor_b32 s52, s59, 1966080
buffer_load_dwordx2 v[52:53], v108, s[44:47], s52 offen
s_xor_b32 s52, s59, 1974272
buffer_load_dwordx2 v[54:55], v108, s[44:47], s52 offen
s_xor_b32 s52, s59, 1851392
buffer_load_dwordx2 v[56:57], v108, s[44:47], s52 offen
s_xor_b32 s52, s59, 1859584
buffer_load_dwordx2 v[58:59], v108, s[44:47], s52 offen
s_xor_b32 s52, s59, 1982464
buffer_load_dwordx2 v[60:61], v108, s[44:47], s52 offen
s_xor_b32 s52, s59, 1990656
buffer_load_dwordx2 v[62:63], v108, s[44:47], s52 offen
s_xor_b32 s52, s59, 1572864
buffer_load_dword v176, v109, s[48:51], s52 offen
s_xor_b32 s52, s59, 1581056
buffer_load_dword v184, v109, s[48:51], s52 offen
s_xor_b32 s52, s59, 1703936
buffer_load_dword v177, v109, s[48:51], s52 offen
s_xor_b32 s52, s59, 1712128
buffer_load_dword v185, v109, s[48:51], s52 offen
s_xor_b32 s52, s59, 1589248
buffer_load_dword v178, v109, s[48:51], s52 offen
s_xor_b32 s52, s59, 1597440
buffer_load_dword v186, v109, s[48:51], s52 offen
s_xor_b32 s52, s59, 1720320
buffer_load_dword v179, v109, s[48:51], s52 offen
s_xor_b32 s52, s59, 1728512
buffer_load_dword v187, v109, s[48:51], s52 offen
s_xor_b32 s52, s59, 1835008
buffer_load_dword v180, v109, s[48:51], s52 offen
s_xor_b32 s52, s59, 1843200
buffer_load_dword v188, v109, s[48:51], s52 offen
s_xor_b32 s52, s59, 1966080
buffer_load_dword v181, v109, s[48:51], s52 offen
s_xor_b32 s52, s59, 1974272
buffer_load_dword v189, v109, s[48:51], s52 offen
s_xor_b32 s52, s59, 1851392
buffer_load_dword v182, v109, s[48:51], s52 offen
s_xor_b32 s52, s59, 1859584
buffer_load_dword v190, v109, s[48:51], s52 offen
s_xor_b32 s52, s59, 1982464
buffer_load_dword v183, v109, s[48:51], s52 offen
s_xor_b32 s52, s59, 1990656
buffer_load_dword v191, v109, s[48:51], s52 offen
v_perm_b32 v104, v136, v128, s57
v_perm_b32 v136, v136, v128, s58
v_mov_b32 v128, v104
v_perm_b32 v104, v137, v129, s57
v_perm_b32 v137, v137, v129, s58
v_mov_b32 v129, v104
v_perm_b32 v104, v138, v130, s57
v_perm_b32 v138, v138, v130, s58
v_mov_b32 v130, v104
v_perm_b32 v104, v139, v131, s57
v_perm_b32 v139, v139, v131, s58
v_mov_b32 v131, v104
v_perm_b32 v104, v140, v132, s57
v_perm_b32 v140, v140, v132, s58
v_mov_b32 v132, v104
v_perm_b32 v104, v141, v133, s57
v_perm_b32 v141, v141, v133, s58
v_mov_b32 v133, v104
v_perm_b32 v104, v142, v134, s57
v_perm_b32 v142, v142, v134, s58
v_mov_b32 v134, v104
v_perm_b32 v104, v143, v135, s57
v_perm_b32 v143, v143, v135, s58
v_mov_b32 v135, v104
s_waitcnt vmcnt(63)
v_perm_b32 v96, v68, v64, s57
v_perm_b32 v97, v76, v72, s57
v_perm_b32 v98, v84, v80, s57
v_perm_b32 v99, v92, v88, s57
ds_write_b128 v123, v[96:99] offset:16384
v_perm_b32 v100, v68, v64, s58
v_perm_b32 v101, v76, v72, s58
v_perm_b32 v102, v84, v80, s58
v_perm_b32 v103, v92, v88, s58
ds_write_b128 v123, v[100:103] offset:18432
s_waitcnt lgkmcnt(0)
v_perm_b32 v96, v69, v65, s57
v_accvgpr_write_b32 a192, v96
v_perm_b32 v97, v77, v73, s57
v_accvgpr_write_b32 a193, v97
v_perm_b32 v98, v85, v81, s57
v_accvgpr_write_b32 a194, v98
v_perm_b32 v99, v93, v89, s57
v_accvgpr_write_b32 a195, v99
v_perm_b32 v100, v69, v65, s58
v_accvgpr_write_b32 a200, v100
v_perm_b32 v101, v77, v73, s58
v_accvgpr_write_b32 a201, v101
v_perm_b32 v102, v85, v81, s58
v_accvgpr_write_b32 a202, v102
v_perm_b32 v103, v93, v89, s58
v_accvgpr_write_b32 a203, v103
v_perm_b32 v96, v70, v66, s57
v_accvgpr_write_b32 a224, v96
v_perm_b32 v97, v78, v74, s57
v_accvgpr_write_b32 a225, v97
v_perm_b32 v98, v86, v82, s57
v_accvgpr_write_b32 a226, v98
v_perm_b32 v99, v94, v90, s57
v_accvgpr_write_b32 a227, v99
v_perm_b32 v100, v70, v66, s58
v_accvgpr_write_b32 a232, v100
v_perm_b32 v101, v78, v74, s58
v_accvgpr_write_b32 a233, v101
v_perm_b32 v102, v86, v82, s58
v_accvgpr_write_b32 a234, v102
v_perm_b32 v103, v94, v90, s58
v_accvgpr_write_b32 a235, v103
v_perm_b32 v96, v71, v67, s57
v_perm_b32 v97, v79, v75, s57
v_perm_b32 v98, v87, v83, s57
v_perm_b32 v99, v95, v91, s57
ds_write_b128 v123, v[96:99] offset:24576
v_perm_b32 v100, v71, v67, s58
v_perm_b32 v101, v79, v75, s58
v_perm_b32 v102, v87, v83, s58
v_perm_b32 v103, v95, v91, s58
ds_write_b128 v123, v[100:103] offset:26624
s_waitcnt lgkmcnt(0)
s_mov_b32 s52, 32768
buffer_load_dwordx4 v[64:67], v110, s[12:15], s52 offen
s_mov_b32 s52, 33792
buffer_load_dwordx4 v[68:71], v110, s[12:15], s52 offen
s_mov_b32 s52, 40960
buffer_load_dwordx4 v[72:75], v110, s[12:15], s52 offen
s_mov_b32 s52, 41984
buffer_load_dwordx4 v[76:79], v110, s[12:15], s52 offen
s_mov_b32 s52, 34816
buffer_load_dwordx4 v[80:83], v110, s[12:15], s52 offen
s_mov_b32 s52, 35840
buffer_load_dwordx4 v[84:87], v110, s[12:15], s52 offen
s_mov_b32 s52, 43008
buffer_load_dwordx4 v[88:91], v110, s[12:15], s52 offen
s_mov_b32 s52, 44032
buffer_load_dwordx4 v[92:95], v110, s[12:15], s52 offen
v_perm_b32 v104, v168, v160, s57
v_perm_b32 v168, v168, v160, s58
v_mov_b32 v160, v104
v_perm_b32 v104, v169, v161, s57
v_perm_b32 v169, v169, v161, s58
v_mov_b32 v161, v104
v_perm_b32 v104, v170, v162, s57
v_perm_b32 v170, v170, v162, s58
v_mov_b32 v162, v104
v_perm_b32 v104, v171, v163, s57
v_perm_b32 v171, v171, v163, s58
v_mov_b32 v163, v104
v_perm_b32 v104, v172, v164, s57
v_perm_b32 v172, v172, v164, s58
v_mov_b32 v164, v104
v_perm_b32 v104, v173, v165, s57
v_perm_b32 v173, v173, v165, s58
v_mov_b32 v165, v104
v_perm_b32 v104, v174, v166, s57
v_perm_b32 v174, v174, v166, s58
v_mov_b32 v166, v104
v_perm_b32 v104, v175, v167, s57
v_perm_b32 v175, v175, v167, s58
v_mov_b32 v167, v104
s_waitcnt vmcnt(56)
v_perm_b32 v104, v2, v0, s57
v_perm_b32 v105, v2, v0, s58
v_perm_b32 v106, v3, v1, s57
v_perm_b32 v96, v3, v1, s58
v_accvgpr_write_b32 a48, v104
v_accvgpr_write_b32 a56, v105
v_accvgpr_write_b32 a64, v106
v_perm_b32 v104, v6, v4, s57
v_perm_b32 v105, v6, v4, s58
v_perm_b32 v106, v7, v5, s57
v_perm_b32 v97, v7, v5, s58
v_accvgpr_write_b32 a49, v104
v_accvgpr_write_b32 a57, v105
v_accvgpr_write_b32 a65, v106
v_perm_b32 v104, v10, v8, s57
v_perm_b32 v105, v10, v8, s58
v_perm_b32 v106, v11, v9, s57
v_perm_b32 v98, v11, v9, s58
v_accvgpr_write_b32 a50, v104
v_accvgpr_write_b32 a58, v105
v_accvgpr_write_b32 a66, v106
v_perm_b32 v104, v14, v12, s57
v_perm_b32 v105, v14, v12, s58
v_perm_b32 v106, v15, v13, s57
v_perm_b32 v99, v15, v13, s58
v_accvgpr_write_b32 a51, v104
v_accvgpr_write_b32 a59, v105
v_accvgpr_write_b32 a67, v106
v_perm_b32 v104, v18, v16, s57
v_perm_b32 v105, v18, v16, s58
v_perm_b32 v106, v19, v17, s57
v_perm_b32 v100, v19, v17, s58
v_accvgpr_write_b32 a52, v104
v_accvgpr_write_b32 a60, v105
v_accvgpr_write_b32 a68, v106
v_perm_b32 v104, v22, v20, s57
v_perm_b32 v105, v22, v20, s58
v_perm_b32 v106, v23, v21, s57
v_perm_b32 v101, v23, v21, s58
v_accvgpr_write_b32 a53, v104
v_accvgpr_write_b32 a61, v105
v_accvgpr_write_b32 a69, v106
v_perm_b32 v104, v26, v24, s57
v_perm_b32 v105, v26, v24, s58
v_perm_b32 v106, v27, v25, s57
v_perm_b32 v102, v27, v25, s58
v_accvgpr_write_b32 a54, v104
v_accvgpr_write_b32 a62, v105
v_accvgpr_write_b32 a70, v106
v_perm_b32 v104, v30, v28, s57
v_perm_b32 v105, v30, v28, s58
v_perm_b32 v106, v31, v29, s57
v_perm_b32 v103, v31, v29, s58
v_accvgpr_write_b32 a55, v104
v_accvgpr_write_b32 a63, v105
v_accvgpr_write_b32 a71, v106
ds_write_b128 v123, v[96:99] offset:4096
ds_write_b128 v123, v[100:103] offset:5120
s_waitcnt lgkmcnt(0)
buffer_load_dword v112, off, s[40:43], 0 offset:192 sc0 sc1
s_xor_b32 s52, s59, 2097152
buffer_load_dwordx2 v[0:1], v108, s[44:47], s52 offen
s_xor_b32 s52, s59, 2105344
buffer_load_dwordx2 v[2:3], v108, s[44:47], s52 offen
s_xor_b32 s52, s59, 2228224
buffer_load_dwordx2 v[4:5], v108, s[44:47], s52 offen
s_xor_b32 s52, s59, 2236416
buffer_load_dwordx2 v[6:7], v108, s[44:47], s52 offen
s_xor_b32 s52, s59, 2113536
buffer_load_dwordx2 v[8:9], v108, s[44:47], s52 offen
s_xor_b32 s52, s59, 2121728
buffer_load_dwordx2 v[10:11], v108, s[44:47], s52 offen
s_xor_b32 s52, s59, 2244608
buffer_load_dwordx2 v[12:13], v108, s[44:47], s52 offen
s_xor_b32 s52, s59, 2252800
buffer_load_dwordx2 v[14:15], v108, s[44:47], s52 offen
s_xor_b32 s52, s59, 2359296
buffer_load_dwordx2 v[16:17], v108, s[44:47], s52 offen
s_xor_b32 s52, s59, 2367488
buffer_load_dwordx2 v[18:19], v108, s[44:47], s52 offen
s_xor_b32 s52, s59, 2490368
buffer_load_dwordx2 v[20:21], v108, s[44:47], s52 offen
s_xor_b32 s52, s59, 2498560
buffer_load_dwordx2 v[22:23], v108, s[44:47], s52 offen
s_xor_b32 s52, s59, 2375680
buffer_load_dwordx2 v[24:25], v108, s[44:47], s52 offen
s_xor_b32 s52, s59, 2383872
buffer_load_dwordx2 v[26:27], v108, s[44:47], s52 offen
s_xor_b32 s52, s59, 2506752
buffer_load_dwordx2 v[28:29], v108, s[44:47], s52 offen
s_xor_b32 s52, s59, 2514944
buffer_load_dwordx2 v[30:31], v108, s[44:47], s52 offen
s_xor_b32 s52, s59, 2097152
buffer_load_dword v192, v109, s[48:51], s52 offen
s_xor_b32 s52, s59, 2105344
buffer_load_dword v200, v109, s[48:51], s52 offen
s_xor_b32 s52, s59, 2228224
buffer_load_dword v193, v109, s[48:51], s52 offen
s_xor_b32 s52, s59, 2236416
buffer_load_dword v201, v109, s[48:51], s52 offen
s_xor_b32 s52, s59, 2113536
buffer_load_dword v194, v109, s[48:51], s52 offen
s_xor_b32 s52, s59, 2121728
buffer_load_dword v202, v109, s[48:51], s52 offen
s_xor_b32 s52, s59, 2244608
buffer_load_dword v195, v109, s[48:51], s52 offen
s_xor_b32 s52, s59, 2252800
buffer_load_dword v203, v109, s[48:51], s52 offen
s_xor_b32 s52, s59, 2359296
buffer_load_dword v196, v109, s[48:51], s52 offen
s_xor_b32 s52, s59, 2367488
buffer_load_dword v204, v109, s[48:51], s52 offen
s_xor_b32 s52, s59, 2490368
buffer_load_dword v197, v109, s[48:51], s52 offen
s_xor_b32 s52, s59, 2498560
buffer_load_dword v205, v109, s[48:51], s52 offen
s_xor_b32 s52, s59, 2375680
buffer_load_dword v198, v109, s[48:51], s52 offen
s_xor_b32 s52, s59, 2383872
buffer_load_dword v206, v109, s[48:51], s52 offen
s_xor_b32 s52, s59, 2506752
buffer_load_dword v199, v109, s[48:51], s52 offen
s_xor_b32 s52, s59, 2514944
buffer_load_dword v207, v109, s[48:51], s52 offen
s_waitcnt vmcnt(57)
v_perm_b32 v104, v34, v32, s57
v_perm_b32 v105, v34, v32, s58
v_perm_b32 v106, v35, v33, s57
v_perm_b32 v96, v35, v33, s58
v_accvgpr_write_b32 a72, v104
v_accvgpr_write_b32 a80, v105
v_accvgpr_write_b32 a88, v106
v_perm_b32 v104, v38, v36, s57
v_perm_b32 v105, v38, v36, s58
v_perm_b32 v106, v39, v37, s57
v_perm_b32 v97, v39, v37, s58
v_accvgpr_write_b32 a73, v104
v_accvgpr_write_b32 a81, v105
v_accvgpr_write_b32 a89, v106
v_perm_b32 v104, v42, v40, s57
v_perm_b32 v105, v42, v40, s58
v_perm_b32 v106, v43, v41, s57
v_perm_b32 v98, v43, v41, s58
v_accvgpr_write_b32 a74, v104
v_accvgpr_write_b32 a82, v105
v_accvgpr_write_b32 a90, v106
v_perm_b32 v104, v46, v44, s57
v_perm_b32 v105, v46, v44, s58
v_perm_b32 v106, v47, v45, s57
v_perm_b32 v99, v47, v45, s58
v_accvgpr_write_b32 a75, v104
v_accvgpr_write_b32 a83, v105
v_accvgpr_write_b32 a91, v106
v_perm_b32 v104, v50, v48, s57
v_perm_b32 v105, v50, v48, s58
v_perm_b32 v106, v51, v49, s57
v_perm_b32 v100, v51, v49, s58
v_accvgpr_write_b32 a76, v104
v_accvgpr_write_b32 a84, v105
v_accvgpr_write_b32 a92, v106
v_perm_b32 v104, v54, v52, s57
v_perm_b32 v105, v54, v52, s58
v_perm_b32 v106, v55, v53, s57
v_perm_b32 v101, v55, v53, s58
v_accvgpr_write_b32 a77, v104
v_accvgpr_write_b32 a85, v105
v_accvgpr_write_b32 a93, v106
v_perm_b32 v104, v58, v56, s57
v_perm_b32 v105, v58, v56, s58
v_perm_b32 v106, v59, v57, s57
v_perm_b32 v102, v59, v57, s58
v_accvgpr_write_b32 a78, v104
v_accvgpr_write_b32 a86, v105
v_accvgpr_write_b32 a94, v106
v_perm_b32 v104, v62, v60, s57
v_perm_b32 v105, v62, v60, s58
v_perm_b32 v106, v63, v61, s57
v_perm_b32 v103, v63, v61, s58
v_accvgpr_write_b32 a79, v104
v_accvgpr_write_b32 a87, v105
v_accvgpr_write_b32 a95, v106
ds_write_b128 v123, v[96:99] offset:6144
ds_write_b128 v123, v[100:103] offset:7168
s_waitcnt lgkmcnt(0)
s_xor_b32 s52, s59, 2621440
buffer_load_dwordx2 v[32:33], v108, s[44:47], s52 offen
s_xor_b32 s52, s59, 2629632
buffer_load_dwordx2 v[34:35], v108, s[44:47], s52 offen
s_xor_b32 s52, s59, 2752512
buffer_load_dwordx2 v[36:37], v108, s[44:47], s52 offen
s_xor_b32 s52, s59, 2760704
buffer_load_dwordx2 v[38:39], v108, s[44:47], s52 offen
s_xor_b32 s52, s59, 2637824
buffer_load_dwordx2 v[40:41], v108, s[44:47], s52 offen
s_xor_b32 s52, s59, 2646016
buffer_load_dwordx2 v[42:43], v108, s[44:47], s52 offen
s_xor_b32 s52, s59, 2768896
buffer_load_dwordx2 v[44:45], v108, s[44:47], s52 offen
s_xor_b32 s52, s59, 2777088
buffer_load_dwordx2 v[46:47], v108, s[44:47], s52 offen
s_xor_b32 s52, s59, 2883584
buffer_load_dwordx2 v[48:49], v108, s[44:47], s52 offen
s_xor_b32 s52, s59, 2891776
buffer_load_dwordx2 v[50:51], v108, s[44:47], s52 offen
s_xor_b32 s52, s59, 3014656
buffer_load_dwordx2 v[52:53], v108, s[44:47], s52 offen
s_xor_b32 s52, s59, 3022848
buffer_load_dwordx2 v[54:55], v108, s[44:47], s52 offen
s_xor_b32 s52, s59, 2899968
buffer_load_dwordx2 v[56:57], v108, s[44:47], s52 offen
s_xor_b32 s52, s59, 2908160
buffer_load_dwordx2 v[58:59], v108, s[44:47], s52 offen
s_xor_b32 s52, s59, 3031040
buffer_load_dwordx2 v[60:61], v108, s[44:47], s52 offen
s_xor_b32 s52, s59, 3039232
buffer_load_dwordx2 v[62:63], v108, s[44:47], s52 offen
s_xor_b32 s52, s59, 3145728
buffer_load_dword v224, v109, s[48:51], s52 offen
s_xor_b32 s52, s59, 3153920
buffer_load_dword v232, v109, s[48:51], s52 offen
s_xor_b32 s52, s59, 3276800
buffer_load_dword v225, v109, s[48:51], s52 offen
s_xor_b32 s52, s59, 3284992
buffer_load_dword v233, v109, s[48:51], s52 offen
s_xor_b32 s52, s59, 3162112
buffer_load_dword v226, v109, s[48:51], s52 offen
s_xor_b32 s52, s59, 3170304
buffer_load_dword v234, v109, s[48:51], s52 offen
s_xor_b32 s52, s59, 3293184
buffer_load_dword v227, v109, s[48:51], s52 offen
s_xor_b32 s52, s59, 3301376
buffer_load_dword v235, v109, s[48:51], s52 offen
s_xor_b32 s52, s59, 3407872
buffer_load_dword v228, v109, s[48:51], s52 offen
s_xor_b32 s52, s59, 3416064
buffer_load_dword v236, v109, s[48:51], s52 offen
s_xor_b32 s52, s59, 3538944
buffer_load_dword v229, v109, s[48:51], s52 offen
s_xor_b32 s52, s59, 3547136
buffer_load_dword v237, v109, s[48:51], s52 offen
s_xor_b32 s52, s59, 3424256
buffer_load_dword v230, v109, s[48:51], s52 offen
s_xor_b32 s52, s59, 3432448
buffer_load_dword v238, v109, s[48:51], s52 offen
s_xor_b32 s52, s59, 3555328
buffer_load_dword v231, v109, s[48:51], s52 offen
s_xor_b32 s52, s59, 3563520
buffer_load_dword v239, v109, s[48:51], s52 offen
v_perm_b32 v104, v152, v144, s57
v_perm_b32 v152, v152, v144, s58
v_mov_b32 v144, v104
v_perm_b32 v104, v153, v145, s57
v_perm_b32 v153, v153, v145, s58
v_mov_b32 v145, v104
v_perm_b32 v104, v154, v146, s57
v_perm_b32 v154, v154, v146, s58
v_mov_b32 v146, v104
v_perm_b32 v104, v155, v147, s57
v_perm_b32 v155, v155, v147, s58
v_mov_b32 v147, v104
v_perm_b32 v104, v156, v148, s57
v_perm_b32 v156, v156, v148, s58
v_mov_b32 v148, v104
v_perm_b32 v104, v157, v149, s57
v_perm_b32 v157, v157, v149, s58
v_mov_b32 v149, v104
v_perm_b32 v104, v158, v150, s57
v_perm_b32 v158, v158, v150, s58
v_mov_b32 v150, v104
v_perm_b32 v104, v159, v151, s57
v_perm_b32 v159, v159, v151, s58
v_mov_b32 v151, v104
s_waitcnt vmcnt(63)
v_perm_b32 v96, v68, v64, s57
v_perm_b32 v97, v76, v72, s57
v_perm_b32 v98, v84, v80, s57
v_perm_b32 v99, v92, v88, s57
ds_write_b128 v123, v[96:99] offset:17408
v_perm_b32 v100, v68, v64, s58
v_perm_b32 v101, v76, v72, s58
v_perm_b32 v102, v84, v80, s58
v_perm_b32 v103, v92, v88, s58
ds_write_b128 v123, v[100:103] offset:19456
s_waitcnt lgkmcnt(0)
v_perm_b32 v96, v69, v65, s57
v_accvgpr_write_b32 a196, v96
v_perm_b32 v97, v77, v73, s57
v_accvgpr_write_b32 a197, v97
v_perm_b32 v98, v85, v81, s57
v_accvgpr_write_b32 a198, v98
v_perm_b32 v99, v93, v89, s57
v_accvgpr_write_b32 a199, v99
v_perm_b32 v100, v69, v65, s58
v_accvgpr_write_b32 a204, v100
v_perm_b32 v101, v77, v73, s58
v_accvgpr_write_b32 a205, v101
v_perm_b32 v102, v85, v81, s58
v_accvgpr_write_b32 a206, v102
v_perm_b32 v103, v93, v89, s58
v_accvgpr_write_b32 a207, v103
v_perm_b32 v96, v70, v66, s57
v_accvgpr_write_b32 a228, v96
v_perm_b32 v97, v78, v74, s57
v_accvgpr_write_b32 a229, v97
v_perm_b32 v98, v86, v82, s57
v_accvgpr_write_b32 a230, v98
v_perm_b32 v99, v94, v90, s57
v_accvgpr_write_b32 a231, v99
v_perm_b32 v100, v70, v66, s58
v_accvgpr_write_b32 a236, v100
v_perm_b32 v101, v78, v74, s58
v_accvgpr_write_b32 a237, v101
v_perm_b32 v102, v86, v82, s58
v_accvgpr_write_b32 a238, v102
v_perm_b32 v103, v94, v90, s58
v_accvgpr_write_b32 a239, v103
v_perm_b32 v96, v71, v67, s57
v_perm_b32 v97, v79, v75, s57
v_perm_b32 v98, v87, v83, s57
v_perm_b32 v99, v95, v91, s57
ds_write_b128 v123, v[96:99] offset:25600
v_perm_b32 v100, v71, v67, s58
v_perm_b32 v101, v79, v75, s58
v_perm_b32 v102, v87, v83, s58
v_perm_b32 v103, v95, v91, s58
ds_write_b128 v123, v[100:103] offset:27648
s_waitcnt lgkmcnt(0)
s_mov_b32 s52, 65536
buffer_load_dwordx4 v[64:67], v110, s[12:15], s52 offen
s_mov_b32 s52, 66560
buffer_load_dwordx4 v[68:71], v110, s[12:15], s52 offen
s_mov_b32 s52, 73728
buffer_load_dwordx4 v[72:75], v110, s[12:15], s52 offen
s_mov_b32 s52, 74752
buffer_load_dwordx4 v[76:79], v110, s[12:15], s52 offen
s_mov_b32 s52, 67584
buffer_load_dwordx4 v[80:83], v110, s[12:15], s52 offen
s_mov_b32 s52, 68608
buffer_load_dwordx4 v[84:87], v110, s[12:15], s52 offen
s_mov_b32 s52, 75776
buffer_load_dwordx4 v[88:91], v110, s[12:15], s52 offen
s_mov_b32 s52, 76800
buffer_load_dwordx4 v[92:95], v110, s[12:15], s52 offen
v_perm_b32 v104, v184, v176, s57
v_perm_b32 v184, v184, v176, s58
v_mov_b32 v176, v104
v_perm_b32 v104, v185, v177, s57
v_perm_b32 v185, v185, v177, s58
v_mov_b32 v177, v104
v_perm_b32 v104, v186, v178, s57
v_perm_b32 v186, v186, v178, s58
v_mov_b32 v178, v104
v_perm_b32 v104, v187, v179, s57
v_perm_b32 v187, v187, v179, s58
v_mov_b32 v179, v104
v_perm_b32 v104, v188, v180, s57
v_perm_b32 v188, v188, v180, s58
v_mov_b32 v180, v104
v_perm_b32 v104, v189, v181, s57
v_perm_b32 v189, v189, v181, s58
v_mov_b32 v181, v104
v_perm_b32 v104, v190, v182, s57
v_perm_b32 v190, v190, v182, s58
v_mov_b32 v182, v104
v_perm_b32 v104, v191, v183, s57
v_perm_b32 v191, v191, v183, s58
v_mov_b32 v183, v104
s_waitcnt vmcnt(56)
v_perm_b32 v104, v2, v0, s57
v_perm_b32 v105, v2, v0, s58
v_perm_b32 v106, v3, v1, s57
v_perm_b32 v96, v3, v1, s58
v_accvgpr_write_b32 a96, v104
v_accvgpr_write_b32 a104, v105
v_accvgpr_write_b32 a112, v106
v_perm_b32 v104, v6, v4, s57
v_perm_b32 v105, v6, v4, s58
v_perm_b32 v106, v7, v5, s57
v_perm_b32 v97, v7, v5, s58
v_accvgpr_write_b32 a97, v104
v_accvgpr_write_b32 a105, v105
v_accvgpr_write_b32 a113, v106
v_perm_b32 v104, v10, v8, s57
v_perm_b32 v105, v10, v8, s58
v_perm_b32 v106, v11, v9, s57
v_perm_b32 v98, v11, v9, s58
v_accvgpr_write_b32 a98, v104
v_accvgpr_write_b32 a106, v105
v_accvgpr_write_b32 a114, v106
v_perm_b32 v104, v14, v12, s57
v_perm_b32 v105, v14, v12, s58
v_perm_b32 v106, v15, v13, s57
v_perm_b32 v99, v15, v13, s58
v_accvgpr_write_b32 a99, v104
v_accvgpr_write_b32 a107, v105
v_accvgpr_write_b32 a115, v106
v_perm_b32 v104, v18, v16, s57
v_perm_b32 v105, v18, v16, s58
v_perm_b32 v106, v19, v17, s57
v_perm_b32 v100, v19, v17, s58
v_accvgpr_write_b32 a100, v104
v_accvgpr_write_b32 a108, v105
v_accvgpr_write_b32 a116, v106
v_perm_b32 v104, v22, v20, s57
v_perm_b32 v105, v22, v20, s58
v_perm_b32 v106, v23, v21, s57
v_perm_b32 v101, v23, v21, s58
v_accvgpr_write_b32 a101, v104
v_accvgpr_write_b32 a109, v105
v_accvgpr_write_b32 a117, v106
v_perm_b32 v104, v26, v24, s57
v_perm_b32 v105, v26, v24, s58
v_perm_b32 v106, v27, v25, s57
v_perm_b32 v102, v27, v25, s58
v_accvgpr_write_b32 a102, v104
v_accvgpr_write_b32 a110, v105
v_accvgpr_write_b32 a118, v106
v_perm_b32 v104, v30, v28, s57
v_perm_b32 v105, v30, v28, s58
v_perm_b32 v106, v31, v29, s57
v_perm_b32 v103, v31, v29, s58
v_accvgpr_write_b32 a103, v104
v_accvgpr_write_b32 a111, v105
v_accvgpr_write_b32 a119, v106
ds_write_b128 v123, v[96:99] offset:8192
ds_write_b128 v123, v[100:103] offset:9216
s_waitcnt lgkmcnt(0)
v_readfirstlane_b32 s53, v112
s_cmp_eq_u32 s53, 0
s_cbranch_scc1 L_ri_w
L_ri_ok:
s_xor_b32 s52, s59, 3145728
buffer_load_dwordx2 v[0:1], v108, s[44:47], s52 offen
s_xor_b32 s52, s59, 3153920
buffer_load_dwordx2 v[2:3], v108, s[44:47], s52 offen
s_xor_b32 s52, s59, 3276800
buffer_load_dwordx2 v[4:5], v108, s[44:47], s52 offen
s_xor_b32 s52, s59, 3284992
buffer_load_dwordx2 v[6:7], v108, s[44:47], s52 offen
s_xor_b32 s52, s59, 3162112
buffer_load_dwordx2 v[8:9], v108, s[44:47], s52 offen
s_xor_b32 s52, s59, 3170304
buffer_load_dwordx2 v[10:11], v108, s[44:47], s52 offen
s_xor_b32 s52, s59, 3293184
buffer_load_dwordx2 v[12:13], v108, s[44:47], s52 offen
s_xor_b32 s52, s59, 3301376
buffer_load_dwordx2 v[14:15], v108, s[44:47], s52 offen
s_xor_b32 s52, s59, 3407872
buffer_load_dwordx2 v[16:17], v108, s[44:47], s52 offen
s_xor_b32 s52, s59, 3416064
buffer_load_dwordx2 v[18:19], v108, s[44:47], s52 offen
s_xor_b32 s52, s59, 3538944
buffer_load_dwordx2 v[20:21], v108, s[44:47], s52 offen
s_xor_b32 s52, s59, 3547136
buffer_load_dwordx2 v[22:23], v108, s[44:47], s52 offen
s_xor_b32 s52, s59, 3424256
buffer_load_dwordx2 v[24:25], v108, s[44:47], s52 offen
s_xor_b32 s52, s59, 3432448
buffer_load_dwordx2 v[26:27], v108, s[44:47], s52 offen
s_xor_b32 s52, s59, 3555328
buffer_load_dwordx2 v[28:29], v108, s[44:47], s52 offen
s_xor_b32 s52, s59, 3563520
buffer_load_dwordx2 v[30:31], v108, s[44:47], s52 offen
s_xor_b32 s52, s59, 2621440
buffer_load_dword v208, v109, s[48:51], s52 offen
s_xor_b32 s52, s59, 2629632
buffer_load_dword v216, v109, s[48:51], s52 offen
s_xor_b32 s52, s59, 2752512
buffer_load_dword v209, v109, s[48:51], s52 offen
s_xor_b32 s52, s59, 2760704
buffer_load_dword v217, v109, s[48:51], s52 offen
s_xor_b32 s52, s59, 2637824
buffer_load_dword v210, v109, s[48:51], s52 offen
s_xor_b32 s52, s59, 2646016
buffer_load_dword v218, v109, s[48:51], s52 offen
s_xor_b32 s52, s59, 2768896
buffer_load_dword v211, v109, s[48:51], s52 offen
s_xor_b32 s52, s59, 2777088
buffer_load_dword v219, v109, s[48:51], s52 offen
s_xor_b32 s52, s59, 2883584
buffer_load_dword v212, v109, s[48:51], s52 offen
s_xor_b32 s52, s59, 2891776
buffer_load_dword v220, v109, s[48:51], s52 offen
s_xor_b32 s52, s59, 3014656
buffer_load_dword v213, v109, s[48:51], s52 offen
s_xor_b32 s52, s59, 3022848
buffer_load_dword v221, v109, s[48:51], s52 offen
s_xor_b32 s52, s59, 2899968
buffer_load_dword v214, v109, s[48:51], s52 offen
s_xor_b32 s52, s59, 2908160
buffer_load_dword v222, v109, s[48:51], s52 offen
s_xor_b32 s52, s59, 3031040
buffer_load_dword v215, v109, s[48:51], s52 offen
s_xor_b32 s52, s59, 3039232
buffer_load_dword v223, v109, s[48:51], s52 offen
s_waitcnt vmcnt(56)
v_perm_b32 v104, v34, v32, s57
v_perm_b32 v105, v34, v32, s58
v_perm_b32 v106, v35, v33, s57
v_perm_b32 v96, v35, v33, s58
v_accvgpr_write_b32 a120, v104
v_accvgpr_write_b32 a128, v105
v_accvgpr_write_b32 a136, v106
v_perm_b32 v104, v38, v36, s57
v_perm_b32 v105, v38, v36, s58
v_perm_b32 v106, v39, v37, s57
v_perm_b32 v97, v39, v37, s58
v_accvgpr_write_b32 a121, v104
v_accvgpr_write_b32 a129, v105
v_accvgpr_write_b32 a137, v106
v_perm_b32 v104, v42, v40, s57
v_perm_b32 v105, v42, v40, s58
v_perm_b32 v106, v43, v41, s57
v_perm_b32 v98, v43, v41, s58
v_accvgpr_write_b32 a122, v104
v_accvgpr_write_b32 a130, v105
v_accvgpr_write_b32 a138, v106
v_perm_b32 v104, v46, v44, s57
v_perm_b32 v105, v46, v44, s58
v_perm_b32 v106, v47, v45, s57
v_perm_b32 v99, v47, v45, s58
v_accvgpr_write_b32 a123, v104
v_accvgpr_write_b32 a131, v105
v_accvgpr_write_b32 a139, v106
v_perm_b32 v104, v50, v48, s57
v_perm_b32 v105, v50, v48, s58
v_perm_b32 v106, v51, v49, s57
v_perm_b32 v100, v51, v49, s58
v_accvgpr_write_b32 a124, v104
v_accvgpr_write_b32 a132, v105
v_accvgpr_write_b32 a140, v106
v_perm_b32 v104, v54, v52, s57
v_perm_b32 v105, v54, v52, s58
v_perm_b32 v106, v55, v53, s57
v_perm_b32 v101, v55, v53, s58
v_accvgpr_write_b32 a125, v104
v_accvgpr_write_b32 a133, v105
v_accvgpr_write_b32 a141, v106
v_perm_b32 v104, v58, v56, s57
v_perm_b32 v105, v58, v56, s58
v_perm_b32 v106, v59, v57, s57
v_perm_b32 v102, v59, v57, s58
v_accvgpr_write_b32 a126, v104
v_accvgpr_write_b32 a134, v105
v_accvgpr_write_b32 a142, v106
v_perm_b32 v104, v62, v60, s57
v_perm_b32 v105, v62, v60, s58
v_perm_b32 v106, v63, v61, s57
v_perm_b32 v103, v63, v61, s58
v_accvgpr_write_b32 a127, v104
v_accvgpr_write_b32 a135, v105
v_accvgpr_write_b32 a143, v106
ds_write_b128 v123, v[96:99] offset:10240
ds_write_b128 v123, v[100:103] offset:11264
s_waitcnt lgkmcnt(0)
s_lshl_b32 s53, s60, 8
v_lshrrev_b32 v114, 2, v122
buffer_load_dword v112, off, s[40:43], 0 offset:4 sc0 sc1
buffer_load_dword v113, v114, s[36:39], s53 offen sc1
s_xor_b32 s52, s59, 3670016
buffer_load_dwordx2 v[32:33], v108, s[44:47], s52 offen
s_xor_b32 s52, s59, 3678208
buffer_load_dwordx2 v[34:35], v108, s[44:47], s52 offen
s_xor_b32 s52, s59, 3801088
buffer_load_dwordx2 v[36:37], v108, s[44:47], s52 offen
s_xor_b32 s52, s59, 3809280
buffer_load_dwordx2 v[38:39], v108, s[44:47], s52 offen
s_xor_b32 s52, s59, 3686400
buffer_load_dwordx2 v[40:41], v108, s[44:47], s52 offen
s_xor_b32 s52, s59, 3694592
buffer_load_dwordx2 v[42:43], v108, s[44:47], s52 offen
s_xor_b32 s52, s59, 3817472
buffer_load_dwordx2 v[44:45], v108, s[44:47], s52 offen
s_xor_b32 s52, s59, 3825664
buffer_load_dwordx2 v[46:47], v108, s[44:47], s52 offen
s_xor_b32 s52, s59, 3932160
buffer_load_dwordx2 v[48:49], v108, s[44:47], s52 offen
s_xor_b32 s52, s59, 3940352
buffer_load_dwordx2 v[50:51], v108, s[44:47], s52 offen
s_xor_b32 s52, s59, 4063232
buffer_load_dwordx2 v[52:53], v108, s[44:47], s52 offen
s_xor_b32 s52, s59, 4071424
buffer_load_dwordx2 v[54:55], v108, s[44:47], s52 offen
s_xor_b32 s52, s59, 3948544
buffer_load_dwordx2 v[56:57], v108, s[44:47], s52 offen
s_xor_b32 s52, s59, 3956736
buffer_load_dwordx2 v[58:59], v108, s[44:47], s52 offen
s_xor_b32 s52, s59, 4079616
buffer_load_dwordx2 v[60:61], v108, s[44:47], s52 offen
s_xor_b32 s52, s59, 4087808
buffer_load_dwordx2 v[62:63], v108, s[44:47], s52 offen
s_xor_b32 s52, s59, 3670016
buffer_load_dword v240, v109, s[48:51], s52 offen
s_xor_b32 s52, s59, 3678208
buffer_load_dword v248, v109, s[48:51], s52 offen
s_xor_b32 s52, s59, 3801088
buffer_load_dword v241, v109, s[48:51], s52 offen
s_xor_b32 s52, s59, 3809280
buffer_load_dword v249, v109, s[48:51], s52 offen
s_xor_b32 s52, s59, 3686400
buffer_load_dword v242, v109, s[48:51], s52 offen
s_xor_b32 s52, s59, 3694592
buffer_load_dword v250, v109, s[48:51], s52 offen
s_xor_b32 s52, s59, 3817472
buffer_load_dword v243, v109, s[48:51], s52 offen
s_xor_b32 s52, s59, 3825664
buffer_load_dword v251, v109, s[48:51], s52 offen
s_xor_b32 s52, s59, 3932160
buffer_load_dword v244, v109, s[48:51], s52 offen
s_xor_b32 s52, s59, 3940352
buffer_load_dword v252, v109, s[48:51], s52 offen
s_xor_b32 s52, s59, 4063232
buffer_load_dword v245, v109, s[48:51], s52 offen
s_xor_b32 s52, s59, 4071424
buffer_load_dword v253, v109, s[48:51], s52 offen
s_xor_b32 s52, s59, 3948544
buffer_load_dword v246, v109, s[48:51], s52 offen
s_xor_b32 s52, s59, 3956736
buffer_load_dword v254, v109, s[48:51], s52 offen
s_xor_b32 s52, s59, 4079616
buffer_load_dword v247, v109, s[48:51], s52 offen
s_xor_b32 s52, s59, 4087808
buffer_load_dword v255, v109, s[48:51], s52 offen
v_perm_b32 v104, v200, v192, s57
v_perm_b32 v200, v200, v192, s58
v_mov_b32 v192, v104
v_perm_b32 v104, v201, v193, s57
v_perm_b32 v201, v201, v193, s58
v_mov_b32 v193, v104
v_perm_b32 v104, v202, v194, s57
v_perm_b32 v202, v202, v194, s58
v_mov_b32 v194, v104
v_perm_b32 v104, v203, v195, s57
v_perm_b32 v203, v203, v195, s58
v_mov_b32 v195, v104
v_perm_b32 v104, v204, v196, s57
v_perm_b32 v204, v204, v196, s58
v_mov_b32 v196, v104
v_perm_b32 v104, v205, v197, s57
v_perm_b32 v205, v205, v197, s58
v_mov_b32 v197, v104
v_perm_b32 v104, v206, v198, s57
v_perm_b32 v206, v206, v198, s58
v_mov_b32 v198, v104
v_perm_b32 v104, v207, v199, s57
v_perm_b32 v207, v207, v199, s58
v_mov_b32 v199, v104
s_waitcnt vmcnt(63)
v_perm_b32 v96, v68, v64, s57
v_perm_b32 v97, v76, v72, s57
v_perm_b32 v98, v84, v80, s57
v_perm_b32 v99, v92, v88, s57
ds_write_b128 v123, v[96:99] offset:20480
v_perm_b32 v100, v68, v64, s58
v_perm_b32 v101, v76, v72, s58
v_perm_b32 v102, v84, v80, s58
v_perm_b32 v103, v92, v88, s58
ds_write_b128 v123, v[100:103] offset:22528
s_waitcnt lgkmcnt(0)
v_perm_b32 v96, v69, v65, s57
v_accvgpr_write_b32 a208, v96
v_perm_b32 v97, v77, v73, s57
v_accvgpr_write_b32 a209, v97
v_perm_b32 v98, v85, v81, s57
v_accvgpr_write_b32 a210, v98
v_perm_b32 v99, v93, v89, s57
v_accvgpr_write_b32 a211, v99
v_perm_b32 v100, v69, v65, s58
v_accvgpr_write_b32 a216, v100
v_perm_b32 v101, v77, v73, s58
v_accvgpr_write_b32 a217, v101
v_perm_b32 v102, v85, v81, s58
v_accvgpr_write_b32 a218, v102
v_perm_b32 v103, v93, v89, s58
v_accvgpr_write_b32 a219, v103
v_perm_b32 v96, v70, v66, s57
v_accvgpr_write_b32 a240, v96
v_perm_b32 v97, v78, v74, s57
v_accvgpr_write_b32 a241, v97
v_perm_b32 v98, v86, v82, s57
v_accvgpr_write_b32 a242, v98
v_perm_b32 v99, v94, v90, s57
v_accvgpr_write_b32 a243, v99
v_perm_b32 v100, v70, v66, s58
v_accvgpr_write_b32 a248, v100
v_perm_b32 v101, v78, v74, s58
v_accvgpr_write_b32 a249, v101
v_perm_b32 v102, v86, v82, s58
v_accvgpr_write_b32 a250, v102
v_perm_b32 v103, v94, v90, s58
v_accvgpr_write_b32 a251, v103
v_perm_b32 v96, v71, v67, s57
v_perm_b32 v97, v79, v75, s57
v_perm_b32 v98, v87, v83, s57
v_perm_b32 v99, v95, v91, s57
ds_write_b128 v123, v[96:99] offset:28672
v_perm_b32 v100, v71, v67, s58
v_perm_b32 v101, v79, v75, s58
v_perm_b32 v102, v87, v83, s58
v_perm_b32 v103, v95, v91, s58
ds_write_b128 v123, v[100:103] offset:30720
s_waitcnt lgkmcnt(0)
s_mov_b32 s52, 98304
buffer_load_dwordx4 v[64:67], v110, s[12:15], s52 offen
s_mov_b32 s52, 99328
buffer_load_dwordx4 v[68:71], v110, s[12:15], s52 offen
s_mov_b32 s52, 106496
buffer_load_dwordx4 v[72:75], v110, s[12:15], s52 offen
s_mov_b32 s52, 107520
buffer_load_dwordx4 v[76:79], v110, s[12:15], s52 offen
s_mov_b32 s52, 100352
buffer_load_dwordx4 v[80:83], v110, s[12:15], s52 offen
s_mov_b32 s52, 101376
buffer_load_dwordx4 v[84:87], v110, s[12:15], s52 offen
s_mov_b32 s52, 108544
buffer_load_dwordx4 v[88:91], v110, s[12:15], s52 offen
s_mov_b32 s52, 109568
buffer_load_dwordx4 v[92:95], v110, s[12:15], s52 offen
v_perm_b32 v104, v232, v224, s57
v_perm_b32 v232, v232, v224, s58
v_mov_b32 v224, v104
v_perm_b32 v104, v233, v225, s57
v_perm_b32 v233, v233, v225, s58
v_mov_b32 v225, v104
v_perm_b32 v104, v234, v226, s57
v_perm_b32 v234, v234, v226, s58
v_mov_b32 v226, v104
v_perm_b32 v104, v235, v227, s57
v_perm_b32 v235, v235, v227, s58
v_mov_b32 v227, v104
v_perm_b32 v104, v236, v228, s57
v_perm_b32 v236, v236, v228, s58
v_mov_b32 v228, v104
v_perm_b32 v104, v237, v229, s57
v_perm_b32 v237, v237, v229, s58
v_mov_b32 v229, v104
v_perm_b32 v104, v238, v230, s57
v_perm_b32 v238, v238, v230, s58
v_mov_b32 v230, v104
v_perm_b32 v104, v239, v231, s57
v_perm_b32 v239, v239, v231, s58
v_mov_b32 v231, v104
s_waitcnt vmcnt(58)
v_perm_b32 v104, v2, v0, s57
v_perm_b32 v105, v2, v0, s58
v_perm_b32 v106, v3, v1, s57
v_perm_b32 v96, v3, v1, s58
v_accvgpr_write_b32 a144, v104
v_accvgpr_write_b32 a152, v105
v_accvgpr_write_b32 a160, v106
v_perm_b32 v104, v6, v4, s57
v_perm_b32 v105, v6, v4, s58
v_perm_b32 v106, v7, v5, s57
v_perm_b32 v97, v7, v5, s58
v_accvgpr_write_b32 a145, v104
v_accvgpr_write_b32 a153, v105
v_accvgpr_write_b32 a161, v106
v_perm_b32 v104, v10, v8, s57
v_perm_b32 v105, v10, v8, s58
v_perm_b32 v106, v11, v9, s57
v_perm_b32 v98, v11, v9, s58
v_accvgpr_write_b32 a146, v104
v_accvgpr_write_b32 a154, v105
v_accvgpr_write_b32 a162, v106
v_perm_b32 v104, v14, v12, s57
v_perm_b32 v105, v14, v12, s58
v_perm_b32 v106, v15, v13, s57
v_perm_b32 v99, v15, v13, s58
v_accvgpr_write_b32 a147, v104
v_accvgpr_write_b32 a155, v105
v_accvgpr_write_b32 a163, v106
v_perm_b32 v104, v18, v16, s57
v_perm_b32 v105, v18, v16, s58
v_perm_b32 v106, v19, v17, s57
v_perm_b32 v100, v19, v17, s58
v_accvgpr_write_b32 a148, v104
v_accvgpr_write_b32 a156, v105
v_accvgpr_write_b32 a164, v106
v_perm_b32 v104, v22, v20, s57
v_perm_b32 v105, v22, v20, s58
v_perm_b32 v106, v23, v21, s57
v_perm_b32 v101, v23, v21, s58
v_accvgpr_write_b32 a149, v104
v_accvgpr_write_b32 a157, v105
v_accvgpr_write_b32 a165, v106
v_perm_b32 v104, v26, v24, s57
v_perm_b32 v105, v26, v24, s58
v_perm_b32 v106, v27, v25, s57
v_perm_b32 v102, v27, v25, s58
v_accvgpr_write_b32 a150, v104
v_accvgpr_write_b32 a158, v105
v_accvgpr_write_b32 a166, v106
v_perm_b32 v104, v30, v28, s57
v_perm_b32 v105, v30, v28, s58
v_perm_b32 v106, v31, v29, s57
v_perm_b32 v103, v31, v29, s58
v_accvgpr_write_b32 a151, v104
v_accvgpr_write_b32 a159, v105
v_accvgpr_write_b32 a167, v106
ds_write_b128 v123, v[96:99] offset:12288
ds_write_b128 v123, v[100:103] offset:13312
s_waitcnt lgkmcnt(0)
v_lshrrev_b32 v0, 4, v122
v_and_b32 v1, 15, v0
v_lshrrev_b32 v2, 4, v0
v_lshrrev_b32 v3, 1, v2
v_and_b32 v4, 1, v2
v_lshrrev_b32 v5, 2, v1
v_and_b32 v6, 1, v1
v_lshl_add_u32 v5, v5, 1, v6
v_bfe_u32 v16, v1, 1, 1
v_lshlrev_b32 v121, 9, v3
v_lshl_add_u32 v121, v5, 6, v121
v_lshl_add_u32 v121, v4, 5, v121
v_lshl_add_u32 v121, v16, 4, v121
s_mov_b32 s70, 0xcccccccc
s_mov_b32 s71, 0xcccccccc
s_mov_b32 s72, 0x000f000f
s_mov_b32 s73, 0x000f000f
v_mov_b32 v7, 0x44444444
v_mov_b32 v8, 0x4e4eeeee
v_cndmask_b32 v120, v7, v8, s[70:71]
v_mov_b32 v7, 0x0000ffff
v_mov_b32 v8, 0xffff0000
v_cndmask_b32 v7, v7, v8, s[70:71]
v_cmp_gt_u32 vcc, 32, v0
s_movk_i32 s54, 288
s_lshr_b32 s52, s3, 1
v_cndmask_b32 v18, 0, v7, vcc
v_cndmask_b32 v19, v7, 0, vcc
s_mul_i32 s52, s52, 2304
s_and_b32 s53, s3, 1
s_lshl_b32 s53, s53, 7
s_add_u32 s52, s52, s53
s_add_u32 s52, s52, 24576
v_mul_lo_u32 v7, v2, s54
v_lshlrev_b32 v7, 1, v7
v_lshl_add_u32 v7, v1, 3, v7
v_add_u32 v124, s52, v7
v_mul_lo_u32 v7, v5, s54
v_lshl_add_u32 v7, v2, 4, v7
v_add_u32 v125, 24576, v7
v_lshrrev_b32 v7, 3, v1
v_bfe_u32 v8, v1, 2, 1
v_lshl_add_u32 v7, v8, 1, v7
v_lshl_add_u32 v7, v7, 1, v6
v_mul_lo_u32 v7, v7, s54
v_lshl_add_u32 v7, v2, 4, v7
v_add_u32 v126, 26880, v7
s_lshl_b32 s52, s3, 6
s_add_u32 s52, s52, 26880
v_lshrrev_b32 v7, 3, v0
v_mul_lo_u32 v7, v7, s54
v_and_b32 v8, 7, v0
v_lshl_add_u32 v7, v8, 3, v7
v_add_u32 v20, s52, v7
s_lshl_b32 s52, s3, 9
s_add_u32 s52, s52, 30208
v_lshlrev_b32 v7, 7, v2
v_lshl_add_u32 v7, v1, 2, v7
v_add_u32 v127, s52, v7
v_lshrrev_b32 v7, 2, v1
v_lshlrev_b32 v8, 14, v7
v_lshl_add_u32 v8, v2, 11, v8
v_and_b32 v9, 3, v1
v_lshl_add_u32 v8, v9, 4, v8
s_lshl_b32 s52, s3, 16
v_add_u32 v17, s52, v8
v_mov_b32 v10, 0x3f80
v_mov_b32 v11, 0x3f800000
v_cmp_eq_u32 vcc, 1, v6
s_nop 1
v_cndmask_b32 v10, v10, v11, vcc
v_cmp_gt_u32 vcc, 2, v9
s_nop 1
v_cndmask_b32 v10, 0, v10, vcc
v_cmp_eq_u32 vcc, 0, v7
s_nop 1
v_cndmask_b32 v12, 0, v10, vcc
v_cmp_eq_u32 vcc, 1, v7
s_nop 1
v_cndmask_b32 v13, 0, v10, vcc
v_cmp_eq_u32 vcc, 2, v7
s_nop 1
v_cndmask_b32 v14, 0, v10, vcc
v_cmp_eq_u32 vcc, 3, v7
s_nop 1
v_cndmask_b32 v15, 0, v10, vcc
ds_write_b128 v122, v[12:15] offset:29184
s_mov_b32 s44, s16
s_mov_b32 s45, s17
s_mov_b32 s46, 8192
s_mov_b32 s47, 0x20000
s_lshl_b32 s52, s3, 8
v_lshlrev_b32 v9, 10, v5
v_lshl_add_u32 v9, v3, 6, v9
v_lshl_add_u32 v9, v16, 5, v9
v_lshl_add_u32 v9, v4, 3, v9
buffer_load_dwordx2 v[24:25], v9, s[44:47], s52 offen offset:0
buffer_load_dwordx2 v[26:27], v9, s[44:47], s52 offen offset:16
buffer_load_dwordx2 v[28:29], v9, s[44:47], s52 offen offset:128
buffer_load_dwordx2 v[30:31], v9, s[44:47], s52 offen offset:144
s_mov_b32 s74, 0x3e0293ee
s_mov_b32 s6, 0x41c00000
s_mov_b32 s61, 0
s_lshl_b32 s52, s60, 14
s_add_u32 s62, s52, 16777216
s_lshl_b32 s52, s60, 2
s_add_u32 s52, s52, s3
s_lshl_b32 s52, s52, 10
s_add_u32 s63, s52, 917504
s_lshl_b32 s75, s60, 8
s_add_u32 s75, s75, 8184
s_lshl_b32 s52, s3, 11
s_add_u32 s76, s52, 8192
s_add_u32 s77, s52, 16384
s_mov_b64 s[0:1], 0
s_waitcnt vmcnt(44)
v_cmp_ne_u32 s[68:69], 0, v113
L_team_chk:
v_readfirstlane_b32 s55, v112
s_and_b32 s52, s55, 0xff
s_cmp_eq_u32 s52, 32
s_cbranch_scc0 L_team_w
s_nop 3
s_bitcmp1_b64 s[68:69], s61
s_cselect_b32 s9, 0, 1
s_cbranch_scc0 L_kv_late
s_mov_b32 m0, s76
s_add_u32 s52, s62, 8192
buffer_load_dwordx4 v107, s[36:39], s62 offen sc1 lds
buffer_load_dwordx4 v107, s[36:39], s62 offen offset:1024 sc1 lds
buffer_load_dwordx4 v[112:115], v107, s[36:39], s52 offen sc1
buffer_load_dwordx4 v[116:119], v107, s[36:39], s52 offen offset:1024 sc1
s_add_u32 s62, s62, 524288
L_kv_back:
s_waitcnt vmcnt(28)
v_perm_b32 v104, v34, v32, s57
v_perm_b32 v105, v34, v32, s58
v_perm_b32 v106, v35, v33, s57
v_perm_b32 v96, v35, v33, s58
v_accvgpr_write_b32 a168, v104
v_accvgpr_write_b32 a176, v105
v_accvgpr_write_b32 a184, v106
v_perm_b32 v104, v38, v36, s57
v_perm_b32 v105, v38, v36, s58
v_perm_b32 v106, v39, v37, s57
v_perm_b32 v97, v39, v37, s58
v_accvgpr_write_b32 a169, v104
v_accvgpr_write_b32 a177, v105
v_accvgpr_write_b32 a185, v106
v_perm_b32 v104, v42, v40, s57
v_perm_b32 v105, v42, v40, s58
v_perm_b32 v106, v43, v41, s57
v_perm_b32 v98, v43, v41, s58
v_accvgpr_write_b32 a170, v104
v_accvgpr_write_b32 a178, v105
v_accvgpr_write_b32 a186, v106
v_perm_b32 v104, v46, v44, s57
v_perm_b32 v105, v46, v44, s58
v_perm_b32 v106, v47, v45, s57
v_perm_b32 v99, v47, v45, s58
v_accvgpr_write_b32 a171, v104
v_accvgpr_write_b32 a179, v105
v_accvgpr_write_b32 a187, v106
v_perm_b32 v104, v50, v48, s57
v_perm_b32 v105, v50, v48, s58
v_perm_b32 v106, v51, v49, s57
v_perm_b32 v100, v51, v49, s58
v_accvgpr_write_b32 a172, v104
v_accvgpr_write_b32 a180, v105
v_accvgpr_write_b32 a188, v106
v_perm_b32 v104, v54, v52, s57
v_perm_b32 v105, v54, v52, s58
v_perm_b32 v106, v55, v53, s57
v_perm_b32 v101, v55, v53, s58
v_accvgpr_write_b32 a173, v104
v_accvgpr_write_b32 a181, v105
v_accvgpr_write_b32 a189, v106
v_perm_b32 v104, v58, v56, s57
v_perm_b32 v105, v58, v56, s58
v_perm_b32 v106, v59, v57, s57
v_perm_b32 v102, v59, v57, s58
v_accvgpr_write_b32 a174, v104
v_accvgpr_write_b32 a182, v105
v_accvgpr_write_b32 a190, v106
v_perm_b32 v104, v62, v60, s57
v_perm_b32 v105, v62, v60, s58
v_perm_b32 v106, v63, v61, s57
v_perm_b32 v103, v63, v61, s58
v_accvgpr_write_b32 a175, v104
v_accvgpr_write_b32 a183, v105
v_accvgpr_write_b32 a191, v106
ds_write_b128 v123, v[96:99] offset:14336
ds_write_b128 v123, v[100:103] offset:15360
s_waitcnt lgkmcnt(0)
v_perm_b32 v104, v216, v208, s57
v_perm_b32 v216, v216, v208, s58
v_mov_b32 v208, v104
v_perm_b32 v104, v217, v209, s57
v_perm_b32 v217, v217, v209, s58
v_mov_b32 v209, v104
v_perm_b32 v104, v218, v210, s57
v_perm_b32 v218, v218, v210, s58
v_mov_b32 v210, v104
v_perm_b32 v104, v219, v211, s57
v_perm_b32 v219, v219, v211, s58
v_mov_b32 v211, v104
v_perm_b32 v104, v220, v212, s57
v_perm_b32 v220, v220, v212, s58
v_mov_b32 v212, v104
v_perm_b32 v104, v221, v213, s57
v_perm_b32 v221, v221, v213, s58
v_mov_b32 v213, v104
v_perm_b32 v104, v222, v214, s57
v_perm_b32 v222, v222, v214, s58
v_mov_b32 v214, v104
v_perm_b32 v104, v223, v215, s57
v_perm_b32 v223, v223, v215, s58
v_mov_b32 v215, v104
s_waitcnt vmcnt(4)
v_perm_b32 v96, v68, v64, s57
v_perm_b32 v97, v76, v72, s57
v_perm_b32 v98, v84, v80, s57
v_perm_b32 v99, v92, v88, s57
ds_write_b128 v123, v[96:99] offset:21504
v_perm_b32 v100, v68, v64, s58
v_perm_b32 v101, v76, v72, s58
v_perm_b32 v102, v84, v80, s58
v_perm_b32 v103, v92, v88, s58
ds_write_b128 v123, v[100:103] offset:23552
s_waitcnt lgkmcnt(0)
v_perm_b32 v96, v69, v65, s57
v_accvgpr_write_b32 a212, v96
v_perm_b32 v97, v77, v73, s57
v_accvgpr_write_b32 a213, v97
v_perm_b32 v98, v85, v81, s57
v_accvgpr_write_b32 a214, v98
v_perm_b32 v99, v93, v89, s57
v_accvgpr_write_b32 a215, v99
v_perm_b32 v100, v69, v65, s58
v_accvgpr_write_b32 a220, v100
v_perm_b32 v101, v77, v73, s58
v_accvgpr_write_b32 a221, v101
v_perm_b32 v102, v85, v81, s58
v_accvgpr_write_b32 a222, v102
v_perm_b32 v103, v93, v89, s58
v_accvgpr_write_b32 a223, v103
v_perm_b32 v96, v70, v66, s57
v_accvgpr_write_b32 a244, v96
v_perm_b32 v97, v78, v74, s57
v_accvgpr_write_b32 a245, v97
v_perm_b32 v98, v86, v82, s57
v_accvgpr_write_b32 a246, v98
v_perm_b32 v99, v94, v90, s57
v_accvgpr_write_b32 a247, v99
v_perm_b32 v100, v70, v66, s58
v_accvgpr_write_b32 a252, v100
v_perm_b32 v101, v78, v74, s58
v_accvgpr_write_b32 a253, v101
v_perm_b32 v102, v86, v82, s58
v_accvgpr_write_b32 a254, v102
v_perm_b32 v103, v94, v90, s58
v_accvgpr_write_b32 a255, v103
v_perm_b32 v96, v71, v67, s57
v_perm_b32 v97, v79, v75, s57
v_perm_b32 v98, v87, v83, s57
v_perm_b32 v99, v95, v91, s57
ds_write_b128 v123, v[96:99] offset:29696
v_perm_b32 v100, v71, v67, s58
v_perm_b32 v101, v79, v75, s58
v_perm_b32 v102, v87, v83, s58
v_perm_b32 v103, v95, v91, s58
ds_write_b128 v123, v[100:103] offset:31744
s_waitcnt lgkmcnt(0)
v_perm_b32 v104, v248, v240, s57
v_perm_b32 v248, v248, v240, s58
v_mov_b32 v240, v104
v_perm_b32 v104, v249, v241, s57
v_perm_b32 v249, v249, v241, s58
v_mov_b32 v241, v104
v_perm_b32 v104, v250, v242, s57
v_perm_b32 v250, v250, v242, s58
v_mov_b32 v242, v104
v_perm_b32 v104, v251, v243, s57
v_perm_b32 v251, v251, v243, s58
v_mov_b32 v243, v104
v_perm_b32 v104, v252, v244, s57
v_perm_b32 v252, v252, v244, s58
v_mov_b32 v244, v104
v_perm_b32 v104, v253, v245, s57
v_perm_b32 v253, v253, v245, s58
v_mov_b32 v245, v104
v_perm_b32 v104, v254, v246, s57
v_perm_b32 v254, v254, v246, s58
v_mov_b32 v246, v104
v_perm_b32 v104, v255, v247, s57
v_perm_b32 v255, v255, v247, s58
v_mov_b32 v247, v104
v_mov_b32 v95, v111
v_mov_b32 v91, v17
v_mov_b32 v99, v18
v_mov_b32 v103, v19
v_mov_b32 v111, v20
v_mov_b32 v104, 0x3f803f80
v_mov_b32 v105, 0x3f803f80
v_mov_b32 v106, 0x3f803f80
v_mov_b32 v108, 0x3f803f80
v_mov_b32 v109, 0x3f803f80
v_mov_b32 v110, 0x3f803f80
s_cmp_eq_u32 s9, 1
s_cbranch_scc1 L_kv_late2
L_kv_back2:
ds_read_b128 v[32:35], v123 offset:0
ds_read_b128 v[36:39], v123 offset:1024
ds_read_b128 v[40:43], v123 offset:2048
ds_read_b128 v[44:47], v123 offset:3072
ds_read_b128 v[48:51], v123 offset:4096
ds_read_b128 v[52:55], v123 offset:5120
ds_read_b128 v[56:59], v123 offset:6144
ds_read_b128 v[60:63], v123 offset:7168
v_mov_b64 v[64:65], 0
v_mov_b64 v[66:67], 0
v_mov_b64 v[68:69], 0
v_mov_b64 v[70:71], 0
v_mov_b64 v[72:73], 0
v_mov_b64 v[74:75], 0
v_mov_b64 v[76:77], 0
v_mov_b64 v[78:79], 0
v_mov_b64 v[80:81], 0
v_mov_b64 v[82:83], 0
v_mov_b64 v[84:85], 0
v_mov_b64 v[86:87], 0
s_waitcnt vmcnt(0) lgkmcnt(0)
v_mov_b64 v[0:1], v[24:25]
v_mov_b64 v[2:3], v[26:27]
v_mov_b64 v[4:5], v[28:29]
v_mov_b64 v[6:7], v[30:31]
v_mov_b64 v[88:89], v[112:113]
v_mov_b64 v[92:93], v[114:115]
v_mov_b64 v[96:97], v[116:117]
v_mov_b64 v[100:101], v[118:119]
v_xor_b32 v20, 2048, v107
v_xor_b32 v28, 4096, v107
v_xor_b32 v12, 6144, v107
ds_write_b128 v107, v[0:3]
ds_write_b128 v107, v[4:7] offset:1024
s_lshr_b32 s55, s55, 8
s_cmp_eq_u32 s55, 32
s_cbranch_scc0 L_r_slow_first
s_branch L_r_fast_first
L_ri_w:
buffer_load_dword v112, off, s[40:43], 0 offset:192 sc0 sc1
s_waitcnt vmcnt(0)
v_readfirstlane_b32 s53, v112
s_cmp_lg_u32 s53, 0
s_cbranch_scc1 L_ri_ok
s_sub_u32 s56, s56, 1
s_cbranch_scc0 L_ri_w
s_endpgm
L_team_w:
buffer_load_dword v112, off, s[40:43], 0 offset:4 sc0 sc1
s_waitcnt vmcnt(0)
s_sub_u32 s56, s56, 1
s_cbranch_scc0 L_team_chk
s_endpgm
L_kv_late:
s_lshl_b32 s53, s60, 8
buffer_load_dword v113, v114, s[36:39], s53 offen sc1
s_branch L_kv_back
L_kv_late2:
s_waitcnt vmcnt(0)
v_cmp_ne_u32 s[68:69], 0, v113
s_nop 4
s_bitcmp1_b64 s[68:69], s61
s_cbranch_scc0 L_kv_6001_w
L_kv_6001_ok:
s_mov_b32 m0, s76
s_add_u32 s52, s62, 8192
buffer_load_dwordx4 v107, s[36:39], s62 offen sc1 lds
buffer_load_dwordx4 v107, s[36:39], s62 offen offset:1024 sc1 lds
buffer_load_dwordx4 v[112:115], v107, s[36:39], s52 offen sc1
buffer_load_dwordx4 v[116:119], v107, s[36:39], s52 offen offset:1024 sc1
s_add_u32 s62, s62, 524288
s_branch L_kv_back2
L_kv_6001_w:
s_lshl_b32 s53, s60, 8
v_lshrrev_b32 v2, 2, v122
L_kv_6001:
buffer_load_dword v3, v2, s[36:39], s53 offen sc1
s_waitcnt vmcnt(0)
v_cmp_ne_u32 s[68:69], 0, v3
s_nop 4
s_bitcmp1_b64 s[68:69], s61
s_cbranch_scc1 L_kv_6001_ok
s_sub_u32 s56, s56, 1
s_cbranch_scc0 L_kv_6001
s_endpgm
.p2align 6
L_r_fast_H0:
s_waitcnt vmcnt(1)
ds_write_b128 v107, v[0:3]
v_smfmac_f32_16x16x64_bf16 v[64:67], v[0:3], a[0:7], v120
s_waitcnt vmcnt(0)
ds_write_b128 v107, v[4:7] offset:1024
v_bitop3_b32 v14, v0, v1, v2 bitop3:0xfe
v_bitop3_b32 v15, v3, v4, v5 bitop3:0xfe
v_smfmac_f32_16x16x64_bf16 v[68:71], v[0:3], a[8:15], v120
v_bitop3_b32 v14, v14, v6, v7 bitop3:0xfe
v_bitop3_b32 v14, v14, v15, 1 bitop3:0xa8
v_cmp_ne_u32 vcc, 0, v14
s_cbranch_vccnz L_r_fast_HR0
L_r_fast_A0:
v_smfmac_f32_16x16x64_bf16 v[72:75], v[0:3], a[16:23], v120
v_smfmac_f32_16x16x64_bf16 v[76:79], v[0:3], v[32:39], v120
v_smfmac_f32_16x16x64_bf16 v[64:67], v[4:7], a[24:31], v120
s_waitcnt lgkmcnt(0)
s_barrier
ds_read_b128 v[16:19], v20 offset:0
ds_read_b128 v[20:23], v20 offset:1024
v_smfmac_f32_16x16x64_bf16 v[68:71], v[4:7], a[32:39], v120
ds_read_b128 v[24:27], v28 offset:0
v_smfmac_f32_16x16x64_bf16 v[72:75], v[4:7], a[40:47], v120
ds_read_b128 v[28:31], v28 offset:1024
v_smfmac_f32_16x16x64_bf16 v[76:79], v[4:7], v[40:47], v120
v_smfmac_f32_16x16x64_bf16 v[80:83], v[0:3], v[128:135], v120
ds_read_b128 v[32:35], v123 offset:8192
s_add_u32 s54, s61, 1
v_smfmac_f32_16x16x64_bf16 v[84:87], v[0:3], v[136:143], v120
ds_read_b128 v[36:39], v123 offset:9216
s_add_u32 s52, s62, 8192
v_smfmac_f32_16x16x64_bf16 v[80:83], v[4:7], v[144:151], v120
ds_read_b128 v[40:43], v123 offset:10240
s_mov_b32 m0, s77
v_smfmac_f32_16x16x64_bf16 v[84:87], v[4:7], v[152:159], v120
ds_read_b128 v[44:47], v123 offset:11264
s_waitcnt lgkmcnt(7)
v_smfmac_f32_16x16x64_bf16 v[64:67], v[16:19], a[48:55], v120
ds_read_b128 v[0:3], v12 offset:0
v_smfmac_f32_16x16x64_bf16 v[68:71], v[16:19], a[56:63], v120
ds_read_b128 v[4:7], v12 offset:1024
s_cmp_eq_u64 s[68:69], -1
s_cbranch_scc0 L_kv_2001_w
L_kv_2001_ok:
v_smfmac_f32_16x16x64_bf16 v[72:75], v[16:19], a[64:71], v120
buffer_store_dwordx4 v[112:115], v122, s[36:39], s63 offen sc0 sc1
s_add_u32 s63, s63, 131072
v_smfmac_f32_16x16x64_bf16 v[76:79], v[16:19], v[48:55], v120
s_waitcnt lgkmcnt(8)
ds_read_b128 v[48:51], v123 offset:12288
v_smfmac_f32_16x16x64_bf16 v[64:67], v[20:23], a[72:79], v120
ds_read_b128 v[52:55], v123 offset:13312
v_smfmac_f32_16x16x64_bf16 v[68:71], v[20:23], a[80:87], v120
buffer_load_dwordx4 v107, s[36:39], s62 offen sc1 lds
v_smfmac_f32_16x16x64_bf16 v[72:75], v[20:23], a[88:95], v120
buffer_load_dwordx4 v107, s[36:39], s62 offen offset:1024 sc1 lds
v_smfmac_f32_16x16x64_bf16 v[76:79], v[20:23], v[56:63], v120
s_waitcnt lgkmcnt(9)
ds_read_b128 v[56:59], v123 offset:14336
v_smfmac_f32_16x16x64_bf16 v[64:67], v[24:27], a[96:103], v120
ds_read_b128 v[60:63], v123 offset:15360
v_smfmac_f32_16x16x64_bf16 v[68:71], v[24:27], a[104:111], v120
buffer_load_dwordx4 v[112:115], v107, s[36:39], s52 offen sc1
v_smfmac_f32_16x16x64_bf16 v[72:75], v[24:27], a[112:119], v120
s_waitcnt lgkmcnt(8)
buffer_load_dwordx4 v[116:119], v107, s[36:39], s52 offen offset:1024 sc1
s_add_u32 s62, s62, 524288
v_smfmac_f32_16x16x64_bf16 v[76:79], v[24:27], v[32:39], v120
ds_read_b128 v[32:35], v122 offset:8192
v_smfmac_f32_16x16x64_bf16 v[64:67], v[28:31], a[120:127], v120
ds_read_b128 v[36:39], v122 offset:12288
v_smfmac_f32_16x16x64_bf16 v[68:71], v[28:31], a[128:135], v120
s_mov_b64 exec, s[0:1]
buffer_store_dword v120, off, s[36:39], s75 sc0 sc1
s_mov_b64 exec, -1
s_add_u32 s75, s75, 4
v_smfmac_f32_16x16x64_bf16 v[72:75], v[28:31], a[136:143], v120
s_waitcnt lgkmcnt(8)
v_smfmac_f32_16x16x64_bf16 v[76:79], v[28:31], v[40:47], v120
s_waitcnt lgkmcnt(7)
ds_read_b128 v[40:43], v122 offset:9216
v_smfmac_f32_16x16x64_bf16 v[64:67], v[0:3], a[144:151], v120
ds_read_b128 v[44:47], v122 offset:13312
v_smfmac_f32_16x16x64_bf16 v[68:71], v[0:3], a[152:159], v120
s_waitcnt lgkmcnt(8)
v_smfmac_f32_16x16x64_bf16 v[64:67], v[4:7], a[168:175], v120
v_smfmac_f32_16x16x64_bf16 v[68:71], v[4:7], a[176:183], v120
v_smfmac_f32_16x16x64_bf16 v[72:75], v[0:3], a[160:167], v120
s_waitcnt lgkmcnt(6)
v_add_f32 v64, v64, v66
v_smfmac_f32_16x16x64_bf16 v[76:79], v[0:3], v[48:55], v120
ds_read_b128 v[48:51], v122 offset:10240
v_add_f32 v65, v65, v67
v_smfmac_f32_16x16x64_bf16 v[72:75], v[4:7], a[184:191], v120
s_waitcnt lgkmcnt(5)
ds_read_b128 v[52:55], v122 offset:14336
v_add_f32_e64 v68, v68, v70
v_smfmac_f32_16x16x64_bf16 v[76:79], v[4:7], v[56:63], v120
v_smfmac_f32_16x16x64_bf16 v[80:83], v[16:19], v[160:167], v120
v_add_f32 v69, v69, v71
v_cvt_pk_bf16_f32 v66, v64, v68
v_cvt_pk_bf16_f32 v70, v65, v69
v_add_f32 v72, v72, v74
v_add_f32 v73, v73, v75
v_add_f32 v76, v76, v78
v_add_f32_e64 v77, v77, v79
v_cvt_pk_bf16_f32 v67, v72, v76
v_cvt_pk_bf16_f32 v71, v73, v77
ds_write2_b64 v124, v[66:67], v[70:71] offset0:0 offset1:36
v_smfmac_f32_16x16x64_bf16 v[84:87], v[16:19], v[168:175], v120
ds_read_b128 v[56:59], v122 offset:11264
v_smfmac_f32_16x16x64_bf16 v[80:83], v[20:23], v[176:183], v120
ds_read_b128 v[60:63], v122 offset:15360
v_smfmac_f32_16x16x64_bf16 v[84:87], v[20:23], v[184:191], v120
v_smfmac_f32_16x16x64_bf16 v[80:83], v[24:27], v[192:199], v120
v_smfmac_f32_16x16x64_bf16 v[84:87], v[24:27], v[200:207], v120
s_waitcnt lgkmcnt(2)
s_barrier
ds_read_b128 v[16:19], v125 offset:0
ds_read_b128 v[20:23], v125 offset:64
v_smfmac_f32_16x16x64_bf16 v[80:83], v[28:31], v[208:215], v120
ds_read_b128 v[24:27], v125 offset:128
v_smfmac_f32_16x16x64_bf16 v[84:87], v[28:31], v[216:223], v120
ds_read_b128 v[28:31], v125 offset:192
v_smfmac_f32_16x16x64_bf16 v[80:83], v[0:3], v[224:231], v120
ds_read_b128 v[8:11], v126 offset:0
v_smfmac_f32_16x16x64_bf16 v[84:87], v[0:3], v[232:239], v120
ds_read_b128 v[12:15], v126 offset:64
v_smfmac_f32_16x16x64_bf16 v[80:83], v[4:7], v[240:247], v120
ds_read_b128 v[0:3], v126 offset:128
v_smfmac_f32_16x16x64_bf16 v[84:87], v[4:7], v[248:255], v120
ds_read_b128 v[4:7], v126 offset:192
s_waitcnt lgkmcnt(6)
v_mfma_f32_16x16x32_bf16 v[68:71], v[32:35], v[16:19], 0
v_mov_b64 v[76:77], 0
v_mov_b64 v[78:79], 0
v_mfma_f32_16x16x32_bf16 v[72:75], v[36:39], v[16:19], 0
v_add_f32 v80, v80, v82
v_add_f32 v81, v81, v83
v_mfma_f32_16x16x32_bf16 v[68:71], v[40:43], v[20:23], v[68:71]
v_add_f32 v84, v84, v86
v_add_f32 v85, v85, v87
v_mfma_f32_16x16x32_bf16 v[72:75], v[44:47], v[20:23], v[72:75]
s_waitcnt lgkmcnt(4)
v_cvt_pk_bf16_f32 v90, v80, v81
v_mfma_f32_16x16x32_bf16 v[68:71], v[48:51], v[24:27], v[68:71]
v_cvt_pk_bf16_f32 v98, v84, v85
v_cvt_pk_bf16_f32 v94, v80, v81
v_mfma_f32_16x16x32_bf16 v[72:75], v[52:55], v[24:27], v[72:75]
v_cvt_pk_bf16_f32 v102, v84, v85
v_mov_b64 v[80:81], 0
v_mfma_f32_16x16x32_bf16 v[68:71], v[56:59], v[28:31], v[68:71]
v_mov_b64 v[82:83], 0
v_mov_b64 v[84:85], 0
v_mfma_f32_16x16x32_bf16 v[72:75], v[60:63], v[28:31], v[72:75]
s_waitcnt lgkmcnt(0)
v_mov_b64 v[86:87], 0
v_mfma_f32_16x16x32_bf16 v[64:67], v[8:11], v[16:19], 0
v_cndmask_b32 v68, v68, v70, s[70:71]
v_cndmask_b32 v69, v69, v71, s[70:71]
v_mfma_f32_16x16x32_bf16 v[64:67], v[12:15], v[20:23], v[64:67]
v_cndmask_b32 v72, v72, v74, s[70:71]
v_cndmask_b32 v73, v73, v75, s[70:71]
v_mfma_f32_16x16x32_bf16 v[64:67], v[0:3], v[24:27], v[64:67]
v_mul_f32 v8, s74, v68
v_mul_f32 v9, s74, v69
v_mfma_f32_16x16x32_bf16 v[64:67], v[4:7], v[28:31], v[64:67]
v_mul_f32 v10, s74, v72
v_mul_f32 v11, s74, v73
v_exp_f32 v20, v8
v_exp_f32 v21, v9
v_exp_f32 v22, v10
v_cndmask_b32 v12, v64, v65, s[70:71]
v_mul_f32 v12, s74, v12
v_exp_f32 v23, v11
v_exp_f32_e64 v24, v12
v_cvt_pk_bf16_f32 v16, v20, v21
v_cvt_pk_bf16_f32 v24, v24, v24
v_cvt_pk_bf16_f32 v18, v22, v23
v_and_b32 v17, v24, v99
v_and_b32 v19, v24, v103
v_max3_f32 v13, |v8|, |v9|, |v10|
v_max3_f32 v13, |v11|, |v12|, v13
v_smfmac_f32_16x16x64_bf16 v[76:79], v[16:19], v[104:111], v120 abid:1
ds_read_b128 v[32:35], v123 offset:16384
ds_read_b128 v[36:39], v123 offset:17408
v_cmp_nle_f32 vcc, v13, s6
v_smfmac_f32_16x16x64_bf16 v[80:83], v[16:19], v[88:95], v120 abid:1
ds_read_b128 v[40:43], v123 offset:18432
ds_read_b128 v[44:47], v123 offset:19456
v_smfmac_f32_16x16x64_bf16 v[84:87], v[16:19], v[96:103], v120 abid:1
ds_read_b128 v[48:51], v123 offset:20480
ds_read_b128 v[52:55], v123 offset:21504
v_add_f32 v76, v76, v78
v_add_f32 v77, v77, v79
v_rcp_f32 v76, v76
v_rcp_f32 v77, v77
v_pk_add_f32 v[80:81], v[80:81], v[82:83]
v_pk_add_f32 v[84:85], v[84:85], v[86:87]
v_pk_mul_f32 v[80:81], v[80:81], v[76:77]
v_pk_mul_f32 v[84:85], v[84:85], v[76:77]
v_cvt_pk_bf16_f32 v80, v80, v84
v_cvt_pk_bf16_f32 v81, v81, v85
ds_write2_b32 v127, v80, v81 offset0:0 offset1:16
s_cbranch_vccnz L_r_fast_max0
L_r_fast_pv0:
v_mov_b64 v[0:1], 0
v_mov_b64 v[2:3], 0
v_mov_b64 v[4:5], 0
v_mov_b64 v[6:7], 0
v_mov_b64 v[8:9], 0
v_mov_b64 v[10:11], 0
v_mov_b64 v[12:13], 0
v_mov_b64 v[14:15], 0
v_mov_b64 v[16:17], 0
v_mov_b64 v[18:19], 0
v_mov_b64 v[20:21], 0
v_mov_b64 v[22:23], 0
v_mov_b64 v[24:25], 0
v_mov_b64_e64 v[26:27], 0
s_waitcnt lgkmcnt(0)
s_barrier
ds_read_b128 v[64:67], v121 offset:30208
ds_read_b128 v[68:71], v121 offset:31232
ds_read_b128 v[56:59], v123 offset:22528
ds_read_b128 v[60:63], v123 offset:23552
v_mov_b64 v[28:29], 0
v_mov_b64 v[30:31], 0
s_waitcnt lgkmcnt(3)
v_smfmac_f32_16x16x64_bf16 v[0:3], v[64:67], v[32:39], v120
ds_read_b128 v[32:35], v123 offset:24576
v_smfmac_f32_16x16x64_bf16 v[4:7], v[64:67], v[40:47], v120
s_waitcnt lgkmcnt(3)
ds_read_b128 v[36:39], v123 offset:25600
v_smfmac_f32_16x16x64_bf16 v[0:3], v[68:71], v[48:55], v120
s_waitcnt lgkmcnt(2)
ds_read_b128 v[40:43], v123 offset:26624
v_smfmac_f32_16x16x64_bf16 v[4:7], v[68:71], v[56:63], v120
ds_read_b128 v[44:47], v123 offset:27648
v_smfmac_f32_16x16x64_bf16 v[8:11], v[64:67], a[192:199], v120
ds_read_b128 v[48:51], v123 offset:28672
v_add_f32 v0, v0, v2
v_smfmac_f32_16x16x64_bf16 v[12:15], v[64:67], a[200:207], v120
ds_read_b128 v[52:55], v123 offset:29696
v_add_f32 v1, v1, v3
v_add_f32 v4, v4, v6
v_smfmac_f32_16x16x64_bf16 v[8:11], v[68:71], a[208:215], v120
ds_read_b128 v[56:59], v123 offset:30720
v_add_f32 v5, v5, v7
v_cvt_pk_bf16_f32 v80, v0, v4
v_smfmac_f32_16x16x64_bf16 v[12:15], v[68:71], a[216:223], v120
ds_read_b128 v[60:63], v123 offset:31744
v_cvt_pk_bf16_f32 v82, v1, v5
v_or_b32 v80, 1, v80
v_smfmac_f32_16x16x64_bf16 v[16:19], v[64:67], a[224:231], v120
v_add_f32 v8, v8, v10
v_add_f32 v9, v9, v11
v_smfmac_f32_16x16x64_bf16 v[20:23], v[64:67], a[232:239], v120
v_add_f32 v12, v12, v14
v_add_f32 v13, v13, v15
v_smfmac_f32_16x16x64_bf16 v[16:19], v[68:71], a[240:247], v120
v_cvt_pk_bf16_f32 v81, v8, v12
v_cvt_pk_bf16_f32 v83, v9, v13
v_smfmac_f32_16x16x64_bf16 v[20:23], v[68:71], a[248:255], v120
s_waitcnt lgkmcnt(6)
buffer_store_dwordx4 v[80:83], v91, s[36:39], s66 offen
v_smfmac_f32_16x16x64_bf16 v[24:27], v[64:67], v[32:39], v120
s_waitcnt lgkmcnt(4)
v_add_f32 v16, v16, v18
v_smfmac_f32_16x16x64_bf16 v[28:31], v[64:67], v[40:47], v120
s_waitcnt lgkmcnt(2)
v_add_f32 v17, v17, v19
v_add_f32 v20, v20, v22
v_smfmac_f32_16x16x64_bf16 v[24:27], v[68:71], v[48:55], v120
s_waitcnt lgkmcnt(0)
v_add_f32 v21, v21, v23
v_cvt_pk_bf16_f32 v84, v16, v20
v_smfmac_f32_16x16x64_bf16 v[28:31], v[68:71], v[56:63], v120
ds_read_b128 v[4:7], v122 offset:29184
v_cvt_pk_bf16_f32 v86, v17, v21
v_or_b32 v84, 1, v84
s_add_u32 s61, s61, 1
s_nop 1
v_pk_add_f32 v[24:25], v[24:25], v[26:27]
v_pk_add_f32 v[28:29], v[28:29], v[30:31]
v_cvt_pk_bf16_f32 v85, v24, v28
v_cvt_pk_bf16_f32 v87, v25, v29
buffer_store_dwordx4 v[84:87], v91, s[36:39], s67 offen
s_waitcnt vmcnt(0)
buffer_load_dwordx4 v[16:19], v107, s[36:39], s64 offen sc1
buffer_load_dwordx4 v[20:23], v107, s[36:39], s64 offen offset:1024 sc1
ds_read_b128 v[32:35], v123 offset:0
ds_read_b128 v[36:39], v123 offset:1024
ds_read_b128 v[40:43], v123 offset:2048
ds_read_b128 v[44:47], v123 offset:3072
ds_read_b128 v[48:51], v123 offset:4096
ds_read_b128 v[52:55], v123 offset:5120
ds_read_b128 v[56:59], v123 offset:6144
ds_read_b128 v[60:63], v123 offset:7168
v_mov_b64 v[64:65], 0
v_mov_b64 v[66:67], 0
v_mov_b64_e64 v[68:69], 0
v_mov_b64 v[70:71], 0
v_mov_b64 v[72:73], 0
v_mov_b64 v[74:75], 0
v_mov_b64 v[76:77], 0
v_mov_b64_e64 v[78:79], 0
v_mov_b64 v[80:81], 0
v_mov_b64 v[82:83], 0
v_mov_b64 v[84:85], 0
v_mov_b64 v[86:87], 0
s_waitcnt lgkmcnt(8)
buffer_load_dwordx4 v[24:27], v107, s[36:39], s64 offen sc1
buffer_load_dwordx4 v[28:31], v107, s[36:39], s64 offen offset:1024 sc1
L_h1_13:
s_waitcnt vmcnt(3)
v_mfma_f32_16x16x32_bf16 v[0:3], v[4:7], v[16:19], 0
s_waitcnt vmcnt(2)
v_mfma_f32_16x16x32_bf16 v[0:3], v[4:7], v[20:23], v[0:3]
v_bitop3_b32 v8, v16, v20, 1 bitop3:0x80
v_cmp_ne_u32 vcc, 1, v8
s_cbranch_vccnz L_h1_13_r
L_h1_13_ok:
v_mov_b64 v[88:89], v[112:113]
v_mov_b64 v[92:93], v[114:115]
v_mov_b64 v[96:97], v[116:117]
v_mov_b64 v[100:101], v[118:119]
s_nop 0
v_add_f32_dpp v0, v0, v0 row_ror:4 row_mask:0xf bank_mask:0xf
v_add_f32_dpp v1, v1, v1 row_ror:4 row_mask:0xf bank_mask:0xf
s_nop 0
v_add_f32_dpp v0, v0, v0 row_ror:8 row_mask:0xf bank_mask:0xf
v_add_f32_dpp v1, v1, v1 row_ror:8 row_mask:0xf bank_mask:0xf
s_mov_b64 exec, s[72:73]
v_cvt_pk_bf16_f32 v0, v0, v1
v_or_b32 v0, 1, v0
buffer_store_dword v0, v95, s[36:39], s65 offen
s_mov_b64 exec, -1
ds_read_b64 v[112:113], v111
v_mov_b32 v114, v90
v_mov_b32 v115, v98
s_waitcnt lgkmcnt(0)
s_waitcnt vmcnt(0)
buffer_load_dwordx4 v[0:3], v107, s[36:39], s65 offen sc1
buffer_load_dwordx4 v[4:7], v107, s[36:39], s65 offen offset:1024 sc1
v_xor_b32 v20, 2048, v107
v_xor_b32 v28, 4096, v107
v_xor_b32 v12, 6144, v107
s_cmp_eq_u64 s[68:69], -1
s_cbranch_scc0 L_rf_2002_w
L_rf_2002_ok:
s_branch L_r_fast_H1
.p2align 6
L_r_fast_H1:
s_waitcnt vmcnt(1)
ds_write_b128 v107, v[0:3]
v_smfmac_f32_16x16x64_bf16 v[64:67], v[0:3], a[0:7], v120
s_waitcnt vmcnt(0)
ds_write_b128 v107, v[4:7] offset:1024
v_bitop3_b32 v14, v0, v1, v2 bitop3:0x80
v_bitop3_b32 v15, v3, v4, v5 bitop3:0x80
v_smfmac_f32_16x16x64_bf16 v[68:71], v[0:3], a[8:15], v120
v_bitop3_b32 v14, v14, v6, v7 bitop3:0x80
v_bitop3_b32 v14, v14, v15, 1 bitop3:0x80
v_cmp_ne_u32 vcc, 1, v14
s_cbranch_vccnz L_r_fast_HR1
L_r_fast_A1:
v_smfmac_f32_16x16x64_bf16 v[72:75], v[0:3], a[16:23], v120
v_smfmac_f32_16x16x64_bf16 v[76:79], v[0:3], v[32:39], v120
v_smfmac_f32_16x16x64_bf16 v[64:67], v[4:7], a[24:31], v120
s_waitcnt lgkmcnt(0)
s_barrier
ds_read_b128 v[16:19], v20 offset:0
ds_read_b128 v[20:23], v20 offset:1024
v_smfmac_f32_16x16x64_bf16 v[68:71], v[4:7], a[32:39], v120
ds_read_b128 v[24:27], v28 offset:0
v_smfmac_f32_16x16x64_bf16 v[72:75], v[4:7], a[40:47], v120
ds_read_b128 v[28:31], v28 offset:1024
v_smfmac_f32_16x16x64_bf16 v[76:79], v[4:7], v[40:47], v120
v_smfmac_f32_16x16x64_bf16 v[80:83], v[0:3], v[128:135], v120
ds_read_b128 v[32:35], v123 offset:8192
s_add_u32 s54, s61, 1
v_smfmac_f32_16x16x64_bf16 v[84:87], v[0:3], v[136:143], v120
ds_read_b128 v[36:39], v123 offset:9216
s_add_u32 s52, s62, 8192
v_smfmac_f32_16x16x64_bf16 v[80:83], v[4:7], v[144:151], v120
ds_read_b128 v[40:43], v123 offset:10240
s_mov_b32 m0, s76
v_smfmac_f32_16x16x64_bf16 v[84:87], v[4:7], v[152:159], v120
ds_read_b128 v[44:47], v123 offset:11264
s_waitcnt lgkmcnt(7)
v_smfmac_f32_16x16x64_bf16 v[64:67], v[16:19], a[48:55], v120
ds_read_b128 v[0:3], v12 offset:0
v_smfmac_f32_16x16x64_bf16 v[68:71], v[16:19], a[56:63], v120
ds_read_b128 v[4:7], v12 offset:1024
s_cmp_eq_u64 s[68:69], -1
s_cbranch_scc0 L_kv_2003_w
L_kv_2003_ok:
v_smfmac_f32_16x16x64_bf16 v[72:75], v[16:19], a[64:71], v120
buffer_store_dwordx4 v[112:115], v122, s[36:39], s63 offen sc0 sc1
s_add_u32 s63, s63, 131072
v_smfmac_f32_16x16x64_bf16 v[76:79], v[16:19], v[48:55], v120
s_waitcnt lgkmcnt(8)
ds_read_b128 v[48:51], v123 offset:12288
v_smfmac_f32_16x16x64_bf16 v[64:67], v[20:23], a[72:79], v120
ds_read_b128 v[52:55], v123 offset:13312
v_smfmac_f32_16x16x64_bf16 v[68:71], v[20:23], a[80:87], v120
buffer_load_dwordx4 v107, s[36:39], s62 offen sc1 lds
v_smfmac_f32_16x16x64_bf16 v[72:75], v[20:23], a[88:95], v120
buffer_load_dwordx4 v107, s[36:39], s62 offen offset:1024 sc1 lds
v_smfmac_f32_16x16x64_bf16 v[76:79], v[20:23], v[56:63], v120
s_waitcnt lgkmcnt(9)
ds_read_b128 v[56:59], v123 offset:14336
v_smfmac_f32_16x16x64_bf16 v[64:67], v[24:27], a[96:103], v120
ds_read_b128 v[60:63], v123 offset:15360
v_smfmac_f32_16x16x64_bf16 v[68:71], v[24:27], a[104:111], v120
buffer_load_dwordx4 v[112:115], v107, s[36:39], s52 offen sc1
v_smfmac_f32_16x16x64_bf16 v[72:75], v[24:27], a[112:119], v120
s_waitcnt lgkmcnt(8)
buffer_load_dwordx4 v[116:119], v107, s[36:39], s52 offen offset:1024 sc1
s_add_u32 s62, s62, 524288
v_smfmac_f32_16x16x64_bf16 v[76:79], v[24:27], v[32:39], v120
ds_read_b128 v[32:35], v122 offset:16384
v_smfmac_f32_16x16x64_bf16 v[64:67], v[28:31], a[120:127], v120
ds_read_b128 v[36:39], v122 offset:20480
v_smfmac_f32_16x16x64_bf16 v[68:71], v[28:31], a[128:135], v120
s_mov_b64 exec, s[0:1]
buffer_store_dword v120, off, s[36:39], s75 sc0 sc1
s_mov_b64 exec, -1
s_add_u32 s75, s75, 4
v_smfmac_f32_16x16x64_bf16 v[72:75], v[28:31], a[136:143], v120
s_waitcnt lgkmcnt(8)
v_smfmac_f32_16x16x64_bf16 v[76:79], v[28:31], v[40:47], v120
s_waitcnt lgkmcnt(7)
ds_read_b128 v[40:43], v122 offset:17408
v_smfmac_f32_16x16x64_bf16 v[64:67], v[0:3], a[144:151], v120
ds_read_b128 v[44:47], v122 offset:21504
v_smfmac_f32_16x16x64_bf16 v[68:71], v[0:3], a[152:159], v120
s_waitcnt lgkmcnt(8)
v_smfmac_f32_16x16x64_bf16 v[64:67], v[4:7], a[168:175], v120
v_smfmac_f32_16x16x64_bf16 v[68:71], v[4:7], a[176:183], v120
v_smfmac_f32_16x16x64_bf16 v[72:75], v[0:3], a[160:167], v120
s_waitcnt lgkmcnt(6)
v_add_f32 v64, v64, v66
v_smfmac_f32_16x16x64_bf16 v[76:79], v[0:3], v[48:55], v120
ds_read_b128 v[48:51], v122 offset:18432
v_add_f32 v65, v65, v67
v_smfmac_f32_16x16x64_bf16 v[72:75], v[4:7], a[184:191], v120
s_waitcnt lgkmcnt(5)
ds_read_b128 v[52:55], v122 offset:22528
v_add_f32 v68, v68, v70
v_smfmac_f32_16x16x64_bf16 v[76:79], v[4:7], v[56:63], v120
v_smfmac_f32_16x16x64_bf16 v[80:83], v[16:19], v[160:167], v120
v_add_f32 v69, v69, v71
v_cvt_pk_bf16_f32 v66, v64, v68
v_cvt_pk_bf16_f32 v70, v65, v69
v_add_f32_e64 v72, v72, v74
v_add_f32 v73, v73, v75
v_add_f32 v76, v76, v78
v_add_f32 v77, v77, v79
v_cvt_pk_bf16_f32 v67, v72, v76
v_cvt_pk_bf16_f32 v71, v73, v77
ds_write2_b64 v124, v[66:67], v[70:71] offset0:0 offset1:36
v_smfmac_f32_16x16x64_bf16 v[84:87], v[16:19], v[168:175], v120
ds_read_b128 v[56:59], v122 offset:19456
v_smfmac_f32_16x16x64_bf16 v[80:83], v[20:23], v[176:183], v120
ds_read_b128 v[60:63], v122 offset:23552
v_smfmac_f32_16x16x64_bf16 v[84:87], v[20:23], v[184:191], v120
v_smfmac_f32_16x16x64_bf16 v[80:83], v[24:27], v[192:199], v120
v_smfmac_f32_16x16x64_bf16 v[84:87], v[24:27], v[200:207], v120
s_waitcnt lgkmcnt(2)
s_barrier
ds_read_b128 v[16:19], v125 offset:0
ds_read_b128 v[20:23], v125 offset:64
v_smfmac_f32_16x16x64_bf16 v[80:83], v[28:31], v[208:215], v120
ds_read_b128 v[24:27], v125 offset:128
v_smfmac_f32_16x16x64_bf16 v[84:87], v[28:31], v[216:223], v120
ds_read_b128 v[28:31], v125 offset:192
v_smfmac_f32_16x16x64_bf16 v[80:83], v[0:3], v[224:231], v120
ds_read_b128 v[8:11], v126 offset:0
v_smfmac_f32_16x16x64_bf16 v[84:87], v[0:3], v[232:239], v120
ds_read_b128 v[12:15], v126 offset:64
v_smfmac_f32_16x16x64_bf16 v[80:83], v[4:7], v[240:247], v120
ds_read_b128 v[0:3], v126 offset:128
v_smfmac_f32_16x16x64_bf16 v[84:87], v[4:7], v[248:255], v120
ds_read_b128 v[4:7], v126 offset:192
s_waitcnt lgkmcnt(6)
v_mfma_f32_16x16x32_bf16 v[68:71], v[32:35], v[16:19], 0
v_mov_b64 v[76:77], 0
v_mov_b64 v[78:79], 0
v_mfma_f32_16x16x32_bf16 v[72:75], v[36:39], v[16:19], 0
v_add_f32 v80, v80, v82
v_add_f32 v81, v81, v83
v_mfma_f32_16x16x32_bf16 v[68:71], v[40:43], v[20:23], v[68:71]
v_add_f32 v84, v84, v86
v_add_f32 v85, v85, v87
v_mfma_f32_16x16x32_bf16 v[72:75], v[44:47], v[20:23], v[72:75]
s_waitcnt lgkmcnt(4)
v_cvt_pk_bf16_f32 v90, v80, v81
v_mfma_f32_16x16x32_bf16 v[68:71], v[48:51], v[24:27], v[68:71]
v_cvt_pk_bf16_f32 v98, v84, v85
v_cvt_pk_bf16_f32 v94, v80, v81
v_mfma_f32_16x16x32_bf16 v[72:75], v[52:55], v[24:27], v[72:75]
v_cvt_pk_bf16_f32 v102, v84, v85
v_mov_b64 v[80:81], 0
v_mfma_f32_16x16x32_bf16 v[68:71], v[56:59], v[28:31], v[68:71]
v_mov_b64 v[82:83], 0
v_mov_b64 v[84:85], 0
v_mfma_f32_16x16x32_bf16 v[72:75], v[60:63], v[28:31], v[72:75]
s_waitcnt lgkmcnt(0)
v_mov_b64 v[86:87], 0
v_mfma_f32_16x16x32_bf16 v[64:67], v[8:11], v[16:19], 0
v_cndmask_b32 v68, v68, v70, s[70:71]
v_cndmask_b32 v69, v69, v71, s[70:71]
v_mfma_f32_16x16x32_bf16 v[64:67], v[12:15], v[20:23], v[64:67]
v_cndmask_b32 v72, v72, v74, s[70:71]
v_cndmask_b32 v73, v73, v75, s[70:71]
v_mfma_f32_16x16x32_bf16 v[64:67], v[0:3], v[24:27], v[64:67]
v_mul_f32 v8, s74, v68
v_mul_f32 v9, s74, v69
v_mfma_f32_16x16x32_bf16 v[64:67], v[4:7], v[28:31], v[64:67]
v_mul_f32 v10, s74, v72
v_mul_f32 v11, s74, v73
v_exp_f32 v20, v8
v_exp_f32 v21, v9
v_exp_f32 v22, v10
v_cndmask_b32 v12, v64, v65, s[70:71]
v_mul_f32 v12, s74, v12
v_exp_f32 v23, v11
v_exp_f32 v24, v12
v_cvt_pk_bf16_f32 v16, v20, v21
v_cvt_pk_bf16_f32 v24, v24, v24
v_cvt_pk_bf16_f32 v18, v22, v23
v_and_b32 v17, v24, v99
v_and_b32 v19, v24, v103
v_max3_f32 v13, |v8|, |v9|, |v10|
v_max3_f32 v13, |v11|, |v12|, v13
v_smfmac_f32_16x16x64_bf16 v[76:79], v[16:19], v[104:111], v120 abid:1
ds_read_b128 v[32:35], v123 offset:16384
ds_read_b128 v[36:39], v123 offset:17408
v_cmp_nle_f32 vcc, v13, s6
v_smfmac_f32_16x16x64_bf16 v[80:83], v[16:19], v[88:95], v120 abid:1
ds_read_b128 v[40:43], v123 offset:18432
ds_read_b128 v[44:47], v123 offset:19456
v_smfmac_f32_16x16x64_bf16 v[84:87], v[16:19], v[96:103], v120 abid:1
ds_read_b128 v[48:51], v123 offset:20480
ds_read_b128 v[52:55], v123 offset:21504
s_cmp_eq_u32 s61, 63
v_add_f32 v76, v76, v78
v_add_f32 v77, v77, v79
v_rcp_f32 v76, v76
v_rcp_f32 v77, v77
v_pk_add_f32 v[80:81], v[80:81], v[82:83]
v_pk_add_f32 v[84:85], v[84:85], v[86:87]
v_pk_mul_f32 v[80:81], v[80:81], v[76:77]
v_pk_mul_f32 v[84:85], v[84:85], v[76:77]
v_cvt_pk_bf16_f32 v80, v80, v84
v_cvt_pk_bf16_f32 v81, v81, v85
ds_write2_b32 v127, v80, v81 offset0:0 offset1:16
s_cbranch_scc1 L_r_done
s_cbranch_vccnz L_r_fast_max1
L_r_fast_pv1:
v_mov_b64 v[0:1], 0
v_mov_b64 v[2:3], 0
v_mov_b64 v[4:5], 0
v_mov_b64 v[6:7], 0
v_mov_b64 v[8:9], 0
v_mov_b64 v[10:11], 0
v_mov_b64 v[12:13], 0
v_mov_b64 v[14:15], 0
v_mov_b64 v[16:17], 0
v_mov_b64 v[18:19], 0
v_mov_b64 v[20:21], 0
v_mov_b64 v[22:23], 0
v_mov_b64 v[24:25], 0
v_mov_b64 v[26:27], 0
s_waitcnt lgkmcnt(0)
s_barrier
ds_read_b128 v[64:67], v121 offset:30208
ds_read_b128 v[68:71], v121 offset:31232
ds_read_b128 v[56:59], v123 offset:22528
ds_read_b128 v[60:63], v123 offset:23552
v_mov_b64 v[28:29], 0
v_mov_b64 v[30:31], 0
s_waitcnt lgkmcnt(3)
v_smfmac_f32_16x16x64_bf16 v[0:3], v[64:67], v[32:39], v120
ds_read_b128 v[32:35], v123 offset:24576
v_smfmac_f32_16x16x64_bf16 v[4:7], v[64:67], v[40:47], v120
s_waitcnt lgkmcnt(3)
ds_read_b128 v[36:39], v123 offset:25600
v_smfmac_f32_16x16x64_bf16 v[0:3], v[68:71], v[48:55], v120
s_waitcnt lgkmcnt(2)
ds_read_b128 v[40:43], v123 offset:26624
v_smfmac_f32_16x16x64_bf16 v[4:7], v[68:71], v[56:63], v120
ds_read_b128 v[44:47], v123 offset:27648
v_smfmac_f32_16x16x64_bf16 v[8:11], v[64:67], a[192:199], v120
ds_read_b128 v[48:51], v123 offset:28672
v_add_f32 v0, v0, v2
v_smfmac_f32_16x16x64_bf16 v[12:15], v[64:67], a[200:207], v120
ds_read_b128 v[52:55], v123 offset:29696
v_add_f32 v1, v1, v3
v_add_f32 v4, v4, v6
v_smfmac_f32_16x16x64_bf16 v[8:11], v[68:71], a[208:215], v120
ds_read_b128 v[56:59], v123 offset:30720
v_add_f32 v5, v5, v7
v_cvt_pk_bf16_f32 v80, v0, v4
v_smfmac_f32_16x16x64_bf16 v[12:15], v[68:71], a[216:223], v120
ds_read_b128 v[60:63], v123 offset:31744
v_cvt_pk_bf16_f32 v82, v1, v5
v_and_b32 v80, -2, v80
v_smfmac_f32_16x16x64_bf16 v[16:19], v[64:67], a[224:231], v120
v_add_f32 v8, v8, v10
v_add_f32 v9, v9, v11
v_smfmac_f32_16x16x64_bf16 v[20:23], v[64:67], a[232:239], v120
v_add_f32 v12, v12, v14
v_add_f32 v13, v13, v15
v_smfmac_f32_16x16x64_bf16 v[16:19], v[68:71], a[240:247], v120
v_cvt_pk_bf16_f32 v81, v8, v12
v_cvt_pk_bf16_f32 v83, v9, v13
v_smfmac_f32_16x16x64_bf16 v[20:23], v[68:71], a[248:255], v120
s_waitcnt lgkmcnt(6)
buffer_store_dwordx4 v[80:83], v91, s[36:39], s66 offen
v_smfmac_f32_16x16x64_bf16 v[24:27], v[64:67], v[32:39], v120
s_waitcnt lgkmcnt(4)
v_add_f32 v16, v16, v18
v_smfmac_f32_16x16x64_bf16 v[28:31], v[64:67], v[40:47], v120
s_waitcnt lgkmcnt(2)
v_add_f32 v17, v17, v19
v_add_f32 v20, v20, v22
v_smfmac_f32_16x16x64_bf16 v[24:27], v[68:71], v[48:55], v120
s_waitcnt lgkmcnt(0)
v_add_f32 v21, v21, v23
v_cvt_pk_bf16_f32 v84, v16, v20
v_smfmac_f32_16x16x64_bf16 v[28:31], v[68:71], v[56:63], v120
ds_read_b128 v[4:7], v122 offset:29184
v_cvt_pk_bf16_f32 v86, v17, v21
v_and_b32_e64 v84, -2, v84
s_add_u32 s61, s61, 1
s_nop 1
v_pk_add_f32 v[24:25], v[24:25], v[26:27]
v_pk_add_f32 v[28:29], v[28:29], v[30:31]
v_cvt_pk_bf16_f32 v85, v24, v28
v_cvt_pk_bf16_f32 v87, v25, v29
buffer_store_dwordx4 v[84:87], v91, s[36:39], s67 offen
s_waitcnt vmcnt(0)
buffer_load_dwordx4 v[16:19], v107, s[36:39], s64 offen sc1
buffer_load_dwordx4 v[20:23], v107, s[36:39], s64 offen offset:1024 sc1
ds_read_b128 v[32:35], v123 offset:0
ds_read_b128 v[36:39], v123 offset:1024
ds_read_b128 v[40:43], v123 offset:2048
ds_read_b128 v[44:47], v123 offset:3072
ds_read_b128 v[48:51], v123 offset:4096
ds_read_b128 v[52:55], v123 offset:5120
ds_read_b128 v[56:59], v123 offset:6144
ds_read_b128 v[60:63], v123 offset:7168
v_mov_b64 v[64:65], 0
v_mov_b64 v[66:67], 0
v_mov_b64 v[68:69], 0
v_mov_b64 v[70:71], 0
v_mov_b64 v[72:73], 0
v_mov_b64 v[74:75], 0
v_mov_b64 v[76:77], 0
v_mov_b64 v[78:79], 0
v_mov_b64 v[80:81], 0
v_mov_b64 v[82:83], 0
v_mov_b64 v[84:85], 0
v_mov_b64 v[86:87], 0
s_cmp_eq_u32 s3, 3
s_cselect_b32 s0, 1, 0
s_waitcnt lgkmcnt(8)
buffer_load_dwordx4 v[24:27], v107, s[36:39], s64 offen sc1
buffer_load_dwordx4 v[28:31], v107, s[36:39], s64 offen offset:1024 sc1
L_h1_14:
s_waitcnt vmcnt(3)
v_mfma_f32_16x16x32_bf16 v[0:3], v[4:7], v[16:19], 0
s_waitcnt vmcnt(2)
v_mfma_f32_16x16x32_bf16 v[0:3], v[4:7], v[20:23], v[0:3]
v_bitop3_b32 v8, v16, v20, 1 bitop3:0xa8
v_cmp_ne_u32 vcc, 0, v8
s_cbranch_vccnz L_h1_14_r
L_h1_14_ok:
v_mov_b64 v[88:89], v[112:113]
v_mov_b64 v[92:93], v[114:115]
v_mov_b64 v[96:97], v[116:117]
v_mov_b64 v[100:101], v[118:119]
s_nop 0
v_add_f32_dpp v0, v0, v0 row_ror:4 row_mask:0xf bank_mask:0xf
v_add_f32_dpp v1, v1, v1 row_ror:4 row_mask:0xf bank_mask:0xf
s_nop 0
v_add_f32_dpp v0, v0, v0 row_ror:8 row_mask:0xf bank_mask:0xf
v_add_f32_dpp v1, v1, v1 row_ror:8 row_mask:0xf bank_mask:0xf
s_mov_b64 exec, s[72:73]
v_cvt_pk_bf16_f32 v0, v0, v1
v_and_b32 v0, -2, v0
buffer_store_dword v0, v95, s[36:39], s65 offen
s_mov_b64 exec, -1
ds_read_b64 v[112:113], v111
v_mov_b32 v114, v90
v_mov_b32 v115, v98
s_waitcnt lgkmcnt(0)
s_waitcnt vmcnt(0)
buffer_load_dwordx4 v[0:3], v107, s[36:39], s65 offen sc1
buffer_load_dwordx4 v[4:7], v107, s[36:39], s65 offen offset:1024 sc1
v_xor_b32 v20, 2048, v107
v_xor_b32 v28, 4096, v107
v_xor_b32 v12, 6144, v107
s_cmp_eq_u64 s[68:69], -1
s_cbranch_scc0 L_rf_2004_w
L_rf_2004_ok:
s_branch L_r_fast_H0
L_r_fast_HR0:
s_mov_b64 exec, vcc
buffer_load_dwordx4 v[0:3], v107, s[36:39], s65 offen sc1
buffer_load_dwordx4 v[4:7], v107, s[36:39], s65 offen offset:1024 sc1
s_mov_b64 exec, -1
s_waitcnt lgkmcnt(0)
s_nop 3
v_mov_b64 v[64:65], 0
v_mov_b64 v[66:67], 0
v_mov_b64 v[68:69], 0
v_mov_b64 v[70:71], 0
s_sub_u32 s56, s56, 1
s_cbranch_scc1 L_r_quit
s_branch L_r_fast_H0
L_r_fast_first:
v_smfmac_f32_16x16x64_bf16 v[64:67], v[0:3], a[0:7], v120
v_smfmac_f32_16x16x64_bf16 v[68:71], v[0:3], a[8:15], v120
s_branch L_r_fast_A0
L_kv_2001_w:
s_lshl_b32 s53, s60, 8
v_lshrrev_b32 v14, 2, v122
s_mov_b32 m0, 32256
s_bitcmp1_b64 s[68:69], s54
buffer_load_dword v14, s[36:39], s53 offen sc1 lds
s_mov_b32 m0, s77
s_cbranch_scc1 L_kv_2001_ok
L_kv_2001:
buffer_load_dword v15, v14, s[36:39], s53 offen sc1
s_waitcnt vmcnt(0)
v_cmp_ne_u32 s[68:69], 0, v15
s_nop 4
s_bitcmp1_b64 s[68:69], s54
s_cbranch_scc1 L_kv_2001_ok
s_sub_u32 s56, s56, 1
s_cbranch_scc0 L_kv_2001
s_endpgm
L_h1_13_r:
s_waitcnt vmcnt(1)
v_mfma_f32_16x16x32_bf16 v[0:3], v[4:7], v[24:27], 0
s_waitcnt vmcnt(0)
v_mfma_f32_16x16x32_bf16 v[0:3], v[4:7], v[28:31], v[0:3]
v_bitop3_b32 v8, v24, v28, 1 bitop3:0x80
v_cmp_ne_u32 vcc, 1, v8
s_cbranch_vccz L_h1_13_ok
s_mov_b64 exec, vcc
buffer_load_dwordx4 v[24:27], v107, s[36:39], s64 offen sc1
buffer_load_dwordx4 v[28:31], v107, s[36:39], s64 offen offset:1024 sc1
s_mov_b64 exec, -1
s_sub_u32 s56, s56, 1
s_cbranch_scc0 L_h1_13_r
s_endpgm
L_rf_2002_w:
v_lshrrev_b32 v14, 2, v122
ds_read_b32 v14, v14 offset:32256
s_waitcnt lgkmcnt(0)
v_cmp_ne_u32 vcc, 0, v14
s_nop 4
s_or_b64 s[68:69], s[68:69], vcc
s_branch L_rf_2002_ok
L_r_fast_max0:
v_max3_f32 v13, v8, v9, v10
v_max3_f32 v13, v13, v11, v12
s_nop 1
v_max_f32_dpp v14, v13, v13 quad_perm:[2,3,0,1] row_mask:0xf bank_mask:0xf
v_max_f32_dpp v13, v13, v13 quad_perm:[2,3,0,1] row_mask:0xf bank_mask:0xf
s_nop 1
v_permlane16_swap_b32 v13, v14
v_max_f32 v15, v13, v14
v_max_f32 v13, v13, v14
s_nop 1
v_permlane32_swap_b32 v13, v15
v_max_f32 v13, v13, v15
v_sub_f32 v8, v8, v13
v_sub_f32 v9, v9, v13
v_sub_f32 v10, v10, v13
v_sub_f32 v11, v11, v13
v_sub_f32 v12, v12, v13
v_exp_f32 v12, v12
v_exp_f32 v8, v8
v_exp_f32 v9, v9
v_exp_f32 v10, v10
v_exp_f32 v11, v11
v_cvt_pk_bf16_f32 v12, v12, v12
v_cvt_pk_bf16_f32 v16, v8, v9
v_cvt_pk_bf16_f32 v18, v10, v11
v_and_b32 v17, v12, v99
v_and_b32 v19, v12, v103
s_waitcnt lgkmcnt(0)
v_mov_b64 v[76:77], 0
v_mov_b64 v[78:79], 0
v_mov_b64 v[80:81], 0
v_mov_b64 v[82:83], 0
v_mov_b64 v[84:85], 0
v_mov_b64 v[86:87], 0
s_nop 1
v_smfmac_f32_16x16x64_bf16 v[76:79], v[16:19], v[104:111], v120 abid:1
v_smfmac_f32_16x16x64_bf16 v[80:83], v[16:19], v[88:95], v120 abid:1
v_smfmac_f32_16x16x64_bf16 v[84:87], v[16:19], v[96:103], v120 abid:1
s_nop 7
s_nop 3
v_add_f32 v76, v76, v78
v_add_f32 v77, v77, v79
v_rcp_f32 v76, v76
v_rcp_f32 v77, v77
v_pk_add_f32 v[80:81], v[80:81], v[82:83]
v_pk_add_f32 v[84:85], v[84:85], v[86:87]
v_pk_mul_f32 v[80:81], v[80:81], v[76:77]
v_pk_mul_f32 v[84:85], v[84:85], v[76:77]
v_cvt_pk_bf16_f32 v80, v80, v84
v_cvt_pk_bf16_f32 v81, v81, v85
ds_write2_b32 v127, v80, v81 offset0:0 offset1:16
s_branch L_r_fast_pv0
L_r_fast_HR1:
s_mov_b64 exec, vcc
buffer_load_dwordx4 v[0:3], v107, s[36:39], s65 offen sc1
buffer_load_dwordx4 v[4:7], v107, s[36:39], s65 offen offset:1024 sc1
s_mov_b64 exec, -1
s_waitcnt lgkmcnt(0)
s_nop 3
v_mov_b64 v[64:65], 0
v_mov_b64 v[66:67], 0
v_mov_b64 v[68:69], 0
v_mov_b64 v[70:71], 0
s_sub_u32 s56, s56, 1
s_cbranch_scc1 L_r_quit
s_branch L_r_fast_H1
L_kv_2003_w:
s_lshl_b32 s53, s60, 8
v_lshrrev_b32 v14, 2, v122
s_mov_b32 m0, 32256
s_bitcmp1_b64 s[68:69], s54
buffer_load_dword v14, s[36:39], s53 offen sc1 lds
s_mov_b32 m0, s76
s_cbranch_scc1 L_kv_2003_ok
L_kv_2003:
buffer_load_dword v15, v14, s[36:39], s53 offen sc1
s_waitcnt vmcnt(0)
v_cmp_ne_u32 s[68:69], 0, v15
s_nop 4
s_bitcmp1_b64 s[68:69], s54
s_cbranch_scc1 L_kv_2003_ok
s_sub_u32 s56, s56, 1
s_cbranch_scc0 L_kv_2003
s_endpgm
L_h1_14_r:
s_waitcnt vmcnt(1)
v_mfma_f32_16x16x32_bf16 v[0:3], v[4:7], v[24:27], 0
s_waitcnt vmcnt(0)
v_mfma_f32_16x16x32_bf16 v[0:3], v[4:7], v[28:31], v[0:3]
v_bitop3_b32 v8, v24, v28, 1 bitop3:0xa8
v_cmp_ne_u32 vcc, 0, v8
s_cbranch_vccz L_h1_14_ok
s_mov_b64 exec, vcc
buffer_load_dwordx4 v[24:27], v107, s[36:39], s64 offen sc1
buffer_load_dwordx4 v[28:31], v107, s[36:39], s64 offen offset:1024 sc1
s_mov_b64 exec, -1
s_sub_u32 s56, s56, 1
s_cbranch_scc0 L_h1_14_r
s_endpgm
L_rf_2004_w:
v_lshrrev_b32 v14, 2, v122
ds_read_b32 v14, v14 offset:32256
s_waitcnt lgkmcnt(0)
v_cmp_ne_u32 vcc, 0, v14
s_nop 4
s_or_b64 s[68:69], s[68:69], vcc
s_branch L_rf_2004_ok
L_r_fast_max1:
v_max3_f32 v13, v8, v9, v10
v_max3_f32 v13, v13, v11, v12
s_nop 1
v_max_f32_dpp v14, v13, v13 quad_perm:[2,3,0,1] row_mask:0xf bank_mask:0xf
v_max_f32_dpp v13, v13, v13 quad_perm:[2,3,0,1] row_mask:0xf bank_mask:0xf
s_nop 1
v_permlane16_swap_b32 v13, v14
v_max_f32 v15, v13, v14
v_max_f32 v13, v13, v14
s_nop 1
v_permlane32_swap_b32 v13, v15
v_max_f32 v13, v13, v15
v_sub_f32 v8, v8, v13
v_sub_f32 v9, v9, v13
v_sub_f32 v10, v10, v13
v_sub_f32 v11, v11, v13
v_sub_f32 v12, v12, v13
v_exp_f32 v12, v12
v_exp_f32 v8, v8
v_exp_f32 v9, v9
v_exp_f32 v10, v10
v_exp_f32 v11, v11
v_cvt_pk_bf16_f32 v12, v12, v12
v_cvt_pk_bf16_f32 v16, v8, v9
v_cvt_pk_bf16_f32 v18, v10, v11
v_and_b32 v17, v12, v99
v_and_b32 v19, v12, v103
s_waitcnt lgkmcnt(0)
v_mov_b64 v[76:77], 0
v_mov_b64 v[78:79], 0
v_mov_b64 v[80:81], 0
v_mov_b64 v[82:83], 0
v_mov_b64 v[84:85], 0
v_mov_b64 v[86:87], 0
s_nop 1
v_smfmac_f32_16x16x64_bf16 v[76:79], v[16:19], v[104:111], v120 abid:1
v_smfmac_f32_16x16x64_bf16 v[80:83], v[16:19], v[88:95], v120 abid:1
v_smfmac_f32_16x16x64_bf16 v[84:87], v[16:19], v[96:103], v120 abid:1
s_nop 7
s_nop 3
v_add_f32 v76, v76, v78
v_add_f32 v77, v77, v79
v_rcp_f32 v76, v76
v_rcp_f32 v77, v77
v_pk_add_f32 v[80:81], v[80:81], v[82:83]
v_pk_add_f32 v[84:85], v[84:85], v[86:87]
v_pk_mul_f32 v[80:81], v[80:81], v[76:77]
v_pk_mul_f32 v[84:85], v[84:85], v[76:77]
v_cvt_pk_bf16_f32 v80, v80, v84
v_cvt_pk_bf16_f32 v81, v81, v85
ds_write2_b32 v127, v80, v81 offset0:0 offset1:16
s_branch L_r_fast_pv1
.p2align 6
L_r_slow_H0:
s_waitcnt vmcnt(1)
ds_write_b128 v107, v[0:3]
v_smfmac_f32_16x16x64_bf16 v[64:67], v[0:3], a[0:7], v120
s_waitcnt vmcnt(0)
ds_write_b128 v107, v[4:7] offset:1024
v_bitop3_b32 v14, v0, v1, v2 bitop3:0xfe
v_bitop3_b32 v15, v3, v4, v5 bitop3:0xfe
v_smfmac_f32_16x16x64_bf16 v[68:71], v[0:3], a[8:15], v120
v_bitop3_b32 v14, v14, v6, v7 bitop3:0xfe
v_bitop3_b32 v14, v14, v15, 1 bitop3:0xa8
v_cmp_ne_u32 vcc, 0, v14
s_cbranch_vccnz L_r_slow_HR0
L_r_slow_A0:
v_smfmac_f32_16x16x64_bf16 v[72:75], v[0:3], a[16:23], v120
v_smfmac_f32_16x16x64_bf16 v[76:79], v[0:3], v[32:39], v120
v_smfmac_f32_16x16x64_bf16 v[64:67], v[4:7], a[24:31], v120
s_waitcnt lgkmcnt(0)
s_barrier
ds_read_b128 v[16:19], v20 offset:0
ds_read_b128 v[20:23], v20 offset:1024
v_smfmac_f32_16x16x64_bf16 v[68:71], v[4:7], a[32:39], v120
ds_read_b128 v[24:27], v28 offset:0
v_smfmac_f32_16x16x64_bf16 v[72:75], v[4:7], a[40:47], v120
ds_read_b128 v[28:31], v28 offset:1024
v_smfmac_f32_16x16x64_bf16 v[76:79], v[4:7], v[40:47], v120
v_smfmac_f32_16x16x64_bf16 v[80:83], v[0:3], v[128:135], v120
ds_read_b128 v[32:35], v123 offset:8192
s_add_u32 s54, s61, 1
v_smfmac_f32_16x16x64_bf16 v[84:87], v[0:3], v[136:143], v120
ds_read_b128 v[36:39], v123 offset:9216
s_add_u32 s52, s62, 8192
v_smfmac_f32_16x16x64_bf16 v[80:83], v[4:7], v[144:151], v120
ds_read_b128 v[40:43], v123 offset:10240
s_mov_b32 m0, s77
v_smfmac_f32_16x16x64_bf16 v[84:87], v[4:7], v[152:159], v120
ds_read_b128 v[44:47], v123 offset:11264
s_waitcnt lgkmcnt(7)
v_smfmac_f32_16x16x64_bf16 v[64:67], v[16:19], a[48:55], v120
ds_read_b128 v[0:3], v12 offset:0
v_smfmac_f32_16x16x64_bf16 v[68:71], v[16:19], a[56:63], v120
ds_read_b128 v[4:7], v12 offset:1024
s_cmp_eq_u64 s[68:69], -1
s_cbranch_scc0 L_kv_1001_w
L_kv_1001_ok:
v_smfmac_f32_16x16x64_bf16 v[72:75], v[16:19], a[64:71], v120
buffer_store_dwordx4 v[112:115], v122, s[36:39], s63 offen sc0 sc1
s_add_u32 s63, s63, 131072
v_smfmac_f32_16x16x64_bf16 v[76:79], v[16:19], v[48:55], v120
s_waitcnt lgkmcnt(8)
ds_read_b128 v[48:51], v123 offset:12288
v_smfmac_f32_16x16x64_bf16 v[64:67], v[20:23], a[72:79], v120
ds_read_b128 v[52:55], v123 offset:13312
v_smfmac_f32_16x16x64_bf16 v[68:71], v[20:23], a[80:87], v120
buffer_load_dwordx4 v107, s[36:39], s62 offen sc1 lds
v_smfmac_f32_16x16x64_bf16 v[72:75], v[20:23], a[88:95], v120
buffer_load_dwordx4 v107, s[36:39], s62 offen offset:1024 sc1 lds
v_smfmac_f32_16x16x64_bf16 v[76:79], v[20:23], v[56:63], v120
s_waitcnt lgkmcnt(9)
ds_read_b128 v[56:59], v123 offset:14336
v_smfmac_f32_16x16x64_bf16 v[64:67], v[24:27], a[96:103], v120
ds_read_b128 v[60:63], v123 offset:15360
v_smfmac_f32_16x16x64_bf16 v[68:71], v[24:27], a[104:111], v120
buffer_load_dwordx4 v[112:115], v107, s[36:39], s52 offen sc1
v_smfmac_f32_16x16x64_bf16 v[72:75], v[24:27], a[112:119], v120
s_waitcnt lgkmcnt(8)
buffer_load_dwordx4 v[116:119], v107, s[36:39], s52 offen offset:1024 sc1
s_add_u32 s62, s62, 524288
v_smfmac_f32_16x16x64_bf16 v[76:79], v[24:27], v[32:39], v120
ds_read_b128 v[32:35], v122 offset:8192
v_smfmac_f32_16x16x64_bf16 v[64:67], v[28:31], a[120:127], v120
ds_read_b128 v[36:39], v122 offset:12288
v_smfmac_f32_16x16x64_bf16 v[68:71], v[28:31], a[128:135], v120
s_mov_b64 exec, s[0:1]
buffer_store_dword v120, off, s[36:39], s75 sc0 sc1
s_mov_b64 exec, -1
s_add_u32 s75, s75, 4
v_smfmac_f32_16x16x64_bf16 v[72:75], v[28:31], a[136:143], v120
s_waitcnt lgkmcnt(8)
v_smfmac_f32_16x16x64_bf16 v[76:79], v[28:31], v[40:47], v120
s_waitcnt lgkmcnt(7)
ds_read_b128 v[40:43], v122 offset:9216
v_smfmac_f32_16x16x64_bf16 v[64:67], v[0:3], a[144:151], v120
ds_read_b128 v[44:47], v122 offset:13312
v_smfmac_f32_16x16x64_bf16 v[68:71], v[0:3], a[152:159], v120
s_waitcnt lgkmcnt(8)
v_smfmac_f32_16x16x64_bf16 v[64:67], v[4:7], a[168:175], v120
v_smfmac_f32_16x16x64_bf16 v[68:71], v[4:7], a[176:183], v120
v_smfmac_f32_16x16x64_bf16 v[72:75], v[0:3], a[160:167], v120
s_waitcnt lgkmcnt(6)
v_add_f32 v64, v64, v66
v_smfmac_f32_16x16x64_bf16 v[76:79], v[0:3], v[48:55], v120
ds_read_b128 v[48:51], v122 offset:10240
v_add_f32 v65, v65, v67
v_smfmac_f32_16x16x64_bf16 v[72:75], v[4:7], a[184:191], v120
s_waitcnt lgkmcnt(5)
ds_read_b128 v[52:55], v122 offset:14336
v_add_f32_e64 v68, v68, v70
v_smfmac_f32_16x16x64_bf16 v[76:79], v[4:7], v[56:63], v120
v_smfmac_f32_16x16x64_bf16 v[80:83], v[16:19], v[160:167], v120
v_add_f32 v69, v69, v71
v_cvt_pk_bf16_f32 v66, v64, v68
v_cvt_pk_bf16_f32 v70, v65, v69
v_add_f32 v72, v72, v74
v_add_f32 v73, v73, v75
v_add_f32 v76, v76, v78
v_add_f32_e64 v77, v77, v79
v_cvt_pk_bf16_f32 v67, v72, v76
v_cvt_pk_bf16_f32 v71, v73, v77
ds_write2_b64 v124, v[66:67], v[70:71] offset0:0 offset1:36
v_smfmac_f32_16x16x64_bf16 v[84:87], v[16:19], v[168:175], v120
ds_read_b128 v[56:59], v122 offset:11264
v_smfmac_f32_16x16x64_bf16 v[80:83], v[20:23], v[176:183], v120
ds_read_b128 v[60:63], v122 offset:15360
v_smfmac_f32_16x16x64_bf16 v[84:87], v[20:23], v[184:191], v120
v_smfmac_f32_16x16x64_bf16 v[80:83], v[24:27], v[192:199], v120
v_smfmac_f32_16x16x64_bf16 v[84:87], v[24:27], v[200:207], v120
s_waitcnt lgkmcnt(2)
s_barrier
ds_read_b128 v[16:19], v125 offset:0
ds_read_b128 v[20:23], v125 offset:64
v_smfmac_f32_16x16x64_bf16 v[80:83], v[28:31], v[208:215], v120
ds_read_b128 v[24:27], v125 offset:128
v_smfmac_f32_16x16x64_bf16 v[84:87], v[28:31], v[216:223], v120
ds_read_b128 v[28:31], v125 offset:192
v_smfmac_f32_16x16x64_bf16 v[80:83], v[0:3], v[224:231], v120
ds_read_b128 v[8:11], v126 offset:0
v_smfmac_f32_16x16x64_bf16 v[84:87], v[0:3], v[232:239], v120
ds_read_b128 v[12:15], v126 offset:64
v_smfmac_f32_16x16x64_bf16 v[80:83], v[4:7], v[240:247], v120
ds_read_b128 v[0:3], v126 offset:128
v_smfmac_f32_16x16x64_bf16 v[84:87], v[4:7], v[248:255], v120
ds_read_b128 v[4:7], v126 offset:192
s_waitcnt lgkmcnt(6)
v_mfma_f32_16x16x32_bf16 v[68:71], v[32:35], v[16:19], 0
v_mov_b64 v[76:77], 0
v_mov_b64 v[78:79], 0
v_mfma_f32_16x16x32_bf16 v[72:75], v[36:39], v[16:19], 0
v_add_f32 v80, v80, v82
v_add_f32 v81, v81, v83
v_mfma_f32_16x16x32_bf16 v[68:71], v[40:43], v[20:23], v[68:71]
v_add_f32 v84, v84, v86
v_add_f32 v85, v85, v87
v_mfma_f32_16x16x32_bf16 v[72:75], v[44:47], v[20:23], v[72:75]
s_waitcnt lgkmcnt(4)
v_cvt_pk_bf16_f32 v90, v80, v81
v_mfma_f32_16x16x32_bf16 v[68:71], v[48:51], v[24:27], v[68:71]
v_cvt_pk_bf16_f32 v98, v84, v85
v_cvt_pk_bf16_f32 v94, v80, v81
v_mfma_f32_16x16x32_bf16 v[72:75], v[52:55], v[24:27], v[72:75]
v_cvt_pk_bf16_f32 v102, v84, v85
v_mov_b64 v[80:81], 0
v_mfma_f32_16x16x32_bf16 v[68:71], v[56:59], v[28:31], v[68:71]
v_mov_b64 v[82:83], 0
v_mov_b64 v[84:85], 0
v_mfma_f32_16x16x32_bf16 v[72:75], v[60:63], v[28:31], v[72:75]
s_waitcnt lgkmcnt(0)
v_mov_b64 v[86:87], 0
v_mfma_f32_16x16x32_bf16 v[64:67], v[8:11], v[16:19], 0
v_cndmask_b32 v68, v68, v70, s[70:71]
v_cndmask_b32 v69, v69, v71, s[70:71]
v_mfma_f32_16x16x32_bf16 v[64:67], v[12:15], v[20:23], v[64:67]
v_cndmask_b32 v72, v72, v74, s[70:71]
v_cndmask_b32 v73, v73, v75, s[70:71]
v_mfma_f32_16x16x32_bf16 v[64:67], v[0:3], v[24:27], v[64:67]
v_mul_f32 v8, s74, v68
v_mul_f32 v9, s74, v69
v_mfma_f32_16x16x32_bf16 v[64:67], v[4:7], v[28:31], v[64:67]
v_mul_f32 v10, s74, v72
v_mul_f32 v11, s74, v73
v_exp_f32 v20, v8
v_exp_f32 v21, v9
v_exp_f32 v22, v10
v_cndmask_b32 v12, v64, v65, s[70:71]
v_mul_f32 v12, s74, v12
v_exp_f32 v23, v11
v_exp_f32_e64 v24, v12
v_cvt_pk_bf16_f32 v16, v20, v21
v_cvt_pk_bf16_f32 v24, v24, v24
v_cvt_pk_bf16_f32 v18, v22, v23
v_and_b32 v17, v24, v99
v_and_b32 v19, v24, v103
v_max3_f32 v13, |v8|, |v9|, |v10|
v_max3_f32 v13, |v11|, |v12|, v13
v_smfmac_f32_16x16x64_bf16 v[76:79], v[16:19], v[104:111], v120 abid:1
ds_read_b128 v[32:35], v123 offset:16384
ds_read_b128 v[36:39], v123 offset:17408
v_cmp_nle_f32 vcc, v13, s6
v_smfmac_f32_16x16x64_bf16 v[80:83], v[16:19], v[88:95], v120 abid:1
ds_read_b128 v[40:43], v123 offset:18432
ds_read_b128 v[44:47], v123 offset:19456
v_smfmac_f32_16x16x64_bf16 v[84:87], v[16:19], v[96:103], v120 abid:1
ds_read_b128 v[48:51], v123 offset:20480
ds_read_b128 v[52:55], v123 offset:21504
v_add_f32 v76, v76, v78
v_add_f32 v77, v77, v79
v_rcp_f32 v76, v76
v_rcp_f32 v77, v77
v_pk_add_f32 v[80:81], v[80:81], v[82:83]
v_pk_add_f32 v[84:85], v[84:85], v[86:87]
v_pk_mul_f32 v[80:81], v[80:81], v[76:77]
v_pk_mul_f32 v[84:85], v[84:85], v[76:77]
v_cvt_pk_bf16_f32 v80, v80, v84
v_cvt_pk_bf16_f32 v81, v81, v85
ds_write2_b32 v127, v80, v81 offset0:0 offset1:16
s_cbranch_vccnz L_r_slow_max0
L_r_slow_pv0:
v_mov_b64 v[0:1], 0
v_mov_b64 v[2:3], 0
v_mov_b64 v[4:5], 0
v_mov_b64 v[6:7], 0
v_mov_b64 v[8:9], 0
v_mov_b64 v[10:11], 0
v_mov_b64 v[12:13], 0
v_mov_b64 v[14:15], 0
v_mov_b64 v[16:17], 0
v_mov_b64 v[18:19], 0
v_mov_b64 v[20:21], 0
v_mov_b64 v[22:23], 0
v_mov_b64 v[24:25], 0
v_mov_b64_e64 v[26:27], 0
s_waitcnt lgkmcnt(0)
s_barrier
ds_read_b128 v[64:67], v121 offset:30208
ds_read_b128 v[68:71], v121 offset:31232
ds_read_b128 v[56:59], v123 offset:22528
ds_read_b128 v[60:63], v123 offset:23552
v_mov_b64 v[28:29], 0
v_mov_b64 v[30:31], 0
s_waitcnt lgkmcnt(3)
v_smfmac_f32_16x16x64_bf16 v[0:3], v[64:67], v[32:39], v120
ds_read_b128 v[32:35], v123 offset:24576
v_smfmac_f32_16x16x64_bf16 v[4:7], v[64:67], v[40:47], v120
s_waitcnt lgkmcnt(3)
ds_read_b128 v[36:39], v123 offset:25600
v_smfmac_f32_16x16x64_bf16 v[0:3], v[68:71], v[48:55], v120
s_waitcnt lgkmcnt(2)
ds_read_b128 v[40:43], v123 offset:26624
v_smfmac_f32_16x16x64_bf16 v[4:7], v[68:71], v[56:63], v120
ds_read_b128 v[44:47], v123 offset:27648
v_smfmac_f32_16x16x64_bf16 v[8:11], v[64:67], a[192:199], v120
ds_read_b128 v[48:51], v123 offset:28672
v_add_f32 v0, v0, v2
v_smfmac_f32_16x16x64_bf16 v[12:15], v[64:67], a[200:207], v120
ds_read_b128 v[52:55], v123 offset:29696
v_add_f32 v1, v1, v3
v_add_f32 v4, v4, v6
v_smfmac_f32_16x16x64_bf16 v[8:11], v[68:71], a[208:215], v120
ds_read_b128 v[56:59], v123 offset:30720
v_add_f32 v5, v5, v7
v_cvt_pk_bf16_f32 v80, v0, v4
v_smfmac_f32_16x16x64_bf16 v[12:15], v[68:71], a[216:223], v120
ds_read_b128 v[60:63], v123 offset:31744
v_cvt_pk_bf16_f32 v82, v1, v5
v_or_b32 v80, 1, v80
v_smfmac_f32_16x16x64_bf16 v[16:19], v[64:67], a[224:231], v120
v_add_f32 v8, v8, v10
v_add_f32 v9, v9, v11
v_smfmac_f32_16x16x64_bf16 v[20:23], v[64:67], a[232:239], v120
v_add_f32 v12, v12, v14
v_add_f32 v13, v13, v15
v_smfmac_f32_16x16x64_bf16 v[16:19], v[68:71], a[240:247], v120
v_cvt_pk_bf16_f32 v81, v8, v12
v_cvt_pk_bf16_f32 v83, v9, v13
v_smfmac_f32_16x16x64_bf16 v[20:23], v[68:71], a[248:255], v120
s_waitcnt lgkmcnt(6)
buffer_store_dwordx4 v[80:83], v91, s[36:39], s66 offen sc0 sc1
v_smfmac_f32_16x16x64_bf16 v[24:27], v[64:67], v[32:39], v120
s_waitcnt lgkmcnt(4)
v_add_f32 v16, v16, v18
v_smfmac_f32_16x16x64_bf16 v[28:31], v[64:67], v[40:47], v120
s_waitcnt lgkmcnt(2)
v_add_f32 v17, v17, v19
v_add_f32 v20, v20, v22
v_smfmac_f32_16x16x64_bf16 v[24:27], v[68:71], v[48:55], v120
s_waitcnt lgkmcnt(0)
v_add_f32 v21, v21, v23
v_cvt_pk_bf16_f32 v84, v16, v20
v_smfmac_f32_16x16x64_bf16 v[28:31], v[68:71], v[56:63], v120
ds_read_b128 v[4:7], v122 offset:29184
v_cvt_pk_bf16_f32 v86, v17, v21
v_or_b32 v84, 1, v84
s_add_u32 s61, s61, 1
s_nop 1
v_pk_add_f32 v[24:25], v[24:25], v[26:27]
v_pk_add_f32 v[28:29], v[28:29], v[30:31]
v_cvt_pk_bf16_f32 v85, v24, v28
v_cvt_pk_bf16_f32 v87, v25, v29
buffer_store_dwordx4 v[84:87], v91, s[36:39], s67 offen sc0 sc1
s_waitcnt vmcnt(0)
buffer_load_dwordx4 v[16:19], v107, s[36:39], s64 offen sc1
buffer_load_dwordx4 v[20:23], v107, s[36:39], s64 offen offset:1024 sc1
ds_read_b128 v[32:35], v123 offset:0
ds_read_b128 v[36:39], v123 offset:1024
ds_read_b128 v[40:43], v123 offset:2048
ds_read_b128 v[44:47], v123 offset:3072
ds_read_b128 v[48:51], v123 offset:4096
ds_read_b128 v[52:55], v123 offset:5120
ds_read_b128 v[56:59], v123 offset:6144
ds_read_b128 v[60:63], v123 offset:7168
v_mov_b64 v[64:65], 0
v_mov_b64 v[66:67], 0
v_mov_b64_e64 v[68:69], 0
v_mov_b64 v[70:71], 0
v_mov_b64 v[72:73], 0
v_mov_b64 v[74:75], 0
v_mov_b64 v[76:77], 0
v_mov_b64_e64 v[78:79], 0
v_mov_b64 v[80:81], 0
v_mov_b64 v[82:83], 0
v_mov_b64 v[84:85], 0
v_mov_b64 v[86:87], 0
s_waitcnt lgkmcnt(8)
buffer_load_dwordx4 v[24:27], v107, s[36:39], s64 offen sc1
buffer_load_dwordx4 v[28:31], v107, s[36:39], s64 offen offset:1024 sc1
L_h1_15:
s_waitcnt vmcnt(3)
v_mfma_f32_16x16x32_bf16 v[0:3], v[4:7], v[16:19], 0
s_waitcnt vmcnt(2)
v_mfma_f32_16x16x32_bf16 v[0:3], v[4:7], v[20:23], v[0:3]
v_bitop3_b32 v8, v16, v20, 1 bitop3:0x80
v_cmp_ne_u32 vcc, 1, v8
s_cbranch_vccnz L_h1_15_r
L_h1_15_ok:
v_mov_b64 v[88:89], v[112:113]
v_mov_b64 v[92:93], v[114:115]
v_mov_b64 v[96:97], v[116:117]
v_mov_b64 v[100:101], v[118:119]
s_nop 0
v_add_f32_dpp v0, v0, v0 row_ror:4 row_mask:0xf bank_mask:0xf
v_add_f32_dpp v1, v1, v1 row_ror:4 row_mask:0xf bank_mask:0xf
s_nop 0
v_add_f32_dpp v0, v0, v0 row_ror:8 row_mask:0xf bank_mask:0xf
v_add_f32_dpp v1, v1, v1 row_ror:8 row_mask:0xf bank_mask:0xf
s_mov_b64 exec, s[72:73]
v_cvt_pk_bf16_f32 v0, v0, v1
v_or_b32 v0, 1, v0
buffer_store_dword v0, v95, s[36:39], s65 offen sc0 sc1
s_mov_b64 exec, -1
ds_read_b64 v[112:113], v111
v_mov_b32 v114, v90
v_mov_b32 v115, v98
s_waitcnt lgkmcnt(0)
s_waitcnt vmcnt(0)
buffer_load_dwordx4 v[0:3], v107, s[36:39], s65 offen sc1
buffer_load_dwordx4 v[4:7], v107, s[36:39], s65 offen offset:1024 sc1
v_xor_b32 v20, 2048, v107
v_xor_b32 v28, 4096, v107
v_xor_b32 v12, 6144, v107
s_cmp_eq_u64 s[68:69], -1
s_cbranch_scc0 L_rf_1002_w
L_rf_1002_ok:
s_branch L_r_slow_H1
.p2align 6
L_r_slow_H1:
s_waitcnt vmcnt(1)
ds_write_b128 v107, v[0:3]
v_smfmac_f32_16x16x64_bf16 v[64:67], v[0:3], a[0:7], v120
s_waitcnt vmcnt(0)
ds_write_b128 v107, v[4:7] offset:1024
v_bitop3_b32 v14, v0, v1, v2 bitop3:0x80
v_bitop3_b32 v15, v3, v4, v5 bitop3:0x80
v_smfmac_f32_16x16x64_bf16 v[68:71], v[0:3], a[8:15], v120
v_bitop3_b32 v14, v14, v6, v7 bitop3:0x80
v_bitop3_b32 v14, v14, v15, 1 bitop3:0x80
v_cmp_ne_u32 vcc, 1, v14
s_cbranch_vccnz L_r_slow_HR1
L_r_slow_A1:
v_smfmac_f32_16x16x64_bf16 v[72:75], v[0:3], a[16:23], v120
v_smfmac_f32_16x16x64_bf16 v[76:79], v[0:3], v[32:39], v120
v_smfmac_f32_16x16x64_bf16 v[64:67], v[4:7], a[24:31], v120
s_waitcnt lgkmcnt(0)
s_barrier
ds_read_b128 v[16:19], v20 offset:0
ds_read_b128 v[20:23], v20 offset:1024
v_smfmac_f32_16x16x64_bf16 v[68:71], v[4:7], a[32:39], v120
ds_read_b128 v[24:27], v28 offset:0
v_smfmac_f32_16x16x64_bf16 v[72:75], v[4:7], a[40:47], v120
ds_read_b128 v[28:31], v28 offset:1024
v_smfmac_f32_16x16x64_bf16 v[76:79], v[4:7], v[40:47], v120
v_smfmac_f32_16x16x64_bf16 v[80:83], v[0:3], v[128:135], v120
ds_read_b128 v[32:35], v123 offset:8192
s_add_u32 s54, s61, 1
v_smfmac_f32_16x16x64_bf16 v[84:87], v[0:3], v[136:143], v120
ds_read_b128 v[36:39], v123 offset:9216
s_add_u32 s52, s62, 8192
v_smfmac_f32_16x16x64_bf16 v[80:83], v[4:7], v[144:151], v120
ds_read_b128 v[40:43], v123 offset:10240
s_mov_b32 m0, s76
v_smfmac_f32_16x16x64_bf16 v[84:87], v[4:7], v[152:159], v120
ds_read_b128 v[44:47], v123 offset:11264
s_waitcnt lgkmcnt(7)
v_smfmac_f32_16x16x64_bf16 v[64:67], v[16:19], a[48:55], v120
ds_read_b128 v[0:3], v12 offset:0
v_smfmac_f32_16x16x64_bf16 v[68:71], v[16:19], a[56:63], v120
ds_read_b128 v[4:7], v12 offset:1024
s_cmp_eq_u64 s[68:69], -1
s_cbranch_scc0 L_kv_1003_w
L_kv_1003_ok:
v_smfmac_f32_16x16x64_bf16 v[72:75], v[16:19], a[64:71], v120
buffer_store_dwordx4 v[112:115], v122, s[36:39], s63 offen sc0 sc1
s_add_u32 s63, s63, 131072
v_smfmac_f32_16x16x64_bf16 v[76:79], v[16:19], v[48:55], v120
s_waitcnt lgkmcnt(8)
ds_read_b128 v[48:51], v123 offset:12288
v_smfmac_f32_16x16x64_bf16 v[64:67], v[20:23], a[72:79], v120
ds_read_b128 v[52:55], v123 offset:13312
v_smfmac_f32_16x16x64_bf16 v[68:71], v[20:23], a[80:87], v120
buffer_load_dwordx4 v107, s[36:39], s62 offen sc1 lds
v_smfmac_f32_16x16x64_bf16 v[72:75], v[20:23], a[88:95], v120
buffer_load_dwordx4 v107, s[36:39], s62 offen offset:1024 sc1 lds
v_smfmac_f32_16x16x64_bf16 v[76:79], v[20:23], v[56:63], v120
s_waitcnt lgkmcnt(9)
ds_read_b128 v[56:59], v123 offset:14336
v_smfmac_f32_16x16x64_bf16 v[64:67], v[24:27], a[96:103], v120
ds_read_b128 v[60:63], v123 offset:15360
v_smfmac_f32_16x16x64_bf16 v[68:71], v[24:27], a[104:111], v120
buffer_load_dwordx4 v[112:115], v107, s[36:39], s52 offen sc1
v_smfmac_f32_16x16x64_bf16 v[72:75], v[24:27], a[112:119], v120
s_waitcnt lgkmcnt(8)
buffer_load_dwordx4 v[116:119], v107, s[36:39], s52 offen offset:1024 sc1
s_add_u32 s62, s62, 524288
v_smfmac_f32_16x16x64_bf16 v[76:79], v[24:27], v[32:39], v120
ds_read_b128 v[32:35], v122 offset:16384
v_smfmac_f32_16x16x64_bf16 v[64:67], v[28:31], a[120:127], v120
ds_read_b128 v[36:39], v122 offset:20480
v_smfmac_f32_16x16x64_bf16 v[68:71], v[28:31], a[128:135], v120
s_mov_b64 exec, s[0:1]
buffer_store_dword v120, off, s[36:39], s75 sc0 sc1
s_mov_b64 exec, -1
s_add_u32 s75, s75, 4
v_smfmac_f32_16x16x64_bf16 v[72:75], v[28:31], a[136:143], v120
s_waitcnt lgkmcnt(8)
v_smfmac_f32_16x16x64_bf16 v[76:79], v[28:31], v[40:47], v120
s_waitcnt lgkmcnt(7)
ds_read_b128 v[40:43], v122 offset:17408
v_smfmac_f32_16x16x64_bf16 v[64:67], v[0:3], a[144:151], v120
ds_read_b128 v[44:47], v122 offset:21504
v_smfmac_f32_16x16x64_bf16 v[68:71], v[0:3], a[152:159], v120
s_waitcnt lgkmcnt(8)
v_smfmac_f32_16x16x64_bf16 v[64:67], v[4:7], a[168:175], v120
v_smfmac_f32_16x16x64_bf16 v[68:71], v[4:7], a[176:183], v120
v_smfmac_f32_16x16x64_bf16 v[72:75], v[0:3], a[160:167], v120
s_waitcnt lgkmcnt(6)
v_add_f32 v64, v64, v66
v_smfmac_f32_16x16x64_bf16 v[76:79], v[0:3], v[48:55], v120
ds_read_b128 v[48:51], v122 offset:18432
v_add_f32 v65, v65, v67
v_smfmac_f32_16x16x64_bf16 v[72:75], v[4:7], a[184:191], v120
s_waitcnt lgkmcnt(5)
ds_read_b128 v[52:55], v122 offset:22528
v_add_f32 v68, v68, v70
v_smfmac_f32_16x16x64_bf16 v[76:79], v[4:7], v[56:63], v120
v_smfmac_f32_16x16x64_bf16 v[80:83], v[16:19], v[160:167], v120
v_add_f32 v69, v69, v71
v_cvt_pk_bf16_f32 v66, v64, v68
v_cvt_pk_bf16_f32 v70, v65, v69
v_add_f32_e64 v72, v72, v74
v_add_f32 v73, v73, v75
v_add_f32 v76, v76, v78
v_add_f32 v77, v77, v79
v_cvt_pk_bf16_f32 v67, v72, v76
v_cvt_pk_bf16_f32 v71, v73, v77
ds_write2_b64 v124, v[66:67], v[70:71] offset0:0 offset1:36
v_smfmac_f32_16x16x64_bf16 v[84:87], v[16:19], v[168:175], v120
ds_read_b128 v[56:59], v122 offset:19456
v_smfmac_f32_16x16x64_bf16 v[80:83], v[20:23], v[176:183], v120
ds_read_b128 v[60:63], v122 offset:23552
v_smfmac_f32_16x16x64_bf16 v[84:87], v[20:23], v[184:191], v120
v_smfmac_f32_16x16x64_bf16 v[80:83], v[24:27], v[192:199], v120
v_smfmac_f32_16x16x64_bf16 v[84:87], v[24:27], v[200:207], v120
s_waitcnt lgkmcnt(2)
s_barrier
ds_read_b128 v[16:19], v125 offset:0
ds_read_b128 v[20:23], v125 offset:64
v_smfmac_f32_16x16x64_bf16 v[80:83], v[28:31], v[208:215], v120
ds_read_b128 v[24:27], v125 offset:128
v_smfmac_f32_16x16x64_bf16 v[84:87], v[28:31], v[216:223], v120
ds_read_b128 v[28:31], v125 offset:192
v_smfmac_f32_16x16x64_bf16 v[80:83], v[0:3], v[224:231], v120
ds_read_b128 v[8:11], v126 offset:0
v_smfmac_f32_16x16x64_bf16 v[84:87], v[0:3], v[232:239], v120
ds_read_b128 v[12:15], v126 offset:64
v_smfmac_f32_16x16x64_bf16 v[80:83], v[4:7], v[240:247], v120
ds_read_b128 v[0:3], v126 offset:128
v_smfmac_f32_16x16x64_bf16 v[84:87], v[4:7], v[248:255], v120
ds_read_b128 v[4:7], v126 offset:192
s_waitcnt lgkmcnt(6)
v_mfma_f32_16x16x32_bf16 v[68:71], v[32:35], v[16:19], 0
v_mov_b64 v[76:77], 0
v_mov_b64 v[78:79], 0
v_mfma_f32_16x16x32_bf16 v[72:75], v[36:39], v[16:19], 0
v_add_f32 v80, v80, v82
v_add_f32 v81, v81, v83
v_mfma_f32_16x16x32_bf16 v[68:71], v[40:43], v[20:23], v[68:71]
v_add_f32 v84, v84, v86
v_add_f32 v85, v85, v87
v_mfma_f32_16x16x32_bf16 v[72:75], v[44:47], v[20:23], v[72:75]
s_waitcnt lgkmcnt(4)
v_cvt_pk_bf16_f32 v90, v80, v81
v_mfma_f32_16x16x32_bf16 v[68:71], v[48:51], v[24:27], v[68:71]
v_cvt_pk_bf16_f32 v98, v84, v85
v_cvt_pk_bf16_f32 v94, v80, v81
v_mfma_f32_16x16x32_bf16 v[72:75], v[52:55], v[24:27], v[72:75]
v_cvt_pk_bf16_f32 v102, v84, v85
v_mov_b64 v[80:81], 0
v_mfma_f32_16x16x32_bf16 v[68:71], v[56:59], v[28:31], v[68:71]
v_mov_b64 v[82:83], 0
v_mov_b64 v[84:85], 0
v_mfma_f32_16x16x32_bf16 v[72:75], v[60:63], v[28:31], v[72:75]
s_waitcnt lgkmcnt(0)
v_mov_b64 v[86:87], 0
v_mfma_f32_16x16x32_bf16 v[64:67], v[8:11], v[16:19], 0
v_cndmask_b32 v68, v68, v70, s[70:71]
v_cndmask_b32 v69, v69, v71, s[70:71]
v_mfma_f32_16x16x32_bf16 v[64:67], v[12:15], v[20:23], v[64:67]
v_cndmask_b32 v72, v72, v74, s[70:71]
v_cndmask_b32 v73, v73, v75, s[70:71]
v_mfma_f32_16x16x32_bf16 v[64:67], v[0:3], v[24:27], v[64:67]
v_mul_f32 v8, s74, v68
v_mul_f32 v9, s74, v69
v_mfma_f32_16x16x32_bf16 v[64:67], v[4:7], v[28:31], v[64:67]
v_mul_f32 v10, s74, v72
v_mul_f32 v11, s74, v73
v_exp_f32 v20, v8
v_exp_f32 v21, v9
v_exp_f32 v22, v10
v_cndmask_b32 v12, v64, v65, s[70:71]
v_mul_f32 v12, s74, v12
v_exp_f32 v23, v11
v_exp_f32 v24, v12
v_cvt_pk_bf16_f32 v16, v20, v21
v_cvt_pk_bf16_f32 v24, v24, v24
v_cvt_pk_bf16_f32 v18, v22, v23
v_and_b32 v17, v24, v99
v_and_b32 v19, v24, v103
v_max3_f32 v13, |v8|, |v9|, |v10|
v_max3_f32 v13, |v11|, |v12|, v13
v_smfmac_f32_16x16x64_bf16 v[76:79], v[16:19], v[104:111], v120 abid:1
ds_read_b128 v[32:35], v123 offset:16384
ds_read_b128 v[36:39], v123 offset:17408
v_cmp_nle_f32 vcc, v13, s6
v_smfmac_f32_16x16x64_bf16 v[80:83], v[16:19], v[88:95], v120 abid:1
ds_read_b128 v[40:43], v123 offset:18432
ds_read_b128 v[44:47], v123 offset:19456
v_smfmac_f32_16x16x64_bf16 v[84:87], v[16:19], v[96:103], v120 abid:1
ds_read_b128 v[48:51], v123 offset:20480
ds_read_b128 v[52:55], v123 offset:21504
s_cmp_eq_u32 s61, 63
v_add_f32 v76, v76, v78
v_add_f32 v77, v77, v79
v_rcp_f32 v76, v76
v_rcp_f32 v77, v77
v_pk_add_f32 v[80:81], v[80:81], v[82:83]
v_pk_add_f32 v[84:85], v[84:85], v[86:87]
v_pk_mul_f32 v[80:81], v[80:81], v[76:77]
v_pk_mul_f32 v[84:85], v[84:85], v[76:77]
v_cvt_pk_bf16_f32 v80, v80, v84
v_cvt_pk_bf16_f32 v81, v81, v85
ds_write2_b32 v127, v80, v81 offset0:0 offset1:16
s_cbranch_scc1 L_r_done
s_cbranch_vccnz L_r_slow_max1
L_r_slow_pv1:
v_mov_b64 v[0:1], 0
v_mov_b64 v[2:3], 0
v_mov_b64 v[4:5], 0
v_mov_b64 v[6:7], 0
v_mov_b64 v[8:9], 0
v_mov_b64 v[10:11], 0
v_mov_b64 v[12:13], 0
v_mov_b64 v[14:15], 0
v_mov_b64 v[16:17], 0
v_mov_b64 v[18:19], 0
v_mov_b64 v[20:21], 0
v_mov_b64 v[22:23], 0
v_mov_b64 v[24:25], 0
v_mov_b64 v[26:27], 0
s_waitcnt lgkmcnt(0)
s_barrier
ds_read_b128 v[64:67], v121 offset:30208
ds_read_b128 v[68:71], v121 offset:31232
ds_read_b128 v[56:59], v123 offset:22528
ds_read_b128 v[60:63], v123 offset:23552
v_mov_b64 v[28:29], 0
v_mov_b64 v[30:31], 0
s_waitcnt lgkmcnt(3)
v_smfmac_f32_16x16x64_bf16 v[0:3], v[64:67], v[32:39], v120
ds_read_b128 v[32:35], v123 offset:24576
v_smfmac_f32_16x16x64_bf16 v[4:7], v[64:67], v[40:47], v120
s_waitcnt lgkmcnt(3)
ds_read_b128 v[36:39], v123 offset:25600
v_smfmac_f32_16x16x64_bf16 v[0:3], v[68:71], v[48:55], v120
s_waitcnt lgkmcnt(2)
ds_read_b128 v[40:43], v123 offset:26624
v_smfmac_f32_16x16x64_bf16 v[4:7], v[68:71], v[56:63], v120
ds_read_b128 v[44:47], v123 offset:27648
v_smfmac_f32_16x16x64_bf16 v[8:11], v[64:67], a[192:199], v120
ds_read_b128 v[48:51], v123 offset:28672
v_add_f32 v0, v0, v2
v_smfmac_f32_16x16x64_bf16 v[12:15], v[64:67], a[200:207], v120
ds_read_b128 v[52:55], v123 offset:29696
v_add_f32 v1, v1, v3
v_add_f32 v4, v4, v6
v_smfmac_f32_16x16x64_bf16 v[8:11], v[68:71], a[208:215], v120
ds_read_b128 v[56:59], v123 offset:30720
v_add_f32 v5, v5, v7
v_cvt_pk_bf16_f32 v80, v0, v4
v_smfmac_f32_16x16x64_bf16 v[12:15], v[68:71], a[216:223], v120
ds_read_b128 v[60:63], v123 offset:31744
v_cvt_pk_bf16_f32 v82, v1, v5
v_and_b32 v80, -2, v80
v_smfmac_f32_16x16x64_bf16 v[16:19], v[64:67], a[224:231], v120
v_add_f32 v8, v8, v10
v_add_f32 v9, v9, v11
v_smfmac_f32_16x16x64_bf16 v[20:23], v[64:67], a[232:239], v120
v_add_f32 v12, v12, v14
v_add_f32 v13, v13, v15
v_smfmac_f32_16x16x64_bf16 v[16:19], v[68:71], a[240:247], v120
v_cvt_pk_bf16_f32 v81, v8, v12
v_cvt_pk_bf16_f32 v83, v9, v13
v_smfmac_f32_16x16x64_bf16 v[20:23], v[68:71], a[248:255], v120
s_waitcnt lgkmcnt(6)
buffer_store_dwordx4 v[80:83], v91, s[36:39], s66 offen sc0 sc1
v_smfmac_f32_16x16x64_bf16 v[24:27], v[64:67], v[32:39], v120
s_waitcnt lgkmcnt(4)
v_add_f32 v16, v16, v18
v_smfmac_f32_16x16x64_bf16 v[28:31], v[64:67], v[40:47], v120
s_waitcnt lgkmcnt(2)
v_add_f32 v17, v17, v19
v_add_f32 v20, v20, v22
v_smfmac_f32_16x16x64_bf16 v[24:27], v[68:71], v[48:55], v120
s_waitcnt lgkmcnt(0)
v_add_f32 v21, v21, v23
v_cvt_pk_bf16_f32 v84, v16, v20
v_smfmac_f32_16x16x64_bf16 v[28:31], v[68:71], v[56:63], v120
ds_read_b128 v[4:7], v122 offset:29184
v_cvt_pk_bf16_f32 v86, v17, v21
v_and_b32_e64 v84, -2, v84
s_add_u32 s61, s61, 1
s_nop 1
v_pk_add_f32 v[24:25], v[24:25], v[26:27]
v_pk_add_f32 v[28:29], v[28:29], v[30:31]
v_cvt_pk_bf16_f32 v85, v24, v28
v_cvt_pk_bf16_f32 v87, v25, v29
buffer_store_dwordx4 v[84:87], v91, s[36:39], s67 offen sc0 sc1
s_waitcnt vmcnt(0)
buffer_load_dwordx4 v[16:19], v107, s[36:39], s64 offen sc1
buffer_load_dwordx4 v[20:23], v107, s[36:39], s64 offen offset:1024 sc1
ds_read_b128 v[32:35], v123 offset:0
ds_read_b128 v[36:39], v123 offset:1024
ds_read_b128 v[40:43], v123 offset:2048
ds_read_b128 v[44:47], v123 offset:3072
ds_read_b128 v[48:51], v123 offset:4096
ds_read_b128 v[52:55], v123 offset:5120
ds_read_b128 v[56:59], v123 offset:6144
ds_read_b128 v[60:63], v123 offset:7168
v_mov_b64 v[64:65], 0
v_mov_b64 v[66:67], 0
v_mov_b64 v[68:69], 0
v_mov_b64 v[70:71], 0
v_mov_b64 v[72:73], 0
v_mov_b64 v[74:75], 0
v_mov_b64 v[76:77], 0
v_mov_b64 v[78:79], 0
v_mov_b64 v[80:81], 0
v_mov_b64 v[82:83], 0
v_mov_b64 v[84:85], 0
v_mov_b64 v[86:87], 0
s_cmp_eq_u32 s3, 3
s_cselect_b32 s0, 1, 0
s_waitcnt lgkmcnt(8)
buffer_load_dwordx4 v[24:27], v107, s[36:39], s64 offen sc1
buffer_load_dwordx4 v[28:31], v107, s[36:39], s64 offen offset:1024 sc1
L_h1_16:
s_waitcnt vmcnt(3)
v_mfma_f32_16x16x32_bf16 v[0:3], v[4:7], v[16:19], 0
s_waitcnt vmcnt(2)
v_mfma_f32_16x16x32_bf16 v[0:3], v[4:7], v[20:23], v[0:3]
v_bitop3_b32 v8, v16, v20, 1 bitop3:0xa8
v_cmp_ne_u32 vcc, 0, v8
s_cbranch_vccnz L_h1_16_r
L_h1_16_ok:
v_mov_b64 v[88:89], v[112:113]
v_mov_b64 v[92:93], v[114:115]
v_mov_b64 v[96:97], v[116:117]
v_mov_b64 v[100:101], v[118:119]
s_nop 0
v_add_f32_dpp v0, v0, v0 row_ror:4 row_mask:0xf bank_mask:0xf
v_add_f32_dpp v1, v1, v1 row_ror:4 row_mask:0xf bank_mask:0xf
s_nop 0
v_add_f32_dpp v0, v0, v0 row_ror:8 row_mask:0xf bank_mask:0xf
v_add_f32_dpp v1, v1, v1 row_ror:8 row_mask:0xf bank_mask:0xf
s_mov_b64 exec, s[72:73]
v_cvt_pk_bf16_f32 v0, v0, v1
v_and_b32 v0, -2, v0
buffer_store_dword v0, v95, s[36:39], s65 offen sc0 sc1
s_mov_b64 exec, -1
ds_read_b64 v[112:113], v111
v_mov_b32 v114, v90
v_mov_b32 v115, v98
s_waitcnt lgkmcnt(0)
s_waitcnt vmcnt(0)
buffer_load_dwordx4 v[0:3], v107, s[36:39], s65 offen sc1
buffer_load_dwordx4 v[4:7], v107, s[36:39], s65 offen offset:1024 sc1
v_xor_b32 v20, 2048, v107
v_xor_b32 v28, 4096, v107
v_xor_b32 v12, 6144, v107
s_cmp_eq_u64 s[68:69], -1
s_cbranch_scc0 L_rf_1004_w
L_rf_1004_ok:
s_branch L_r_slow_H0
L_r_slow_HR0:
s_mov_b64 exec, vcc
buffer_load_dwordx4 v[0:3], v107, s[36:39], s65 offen sc1
buffer_load_dwordx4 v[4:7], v107, s[36:39], s65 offen offset:1024 sc1
s_mov_b64 exec, -1
s_waitcnt lgkmcnt(0)
s_nop 3
v_mov_b64 v[64:65], 0
v_mov_b64 v[66:67], 0
v_mov_b64 v[68:69], 0
v_mov_b64 v[70:71], 0
s_sub_u32 s56, s56, 1
s_cbranch_scc1 L_r_quit
s_branch L_r_slow_H0
L_r_slow_first:
v_smfmac_f32_16x16x64_bf16 v[64:67], v[0:3], a[0:7], v120
v_smfmac_f32_16x16x64_bf16 v[68:71], v[0:3], a[8:15], v120
s_branch L_r_slow_A0
L_kv_1001_w:
s_lshl_b32 s53, s60, 8
v_lshrrev_b32 v14, 2, v122
s_mov_b32 m0, 32256
s_bitcmp1_b64 s[68:69], s54
buffer_load_dword v14, s[36:39], s53 offen sc1 lds
s_mov_b32 m0, s77
s_cbranch_scc1 L_kv_1001_ok
L_kv_1001:
buffer_load_dword v15, v14, s[36:39], s53 offen sc1
s_waitcnt vmcnt(0)
v_cmp_ne_u32 s[68:69], 0, v15
s_nop 4
s_bitcmp1_b64 s[68:69], s54
s_cbranch_scc1 L_kv_1001_ok
s_sub_u32 s56, s56, 1
s_cbranch_scc0 L_kv_1001
s_endpgm
L_h1_15_r:
s_waitcnt vmcnt(1)
v_mfma_f32_16x16x32_bf16 v[0:3], v[4:7], v[24:27], 0
s_waitcnt vmcnt(0)
v_mfma_f32_16x16x32_bf16 v[0:3], v[4:7], v[28:31], v[0:3]
v_bitop3_b32 v8, v24, v28, 1 bitop3:0x80
v_cmp_ne_u32 vcc, 1, v8
s_cbranch_vccz L_h1_15_ok
s_mov_b64 exec, vcc
buffer_load_dwordx4 v[24:27], v107, s[36:39], s64 offen sc1
buffer_load_dwordx4 v[28:31], v107, s[36:39], s64 offen offset:1024 sc1
s_mov_b64 exec, -1
s_sub_u32 s56, s56, 1
s_cbranch_scc0 L_h1_15_r
s_endpgm
L_rf_1002_w:
v_lshrrev_b32 v14, 2, v122
ds_read_b32 v14, v14 offset:32256
s_waitcnt lgkmcnt(0)
v_cmp_ne_u32 vcc, 0, v14
s_nop 4
s_or_b64 s[68:69], s[68:69], vcc
s_branch L_rf_1002_ok
L_r_slow_max0:
v_max3_f32 v13, v8, v9, v10
v_max3_f32 v13, v13, v11, v12
s_nop 1
v_max_f32_dpp v14, v13, v13 quad_perm:[2,3,0,1] row_mask:0xf bank_mask:0xf
v_max_f32_dpp v13, v13, v13 quad_perm:[2,3,0,1] row_mask:0xf bank_mask:0xf
s_nop 1
v_permlane16_swap_b32 v13, v14
v_max_f32 v15, v13, v14
v_max_f32 v13, v13, v14
s_nop 1
v_permlane32_swap_b32 v13, v15
v_max_f32 v13, v13, v15
v_sub_f32 v8, v8, v13
v_sub_f32 v9, v9, v13
v_sub_f32 v10, v10, v13
v_sub_f32 v11, v11, v13
v_sub_f32 v12, v12, v13
v_exp_f32 v12, v12
v_exp_f32 v8, v8
v_exp_f32 v9, v9
v_exp_f32 v10, v10
v_exp_f32 v11, v11
v_cvt_pk_bf16_f32 v12, v12, v12
v_cvt_pk_bf16_f32 v16, v8, v9
v_cvt_pk_bf16_f32 v18, v10, v11
v_and_b32 v17, v12, v99
v_and_b32 v19, v12, v103
s_waitcnt lgkmcnt(0)
v_mov_b64 v[76:77], 0
v_mov_b64 v[78:79], 0
v_mov_b64 v[80:81], 0
v_mov_b64 v[82:83], 0
v_mov_b64 v[84:85], 0
v_mov_b64 v[86:87], 0
s_nop 1
v_smfmac_f32_16x16x64_bf16 v[76:79], v[16:19], v[104:111], v120 abid:1
v_smfmac_f32_16x16x64_bf16 v[80:83], v[16:19], v[88:95], v120 abid:1
v_smfmac_f32_16x16x64_bf16 v[84:87], v[16:19], v[96:103], v120 abid:1
s_nop 7
s_nop 3
v_add_f32 v76, v76, v78
v_add_f32 v77, v77, v79
v_rcp_f32 v76, v76
v_rcp_f32 v77, v77
v_pk_add_f32 v[80:81], v[80:81], v[82:83]
v_pk_add_f32 v[84:85], v[84:85], v[86:87]
v_pk_mul_f32 v[80:81], v[80:81], v[76:77]
v_pk_mul_f32 v[84:85], v[84:85], v[76:77]
v_cvt_pk_bf16_f32 v80, v80, v84
v_cvt_pk_bf16_f32 v81, v81, v85
ds_write2_b32 v127, v80, v81 offset0:0 offset1:16
s_branch L_r_slow_pv0
L_r_slow_HR1:
s_mov_b64 exec, vcc
buffer_load_dwordx4 v[0:3], v107, s[36:39], s65 offen sc1
buffer_load_dwordx4 v[4:7], v107, s[36:39], s65 offen offset:1024 sc1
s_mov_b64 exec, -1
s_waitcnt lgkmcnt(0)
s_nop 3
v_mov_b64 v[64:65], 0
v_mov_b64 v[66:67], 0
v_mov_b64 v[68:69], 0
v_mov_b64 v[70:71], 0
s_sub_u32 s56, s56, 1
s_cbranch_scc1 L_r_quit
s_branch L_r_slow_H1
L_kv_1003_w:
s_lshl_b32 s53, s60, 8
v_lshrrev_b32 v14, 2, v122
s_mov_b32 m0, 32256
s_bitcmp1_b64 s[68:69], s54
buffer_load_dword v14, s[36:39], s53 offen sc1 lds
s_mov_b32 m0, s76
s_cbranch_scc1 L_kv_1003_ok
L_kv_1003:
buffer_load_dword v15, v14, s[36:39], s53 offen sc1
s_waitcnt vmcnt(0)
v_cmp_ne_u32 s[68:69], 0, v15
s_nop 4
s_bitcmp1_b64 s[68:69], s54
s_cbranch_scc1 L_kv_1003_ok
s_sub_u32 s56, s56, 1
s_cbranch_scc0 L_kv_1003
s_endpgm
L_h1_16_r:
s_waitcnt vmcnt(1)
v_mfma_f32_16x16x32_bf16 v[0:3], v[4:7], v[24:27], 0
s_waitcnt vmcnt(0)
v_mfma_f32_16x16x32_bf16 v[0:3], v[4:7], v[28:31], v[0:3]
v_bitop3_b32 v8, v24, v28, 1 bitop3:0xa8
v_cmp_ne_u32 vcc, 0, v8
s_cbranch_vccz L_h1_16_ok
s_mov_b64 exec, vcc
buffer_load_dwordx4 v[24:27], v107, s[36:39], s64 offen sc1
buffer_load_dwordx4 v[28:31], v107, s[36:39], s64 offen offset:1024 sc1
s_mov_b64 exec, -1
s_sub_u32 s56, s56, 1
s_cbranch_scc0 L_h1_16_r
s_endpgm
L_rf_1004_w:
v_lshrrev_b32 v14, 2, v122
ds_read_b32 v14, v14 offset:32256
s_waitcnt lgkmcnt(0)
v_cmp_ne_u32 vcc, 0, v14
s_nop 4
s_or_b64 s[68:69], s[68:69], vcc
s_branch L_rf_1004_ok
L_r_slow_max1:
v_max3_f32 v13, v8, v9, v10
v_max3_f32 v13, v13, v11, v12
s_nop 1
v_max_f32_dpp v14, v13, v13 quad_perm:[2,3,0,1] row_mask:0xf bank_mask:0xf
v_max_f32_dpp v13, v13, v13 quad_perm:[2,3,0,1] row_mask:0xf bank_mask:0xf
s_nop 1
v_permlane16_swap_b32 v13, v14
v_max_f32 v15, v13, v14
v_max_f32 v13, v13, v14
s_nop 1
v_permlane32_swap_b32 v13, v15
v_max_f32 v13, v13, v15
v_sub_f32 v8, v8, v13
v_sub_f32 v9, v9, v13
v_sub_f32 v10, v10, v13
v_sub_f32 v11, v11, v13
v_sub_f32 v12, v12, v13
v_exp_f32 v12, v12
v_exp_f32 v8, v8
v_exp_f32 v9, v9
v_exp_f32 v10, v10
v_exp_f32 v11, v11
v_cvt_pk_bf16_f32 v12, v12, v12
v_cvt_pk_bf16_f32 v16, v8, v9
v_cvt_pk_bf16_f32 v18, v10, v11
v_and_b32 v17, v12, v99
v_and_b32 v19, v12, v103
s_waitcnt lgkmcnt(0)
v_mov_b64 v[76:77], 0
v_mov_b64 v[78:79], 0
v_mov_b64 v[80:81], 0
v_mov_b64 v[82:83], 0
v_mov_b64 v[84:85], 0
v_mov_b64 v[86:87], 0
s_nop 1
v_smfmac_f32_16x16x64_bf16 v[76:79], v[16:19], v[104:111], v120 abid:1
v_smfmac_f32_16x16x64_bf16 v[80:83], v[16:19], v[88:95], v120 abid:1
v_smfmac_f32_16x16x64_bf16 v[84:87], v[16:19], v[96:103], v120 abid:1
s_nop 7
s_nop 3
v_add_f32 v76, v76, v78
v_add_f32 v77, v77, v79
v_rcp_f32 v76, v76
v_rcp_f32 v77, v77
v_pk_add_f32 v[80:81], v[80:81], v[82:83]
v_pk_add_f32 v[84:85], v[84:85], v[86:87]
v_pk_mul_f32 v[80:81], v[80:81], v[76:77]
v_pk_mul_f32 v[84:85], v[84:85], v[76:77]
v_cvt_pk_bf16_f32 v80, v80, v84
v_cvt_pk_bf16_f32 v81, v81, v85
ds_write2_b32 v127, v80, v81 offset0:0 offset1:16
s_branch L_r_slow_pv1
L_r_quit:
s_endpgm
L_r_done:
s_waitcnt vmcnt(0)
ds_read_b64 v[112:113], v111
v_mov_b32 v114, v90
v_mov_b32 v115, v98
s_waitcnt lgkmcnt(0)
buffer_store_dwordx4 v[112:115], v122, s[36:39], s63 offen sc0 sc1
s_add_u32 s63, s63, 131072
s_waitcnt vmcnt(0)
s_barrier
s_mov_b64 exec, 1
buffer_store_dword v120, off, s[36:39], s75 sc0 sc1
buffer_store_dword v120, off, s[36:39], s75 offset:4 sc0 sc1
s_waitcnt vmcnt(0)
s_endpgm

.section .rodata,"a"
.p2align 6
.amdhsa_kernel gated_mix__mha_block__memory_aug_recurrent_mem_tr__prompt_kernel
  .amdhsa_next_free_vgpr 512
  .amdhsa_next_free_sgpr 102
  .amdhsa_accum_offset 256
  .amdhsa_group_segment_fixed_size 0
  .amdhsa_kernarg_size 112
  .amdhsa_user_sgpr_count 2
  .amdhsa_user_sgpr_kernarg_segment_ptr 1
  .amdhsa_system_sgpr_workgroup_id_x 1
.end_amdhsa_kernel
```
